```python
import torch

def _softmax(x, axis=-1):
    return torch.softmax(x, dim=axis)
def _gelu(x):
    return torch.nn.functional.gelu(x, approximate="tanh")
def _silu(x):
    return torch.nn.functional.silu(x)
def _sigmoid(x):
    return torch.sigmoid(x)
def _layernorm(x, axis=-1, eps=1e-5):
    m = x.mean(dim=axis, keepdim=True)
    v = x.var(dim=axis, keepdim=True, unbiased=False)
    return (x - m) / torch.sqrt(v + eps)
def _scatter_add(tgt, idx, src, axis=0):
    return tgt.clone().index_add_(axis, idx, src)
def _segment_sum(src, seg, n):
    out = torch.zeros((n,) + src.shape[1:], dtype=src.dtype)
    return out.index_add_(0, seg, src)
def _pad(x, pw):
    flat = tuple(v for pair in reversed(pw) for v in pair)
    return torch.nn.functional.pad(x, flat)

kernel_name = 'parallel_sum__softmax_full_mha__swiglu_ffn__prompt'

def setup_inputs():

    _w = (lambda a: (lambda t: t.to(torch.bfloat16) if t.is_floating_point() else t)(torch.as_tensor(a)))
    def _A_setup():
        B, S, D = 1, 2048, 1024
        return {
            "x": _w((lambda *s: torch.randn(*s, dtype=torch.bfloat16) * 0.05)(B, S, D)),
            "wqkv": _w((lambda *s: torch.randn(*s, dtype=torch.bfloat16) * 0.05)(D, 3 * D)),
            "wo": _w((lambda *s: torch.randn(*s, dtype=torch.bfloat16) * 0.05)(D, D)),
        }
    _A_in = _A_setup()

    def _B_setup():
        B, S, D, F = 1, 2048, 1024, 3584
        return {
            "x": _w((lambda *s: torch.randn(*s, dtype=torch.bfloat16) * 0.05)(B, S, D)),
            "w_gate": _w((lambda *s: torch.randn(*s, dtype=torch.bfloat16) * 0.05)(D, F)),
            "w_up": _w((lambda *s: torch.randn(*s, dtype=torch.bfloat16) * 0.05)(D, F)),
            "w_down": _w((lambda *s: torch.randn(*s, dtype=torch.bfloat16) * 0.05)(F, D)),
        }
    _B_in = _B_setup()

    return {
        "A_x": _A_in["x"],
        "A_wqkv": _A_in["wqkv"],
        "A_wo": _A_in["wo"],
        "B_x": _B_in["x"],
        "B_w_gate": _B_in["w_gate"],
        "B_w_up": _B_in["w_up"],
        "B_w_down": _B_in["w_down"],
    }

def reference(A_x, A_wqkv, A_wo, B_x, B_w_gate, B_w_up, B_w_down):
    def _A_ref(x, wqkv, wo):
        B, S, D = x.shape
        H = 32; Dh = D // H
        qkv = (lambda x, *d: x.permute(*d))((x @ wqkv).reshape(B, S, 3, H, Dh), 2, 0, 3, 1, 4)
        q, k, v = qkv[0], qkv[1], qkv[2]
        scale = Dh ** -0.5
        scores = torch.einsum("bhqd,bhkd->bhqk", q, k) * scale
        p = _softmax(scores, axis=-1)
        o = torch.einsum("bhqk,bhkd->bhqd", p, v)
        return (lambda x, *d: x.permute(*d))(o, 0, 2, 1, 3).reshape(B, S, D) @ wo

    def _B_ref(x, w_gate, w_up, w_down):
        g = _silu(x @ w_gate)
        u = x @ w_up
        return (g * u) @ w_down

    x = A_x
    xn = _layernorm(x, axis=-1)
    return x + _A_ref(xn, A_wqkv, A_wo) + _B_ref(xn, B_w_gate, B_w_up, B_w_down)
```

```asm
; @launch kernel=gemm1_kernel grid=(256,1,1) block=(256,1,1) lds=147712
; @launch kernel=k2_kernel grid=(256,1,1) block=(512,1,1) lds=147968
.amdgcn_target "amdgcn-amd-amdhsa--gfx950"
.text
.globl gemm1_kernel
.p2align 8
.type gemm1_kernel,@function
gemm1_kernel:
    s_cmp_ge_u32 s2, 256
    s_cbranch_scc1 L_gemm1_kernel_end
    s_load_dwordx2 s[4:5], s[0:1], 8
    s_load_dwordx2 s[92:93], s[0:1], 48
    s_memrealtime s[94:95]
    s_load_dwordx2 s[78:79], s[0:1], 64
    s_load_dwordx2 s[76:77], s[0:1], 0
    s_load_dwordx4 s[56:59], s[0:1], 32
    s_load_dwordx2 s[6:7], s[0:1], 72
    s_getpc_b64 s[90:91]
L_pc_gemm1_kernelf:
    s_add_u32 s90, s90, L_gemm1_kernel_t0-L_pc_gemm1_kernelf
    s_addc_u32 s91, s91, 0
    v_lshlrev_b32 v13, 7, v0
    v_min_u32 v14, L_text_end-L_gemm1_kernel_t0, v13
    global_load_dword a224, v14, s[90:91]
    v_add_u32 v13, 32768, v13
    v_min_u32 v14, L_text_end-L_gemm1_kernel_t0, v13
    global_load_dword a224, v14, s[90:91]
L_gemm1_kernel_t0:
    v_lshrrev_b32 v13, 6, v0
    v_and_b32 v0, 63, v0
    v_readfirstlane_b32 s52, v13
    s_and_b32 s60, s2, 7
    s_lshr_b32 s61, s2, 3
    s_and_b32 s53, s61, 7
    s_lshr_b32 s61, s61, 3
    s_lshr_b32 s50, s52, 1
    s_and_b32 s51, s52, 1
    s_lshl_b32 s62, s60, 2
    s_add_u32 s62, s62, s61
    s_lshl_b32 s68, s53, 5
    s_add_u32 s68, s68, s62
    s_lshl_b32 s69, s68, 14
    v_and_b32 v17, 7, v0
    v_lshrrev_b32 v18, 3, v0
    v_lshlrev_b32 v20, 11, v17
    v_lshl_add_u32 v20, v18, 4, v20
    s_lshl_b32 s63, s52, 9
    v_add_u32 v20, s63, v20
    s_waitcnt lgkmcnt(0)
    s_mov_b32 s96, s76
    s_mov_b32 s97, s77
    s_mov_b32 s98, 4194304
    s_mov_b32 s99, 0x20000
    buffer_load_dwordx4 v[24:27], v20, s[96:99], s69 offen offset:0
    buffer_load_dwordx4 v[28:31], v20, s[96:99], s69 offen offset:128
    buffer_load_dwordx4 v[32:35], v20, s[96:99], s69 offen offset:256
    buffer_load_dwordx4 v[36:39], v20, s[96:99], s69 offen offset:384
    s_mov_b32 s96, s78
    s_mov_b32 s97, s79
    s_mov_b32 s98, 256
    s_mov_b32 s99, 0x20000
    s_lshl_b32 s55, s62, 7
    s_lshl_b32 s63, s53, 12
    s_add_u32 s55, s55, s63
    s_add_u32 s55, s55, 35655680
    s_or_b32 s94, s94, 1
    s_cmp_lg_u32 s52, 0
    s_cbranch_scc1 L_gemm1_kernel_nn
    v_mov_b32 v80, s94
    v_mov_b32 v81, 0
    v_mov_b32 v84, 0
    s_lshl_b32 s63, s53, 5
    s_mov_b64 exec, 1
    buffer_atomic_cmpswap v[80:81], v84, s[96:99], s63 offen sc0 sc1
    s_mov_b64 exec, -1
L_gemm1_kernel_nn:
    s_mul_i32 s62, s60, 3
    s_add_u32 s63, s62, s61
    s_add_u32 s64, s62, 24
    s_lshl_b32 s65, s63, 1
    s_add_u32 s66, s65, 1
    s_add_u32 s67, s60, 48
    s_cmp_eq_u32 s61, 3
    s_cselect_b32 s44, 1, 0
    s_cselect_b32 s45, s64, s63
    s_cselect_b32 s49, s67, s66
    s_add_u32 s73, s64, 1
    s_add_u32 s74, s64, 2
    s_lshl_b32 s71, s60, 1
    s_add_u32 s63, s71, s61
    s_add_u32 s72, s71, 16
    s_cmp_eq_u32 s61, 2
    s_cselect_b32 s63, s72, s63
    s_add_u32 s64, s71, 17
    s_cmp_eq_u32 s61, 3
    s_cselect_b32 s45, s64, s63
    s_add_u32 s73, s71, 32
    s_add_u32 s74, s71, 33
    s_mov_b32 s70, 6144
    s_cmp_eq_u32 s61, 3
    s_cselect_b32 s46, s73, s65
    s_cselect_b32 s47, s74, s65
    s_cselect_b32 s70, s70, 7168
    s_lshl_b32 s40, s70, 5
    s_mov_b32 s36, 0
    s_mov_b32 s37, 0
    s_mov_b32 s38, 0
    s_mov_b32 s39, 0
    s_lshl_b32 s41, s52, 12
    s_mul_i32 s42, s52, 5120
    s_add_u32 s42, s42, 16384
    v_lshrrev_b32 v13, 3, v0
    v_and_b32 v14, 7, v0
    v_bfe_u32 v15, v0, 4, 1
    v_lshlrev_b32 v15, 2, v15
    v_xor_b32 v14, v14, v15
    v_bfe_u32 v15, v0, 5, 1
    v_lshlrev_b32 v15, 1, v15
    v_xor_b32 v14, v14, v15
    v_lshlrev_b32 v14, 4, v14
    v_and_b32 v15, 3, v13
    v_lshrrev_b32 v13, 2, v13
    v_lshl_add_u32 v13, v13, 3, v15
    s_lshl_b32 s71, s50, 4
    s_lshl_b32 s72, s51, 2
    s_add_u32 s71, s71, s72
    v_add_u32 v13, s71, v13
    s_mov_b32 s72, 6144
    v_mul_lo_u32 v8, v13, s72
    v_mul_lo_u32 v9, v13, s70
    s_mov_b32 s72, 7168
    v_mul_lo_u32 v11, v13, s72
    v_add_u32 v8, v8, v14
    v_add_u32 v9, v9, v14
    v_add_u32 v11, v11, v14
    s_lshl_b32 s72, s45, 7
    s_add_u32 s72, s72, 4096
    v_add_u32 v8, s72, v8
    s_lshl_b32 s72, s47, 7
    s_add_u32 s72, s72, 2048
    v_add_u32 v10, s72, v9
    s_lshl_b32 s72, s46, 7
    s_add_u32 s72, s72, 3072
    v_add_u32 v9, s72, v9
    s_lshl_b32 s72, s49, 7
    s_add_u32 s73, s72, 4096
    v_add_u32 v12, s73, v11
    s_add_u32 s73, s72, 1024
    v_add_u32 v11, s73, v11
    v_lshlrev_b32 v7, 4, v0
    s_lshl_b32 s72, s52, 12
    v_add_u32 v7, s72, v7
    s_waitcnt lgkmcnt(0)
    s_sub_u32 s12, s4, 4096
    s_subb_u32 s13, s5, 0
    s_mov_b32 s14, 6295552
    s_mov_b32 s15, 0x20000
    s_sub_u32 s24, s56, 4096
    s_subb_u32 s25, s57, 0
    s_mov_b32 s26, 7344128
    s_mov_b32 s27, 0x20000
    s_sub_u32 s28, s58, 4096
    s_subb_u32 s29, s59, 0
    s_mov_b32 s30, 7344128
    s_mov_b32 s31, 0x20000
    s_cmp_eq_u32 s44, 1
    s_cselect_b32 s16, s12, s24
    s_cselect_b32 s17, s13, s25
    s_cselect_b32 s18, s14, s26
    s_mov_b32 s19, 0x20000
    s_cselect_b32 s20, s12, s28
    s_cselect_b32 s21, s13, s29
    s_cselect_b32 s22, s14, s26
    s_mov_b32 s23, 0x20000
    s_lshl_b32 s72, s53, 19
    s_add_u32 s8, s6, s72
    s_addc_u32 s9, s7, 0
    s_mov_b32 s10, 524288
    s_mov_b32 s11, 0x20000
    s_mov_b32 s32, s6
    s_mov_b32 s33, s7
    s_mov_b32 s34, 39911424
    s_mov_b32 s35, 0x20000
    s_add_u32 m0, s42, 0
    s_nop 0
    buffer_load_dwordx4 v8, s[12:15], s37 offen nt lds
    s_add_u32 s37, s37, 196608
    buffer_load_dwordx4 v9, s[16:19], s38 offen offset:1024 nt lds
    buffer_load_dwordx4 v10, s[20:23], s38 offen offset:2048 nt lds
    s_add_u32 s38, s38, s40
    buffer_load_dwordx4 v11, s[24:27], s39 offen offset:3072 nt lds
    s_add_u32 m0, s42, 4096
    s_nop 0
    buffer_load_dwordx4 v12, s[28:31], s39 offen nt lds
    s_add_u32 s39, s39, 229376
    s_cmp_ge_u32 s2, 16
    s_cbranch_scc1 L_gemm1_kernel_nz
    s_lshl_b32 s72, s2, 8
    s_add_u32 s72, s72, 35651584
    v_lshlrev_b32 v13, 2, v0
    v_mov_b32 v14, 0
    buffer_store_dword v14, v13, s[32:35], s72 offen
L_gemm1_kernel_nz:
    s_lshr_b32 s72, s68, 5
    s_lshl_b32 s72, s72, 19
    s_bfe_u32 s73, s68, 0x40001
    s_lshl_b32 s73, s73, 10
    s_add_u32 s72, s72, s73
    s_and_b32 s73, s68, 1
    s_lshl_b32 s73, s73, 7
    s_add_u32 s72, s72, s73
    s_lshl_b32 s73, s52, 17
    s_add_u32 s72, s72, s73
    v_lshrrev_b32 v21, 2, v18
    v_lshlrev_b32 v21, 14, v21
    v_and_b32 v22, 3, v18
    v_lshl_add_u32 v21, v22, 8, v21
    v_lshl_add_u32 v21, v17, 4, v21
    v_lshlrev_b32 v22, 4, v17
    v_add_u32 v22, 147456, v22
    s_lshl_b32 s73, s52, 2
    v_add_u32 v23, s73, v22
    s_waitcnt vmcnt(8)
    v_lshlrev_b32 v48, 16, v24
    v_and_b32 v49, 0xffff0000, v24
    v_lshlrev_b32 v50, 16, v25
    v_and_b32 v51, 0xffff0000, v25
    v_lshlrev_b32 v52, 16, v26
    v_and_b32 v53, 0xffff0000, v26
    v_lshlrev_b32 v54, 16, v27
    v_and_b32 v55, 0xffff0000, v27
    s_waitcnt vmcnt(7)
    v_lshlrev_b32 v56, 16, v28
    v_and_b32 v57, 0xffff0000, v28
    v_lshlrev_b32 v58, 16, v29
    v_and_b32 v59, 0xffff0000, v29
    v_lshlrev_b32 v60, 16, v30
    v_and_b32 v61, 0xffff0000, v30
    v_lshlrev_b32 v62, 16, v31
    v_and_b32 v63, 0xffff0000, v31
    s_waitcnt vmcnt(6)
    v_lshlrev_b32 v64, 16, v32
    v_and_b32 v65, 0xffff0000, v32
    v_lshlrev_b32 v66, 16, v33
    v_and_b32 v67, 0xffff0000, v33
    v_lshlrev_b32 v68, 16, v34
    v_and_b32 v69, 0xffff0000, v34
    v_lshlrev_b32 v70, 16, v35
    v_and_b32 v71, 0xffff0000, v35
    s_waitcnt vmcnt(5)
    v_lshlrev_b32 v72, 16, v36
    v_and_b32 v73, 0xffff0000, v36
    v_lshlrev_b32 v74, 16, v37
    v_and_b32 v75, 0xffff0000, v37
    v_lshlrev_b32 v76, 16, v38
    v_and_b32 v77, 0xffff0000, v38
    v_lshlrev_b32 v78, 16, v39
    v_and_b32 v79, 0xffff0000, v39
    v_pk_add_f32 v[40:41], v[48:49], v[50:51]
    v_pk_add_f32 v[42:43], v[52:53], v[54:55]
    v_pk_add_f32 v[40:41], v[40:41], v[56:57]
    v_pk_add_f32 v[42:43], v[42:43], v[58:59]
    v_pk_add_f32 v[40:41], v[40:41], v[60:61]
    v_pk_add_f32 v[42:43], v[42:43], v[62:63]
    v_pk_add_f32 v[40:41], v[40:41], v[64:65]
    v_pk_add_f32 v[42:43], v[42:43], v[66:67]
    v_pk_add_f32 v[40:41], v[40:41], v[68:69]
    v_pk_add_f32 v[42:43], v[42:43], v[70:71]
    v_pk_add_f32 v[40:41], v[40:41], v[72:73]
    v_pk_add_f32 v[42:43], v[42:43], v[74:75]
    v_pk_add_f32 v[40:41], v[40:41], v[76:77]
    v_pk_add_f32 v[42:43], v[42:43], v[78:79]
    v_pk_add_f32 v[40:41], v[40:41], v[42:43]
    v_add_f32 v40, v40, v41
    s_nop 1
    v_add_f32_dpp v40, v40, v40 row_ror:8 row_mask:0xf bank_mask:0xf
    v_mov_b32 v41, v40
    s_nop 1
    v_permlane16_swap_b32 v40, v41
    v_add_f32 v40, v40, v41
    v_mov_b32 v41, v40
    s_nop 1
    v_permlane32_swap_b32 v40, v41
    v_add_f32 v40, v40, v41
    ds_write_b32 v23, v40
    s_waitcnt lgkmcnt(0)
    s_barrier
    ds_read_b128 v[40:43], v22
    s_waitcnt lgkmcnt(0)
    v_add_f32 v40, v40, v41
    v_add_f32 v42, v42, v43
    v_add_f32 v40, v40, v42
    v_mul_f32 v44, 0xba800000, v40
    v_mov_b32 v45, v44
    v_pk_add_f32 v[24:25], v[48:49], v[44:45]
    v_pk_mul_f32 v[40:41], v[24:25], v[24:25]
    v_pk_add_f32 v[26:27], v[50:51], v[44:45]
    v_pk_mul_f32 v[42:43], v[26:27], v[26:27]
    v_pk_add_f32 v[28:29], v[52:53], v[44:45]
    v_pk_fma_f32 v[40:41], v[28:29], v[28:29], v[40:41]
    v_pk_add_f32 v[30:31], v[54:55], v[44:45]
    v_pk_fma_f32 v[42:43], v[30:31], v[30:31], v[42:43]
    v_pk_add_f32 v[24:25], v[56:57], v[44:45]
    v_pk_fma_f32 v[40:41], v[24:25], v[24:25], v[40:41]
    v_pk_add_f32 v[26:27], v[58:59], v[44:45]
    v_pk_fma_f32 v[42:43], v[26:27], v[26:27], v[42:43]
    v_pk_add_f32 v[28:29], v[60:61], v[44:45]
    v_pk_fma_f32 v[40:41], v[28:29], v[28:29], v[40:41]
    v_pk_add_f32 v[30:31], v[62:63], v[44:45]
    v_pk_fma_f32 v[42:43], v[30:31], v[30:31], v[42:43]
    v_pk_add_f32 v[24:25], v[64:65], v[44:45]
    v_pk_fma_f32 v[40:41], v[24:25], v[24:25], v[40:41]
    v_pk_add_f32 v[26:27], v[66:67], v[44:45]
    v_pk_fma_f32 v[42:43], v[26:27], v[26:27], v[42:43]
    v_pk_add_f32 v[28:29], v[68:69], v[44:45]
    v_pk_fma_f32 v[40:41], v[28:29], v[28:29], v[40:41]
    v_pk_add_f32 v[30:31], v[70:71], v[44:45]
    v_pk_fma_f32 v[42:43], v[30:31], v[30:31], v[42:43]
    v_pk_add_f32 v[24:25], v[72:73], v[44:45]
    v_pk_fma_f32 v[40:41], v[24:25], v[24:25], v[40:41]
    v_pk_add_f32 v[26:27], v[74:75], v[44:45]
    v_pk_fma_f32 v[42:43], v[26:27], v[26:27], v[42:43]
    v_pk_add_f32 v[28:29], v[76:77], v[44:45]
    v_pk_fma_f32 v[40:41], v[28:29], v[28:29], v[40:41]
    v_pk_add_f32 v[30:31], v[78:79], v[44:45]
    v_pk_fma_f32 v[42:43], v[30:31], v[30:31], v[42:43]
    v_pk_add_f32 v[40:41], v[40:41], v[42:43]
    v_add_f32 v40, v40, v41
    s_nop 1
    v_add_f32_dpp v40, v40, v40 row_ror:8 row_mask:0xf bank_mask:0xf
    v_mov_b32 v41, v40
    s_nop 1
    v_permlane16_swap_b32 v40, v41
    v_add_f32 v40, v40, v41
    v_mov_b32 v41, v40
    s_nop 1
    v_permlane32_swap_b32 v40, v41
    v_add_f32 v40, v40, v41
    ds_write_b32 v23, v40 offset:128
    v_cvt_pk_bf16_f32 v44, v44, v44
    v_lshlrev_b32 v44, 16, v44
    v_mov_b32 v45, v44
    s_waitcnt lgkmcnt(0)
    s_barrier
    ds_read_b128 v[40:43], v22 offset:128
    v_pk_add_f32 v[48:49], v[48:49], v[44:45]
    v_cvt_pk_bf16_f32 v24, v48, v49
    v_pk_add_f32 v[50:51], v[50:51], v[44:45]
    v_cvt_pk_bf16_f32 v25, v50, v51
    v_pk_add_f32 v[52:53], v[52:53], v[44:45]
    v_cvt_pk_bf16_f32 v26, v52, v53
    v_pk_add_f32 v[54:55], v[54:55], v[44:45]
    v_cvt_pk_bf16_f32 v27, v54, v55
    v_pk_add_f32 v[56:57], v[56:57], v[44:45]
    v_cvt_pk_bf16_f32 v28, v56, v57
    v_pk_add_f32 v[58:59], v[58:59], v[44:45]
    v_cvt_pk_bf16_f32 v29, v58, v59
    v_pk_add_f32 v[60:61], v[60:61], v[44:45]
    v_cvt_pk_bf16_f32 v30, v60, v61
    v_pk_add_f32 v[62:63], v[62:63], v[44:45]
    v_cvt_pk_bf16_f32 v31, v62, v63
    v_pk_add_f32 v[64:65], v[64:65], v[44:45]
    v_cvt_pk_bf16_f32 v32, v64, v65
    v_pk_add_f32 v[66:67], v[66:67], v[44:45]
    v_cvt_pk_bf16_f32 v33, v66, v67
    v_pk_add_f32 v[68:69], v[68:69], v[44:45]
    v_cvt_pk_bf16_f32 v34, v68, v69
    v_pk_add_f32 v[70:71], v[70:71], v[44:45]
    v_cvt_pk_bf16_f32 v35, v70, v71
    v_pk_add_f32 v[72:73], v[72:73], v[44:45]
    v_cvt_pk_bf16_f32 v36, v72, v73
    v_pk_add_f32 v[74:75], v[74:75], v[44:45]
    v_cvt_pk_bf16_f32 v37, v74, v75
    v_pk_add_f32 v[76:77], v[76:77], v[44:45]
    v_cvt_pk_bf16_f32 v38, v76, v77
    v_pk_add_f32 v[78:79], v[78:79], v[44:45]
    v_cvt_pk_bf16_f32 v39, v78, v79
    s_waitcnt lgkmcnt(0)
    v_add_f32 v40, v40, v41
    v_add_f32 v42, v42, v43
    v_add_f32 v40, v40, v42
    v_mul_f32 v40, 0x3a800000, v40
    v_cvt_pk_bf16_f32 v40, v40, v40
    v_lshlrev_b32 v40, 16, v40
    v_add_f32 v40, 0x3727c5ac, v40
    v_cvt_pk_bf16_f32 v40, v40, v40
    v_lshlrev_b32 v40, 16, v40
    v_sqrt_f32 v40, v40
    s_nop 0
    v_cvt_pk_bf16_f32 v40, v40, v40
    v_lshlrev_b32 v40, 16, v40
    v_rcp_f32 v40, v40
    s_nop 0
    v_mov_b32 v41, v40
    v_lshlrev_b32 v48, 16, v24
    v_and_b32 v49, 0xffff0000, v24
    v_lshlrev_b32 v50, 16, v25
    v_and_b32 v51, 0xffff0000, v25
    v_lshlrev_b32 v52, 16, v26
    v_and_b32 v53, 0xffff0000, v26
    v_lshlrev_b32 v54, 16, v27
    v_and_b32 v55, 0xffff0000, v27
    v_pk_mul_f32 v[48:49], v[48:49], v[40:41]
    v_pk_mul_f32 v[50:51], v[50:51], v[40:41]
    v_pk_mul_f32 v[52:53], v[52:53], v[40:41]
    v_pk_mul_f32 v[54:55], v[54:55], v[40:41]
    v_cvt_pk_bf16_f32 v24, v48, v49
    v_cvt_pk_bf16_f32 v25, v50, v51
    v_cvt_pk_bf16_f32 v26, v52, v53
    v_cvt_pk_bf16_f32 v27, v54, v55
    s_add_u32 s73, s72, 0
    buffer_store_dwordx4 v[24:27], v21, s[32:35], s73 offen sc1
    v_lshlrev_b32 v56, 16, v28
    v_and_b32 v57, 0xffff0000, v28
    v_lshlrev_b32 v58, 16, v29
    v_and_b32 v59, 0xffff0000, v29
    v_lshlrev_b32 v60, 16, v30
    v_and_b32 v61, 0xffff0000, v30
    v_lshlrev_b32 v62, 16, v31
    v_and_b32 v63, 0xffff0000, v31
    v_pk_mul_f32 v[56:57], v[56:57], v[40:41]
    v_pk_mul_f32 v[58:59], v[58:59], v[40:41]
    v_pk_mul_f32 v[60:61], v[60:61], v[40:41]
    v_pk_mul_f32 v[62:63], v[62:63], v[40:41]
    v_cvt_pk_bf16_f32 v28, v56, v57
    v_cvt_pk_bf16_f32 v29, v58, v59
    v_cvt_pk_bf16_f32 v30, v60, v61
    v_cvt_pk_bf16_f32 v31, v62, v63
    s_add_u32 s73, s72, 32768
    buffer_store_dwordx4 v[28:31], v21, s[32:35], s73 offen sc1
    v_lshlrev_b32 v64, 16, v32
    v_and_b32 v65, 0xffff0000, v32
    v_lshlrev_b32 v66, 16, v33
    v_and_b32 v67, 0xffff0000, v33
    v_lshlrev_b32 v68, 16, v34
    v_and_b32 v69, 0xffff0000, v34
    v_lshlrev_b32 v70, 16, v35
    v_and_b32 v71, 0xffff0000, v35
    v_pk_mul_f32 v[64:65], v[64:65], v[40:41]
    v_pk_mul_f32 v[66:67], v[66:67], v[40:41]
    v_pk_mul_f32 v[68:69], v[68:69], v[40:41]
    v_pk_mul_f32 v[70:71], v[70:71], v[40:41]
    v_cvt_pk_bf16_f32 v32, v64, v65
    v_cvt_pk_bf16_f32 v33, v66, v67
    v_cvt_pk_bf16_f32 v34, v68, v69
    v_cvt_pk_bf16_f32 v35, v70, v71
    s_add_u32 s73, s72, 65536
    buffer_store_dwordx4 v[32:35], v21, s[32:35], s73 offen sc1
    v_lshlrev_b32 v72, 16, v36
    v_and_b32 v73, 0xffff0000, v36
    v_lshlrev_b32 v74, 16, v37
    v_and_b32 v75, 0xffff0000, v37
    v_lshlrev_b32 v76, 16, v38
    v_and_b32 v77, 0xffff0000, v38
    v_lshlrev_b32 v78, 16, v39
    v_and_b32 v79, 0xffff0000, v39
    v_pk_mul_f32 v[72:73], v[72:73], v[40:41]
    v_pk_mul_f32 v[74:75], v[74:75], v[40:41]
    v_pk_mul_f32 v[76:77], v[76:77], v[40:41]
    v_pk_mul_f32 v[78:79], v[78:79], v[40:41]
    v_cvt_pk_bf16_f32 v36, v72, v73
    v_cvt_pk_bf16_f32 v37, v74, v75
    v_cvt_pk_bf16_f32 v38, v76, v77
    v_cvt_pk_bf16_f32 v39, v78, v79
    s_add_u32 s73, s72, 98304
    buffer_store_dwordx4 v[36:39], v21, s[32:35], s73 offen sc1
    s_add_u32 m0, s42, 36864
    s_nop 0
    buffer_load_dwordx4 v8, s[12:15], s37 offen nt lds
    s_add_u32 s37, s37, 196608
    buffer_load_dwordx4 v9, s[16:19], s38 offen offset:1024 nt lds
    buffer_load_dwordx4 v10, s[20:23], s38 offen offset:2048 nt lds
    s_add_u32 s38, s38, s40
    buffer_load_dwordx4 v11, s[24:27], s39 offen offset:3072 nt lds
    s_add_u32 m0, s42, 40960
    s_nop 0
    buffer_load_dwordx4 v12, s[28:31], s39 offen nt lds
    s_add_u32 s39, s39, 229376
    s_add_u32 m0, s42, 73728
    s_nop 0
    buffer_load_dwordx4 v8, s[12:15], s37 offen nt lds
    s_add_u32 s37, s37, 196608
    buffer_load_dwordx4 v9, s[16:19], s38 offen offset:1024 nt lds
    buffer_load_dwordx4 v10, s[20:23], s38 offen offset:2048 nt lds
    s_add_u32 s38, s38, s40
    buffer_load_dwordx4 v11, s[24:27], s39 offen offset:3072 nt lds
    s_add_u32 m0, s42, 77824
    s_nop 0
    buffer_load_dwordx4 v12, s[28:31], s39 offen nt lds
    s_add_u32 s39, s39, 229376
    v_lshlrev_b32 v1, 4, v0
    s_lshl_b32 s72, s50, 13
    v_add_u32 v1, s72, v1
    v_add_u32 v2, 73728, v1
    v_bfe_u32 v13, v0, 2, 3
    v_lshlrev_b32 v14, 7, v13
    v_lshrrev_b32 v15, 5, v0
    v_mul_u32_u24 v15, 10240, v15
    v_add_u32 v14, v14, v15
    v_and_b32 v15, 3, v0
    v_lshl_add_u32 v14, v15, 3, v14
    v_add_u32 v14, 16384, v14
    v_bfe_u32 v15, v0, 3, 1
    v_lshlrev_b32 v15, 1, v15
    v_bfe_u32 v13, v0, 4, 1
    v_or_b32 v15, v15, v13
    s_lshl_b32 s72, s51, 1
    v_xor_b32 v15, s72, v15
    v_lshl_add_u32 v3, v15, 5, v14
    v_xor_b32 v5, 32, v3
    v_add_u32 v4, 73728, v3
    v_add_u32 v6, 73728, v5
    s_getpc_b64 s[74:75]
L_pc_gemm1_kernel:
    s_add_u32 s74, s74, L_gemm1_kernel_epi-L_pc_gemm1_kernel
    s_addc_u32 s75, s75, 0
    s_lshl_b32 s72, s52, 13
    v_lshlrev_b32 v15, 7, v0
    v_add_u32 v15, s72, v15
    v_min_u32 v15, L_text_end-L_gemm1_kernel_epi, v15
    s_waitcnt vmcnt(10)
    s_barrier
    s_cmp_lg_u32 s52, 0
    s_cbranch_scc1 L_gemm1_kernel_got
    v_readfirstlane_b32 s72, v80
    s_nop 0
    s_cmp_eq_u32 s72, 0
    s_cselect_b32 s94, s94, s72
    v_mov_b32 v80, s94
    v_mov_b32 v84, 0
    s_mov_b64 exec, 1
    buffer_atomic_swap v80, v84, s[32:35], s55 offen sc1
    s_mov_b64 exec, -1
    v_and_b32 v84, 31, v0
    v_lshlrev_b32 v84, 7, v84
    s_lshl_b32 s55, s53, 12
    s_add_u32 s55, s55, 35655680
    s_mov_b32 s78, 0x100000
L_gemm1_kernel_poll:
    v_mov_b32 v82, 0
    s_mov_b32 exec_hi, 0
    buffer_atomic_add v82, v84, s[32:35], s55 offen sc0 sc1
    s_mov_b64 exec, -1
    s_waitcnt vmcnt(0)
    v_cmp_eq_u32 vcc, s94, v82
    s_nop 0
    s_cmp_eq_u32 vcc_lo, -1
    s_cbranch_scc1 L_gemm1_kernel_got
    s_sleep 4
    s_sub_u32 s78, s78, 1
    s_cmp_lg_u32 s78, 0
    s_cbranch_scc1 L_gemm1_kernel_poll
L_gemm1_kernel_got:
    s_barrier
    s_add_u32 m0, s41, 0
    s_nop 0
    buffer_load_dwordx4 v7, s[8:11], s36 offen offset:0 sc1 lds
    buffer_load_dwordx4 v7, s[8:11], s36 offen offset:1024 sc1 lds
    buffer_load_dwordx4 v7, s[8:11], s36 offen offset:2048 sc1 lds
    buffer_load_dwordx4 v7, s[8:11], s36 offen offset:3072 sc1 lds
    s_add_u32 s36, s36, 16384
    s_add_u32 m0, s41, 36864
    s_nop 0
    buffer_load_dwordx4 v7, s[8:11], s36 offen offset:0 sc1 lds
    buffer_load_dwordx4 v7, s[8:11], s36 offen offset:1024 sc1 lds
    buffer_load_dwordx4 v7, s[8:11], s36 offen offset:2048 sc1 lds
    buffer_load_dwordx4 v7, s[8:11], s36 offen offset:3072 sc1 lds
    s_add_u32 s36, s36, 16384
    s_add_u32 m0, s41, 73728
    s_nop 0
    buffer_load_dwordx4 v7, s[8:11], s36 offen offset:0 sc1 lds
    buffer_load_dwordx4 v7, s[8:11], s36 offen offset:1024 sc1 lds
    buffer_load_dwordx4 v7, s[8:11], s36 offen offset:2048 sc1 lds
    buffer_load_dwordx4 v7, s[8:11], s36 offen offset:3072 sc1 lds
    s_add_u32 s36, s36, 16384
    s_mov_b32 s96, s92
    s_mov_b32 s97, s93
    s_mov_b32 s98, 7340032
    s_mov_b32 s99, 0x20000
    s_lshl_b32 s72, s2, 2
    s_add_u32 s72, s72, s52
    s_mul_i32 s72, s72, 1024
    v_lshlrev_b32 v13, 7, v0
    v_add_u32 v13, s72, v13
    v_mov_b32 v14, 0x80000000
    v_cmp_gt_u32 vcc, 8, v0
    s_nop 1
    v_cndmask_b32 v13, v14, v13, vcc
    buffer_load_dword a224, v13, s[96:99], 0 offen
    s_mov_b32 s43, 8
    s_waitcnt vmcnt(9)
    s_barrier
    ds_read_b64_tr_b16 a[144:145], v3 offset:0
    ds_read_b64_tr_b16 a[146:147], v3 offset:5120
    ds_read_b64_tr_b16 a[148:149], v5 offset:0
    ds_read_b64_tr_b16 a[150:151], v5 offset:5120
    ds_read_b64_tr_b16 a[152:153], v3 offset:1024
    ds_read_b64_tr_b16 a[154:155], v3 offset:6144
    ds_read_b128 a[80:83], v1 offset:0
    ds_read_b128 a[84:87], v1 offset:1024
    ds_read_b128 a[88:91], v1 offset:2048
    ds_read_b128 a[92:95], v1 offset:3072
    ds_read_b128 a[96:99], v1 offset:4096
    ds_read_b128 a[100:103], v1 offset:5120
    ds_read_b128 a[104:107], v1 offset:6144
    ds_read_b128 a[108:111], v1 offset:7168
    s_waitcnt lgkmcnt(7)
    v_mfma_f32_16x16x32_bf16 a[0:3], a[144:147], a[80:83], 0
    ds_read_b64_tr_b16 a[156:157], v5 offset:1024
    s_waitcnt lgkmcnt(7)
    v_mfma_f32_16x16x32_bf16 a[8:11], a[144:147], a[84:87], 0
    s_add_u32 m0, s42, 110592
    s_waitcnt lgkmcnt(6)
    v_mfma_f32_16x16x32_bf16 a[16:19], a[144:147], a[88:91], 0
    buffer_load_dwordx4 v8, s[12:15], s37 offen nt lds
    s_waitcnt lgkmcnt(5)
    v_mfma_f32_16x16x32_bf16 a[24:27], a[144:147], a[92:95], 0
    s_waitcnt lgkmcnt(4)
    v_mfma_f32_16x16x32_bf16 a[32:35], a[144:147], a[96:99], 0
    ds_read_b64_tr_b16 a[158:159], v5 offset:6144
    s_waitcnt lgkmcnt(4)
    v_mfma_f32_16x16x32_bf16 a[40:43], a[144:147], a[100:103], 0
    s_waitcnt lgkmcnt(3)
    v_mfma_f32_16x16x32_bf16 a[48:51], a[144:147], a[104:107], 0
    s_waitcnt lgkmcnt(2)
    v_mfma_f32_16x16x32_bf16 a[56:59], a[144:147], a[108:111], 0
    v_mfma_f32_16x16x32_bf16 a[60:63], a[148:151], a[108:111], 0
    ds_read_b64_tr_b16 a[144:145], v3 offset:2048
    v_mfma_f32_16x16x32_bf16 a[52:55], a[148:151], a[104:107], 0
    buffer_load_dwordx4 v9, s[16:19], s38 offen offset:1024 nt lds
    v_mfma_f32_16x16x32_bf16 a[44:47], a[148:151], a[100:103], 0
    s_add_u32 s37, s37, 196608
    v_mfma_f32_16x16x32_bf16 a[36:39], a[148:151], a[96:99], 0
    v_mfma_f32_16x16x32_bf16 a[28:31], a[148:151], a[92:95], 0
    ds_read_b64_tr_b16 a[146:147], v3 offset:7168
    v_mfma_f32_16x16x32_bf16 a[20:23], a[148:151], a[88:91], 0
    v_mfma_f32_16x16x32_bf16 a[12:15], a[148:151], a[84:87], 0
    buffer_load_dwordx4 v10, s[20:23], s38 offen offset:2048 nt lds
    v_mfma_f32_16x16x32_bf16 a[4:7], a[148:151], a[80:83], 0
    s_add_u32 s38, s38, s40
    v_mfma_f32_16x16x32_bf16 v[16:19], a[152:155], a[80:83], 0
    ds_read_b64_tr_b16 a[148:149], v5 offset:2048
    v_mfma_f32_16x16x32_bf16 v[48:51], a[152:155], a[84:87], 0
    v_mfma_f32_16x16x32_bf16 v[80:83], a[152:155], a[88:91], 0
    v_mfma_f32_16x16x32_bf16 v[112:115], a[152:155], a[92:95], 0
    v_mfma_f32_16x16x32_bf16 v[144:147], a[152:155], a[96:99], 0
    ds_read_b64_tr_b16 a[150:151], v5 offset:7168
    v_mfma_f32_16x16x32_bf16 v[176:179], a[152:155], a[100:103], 0
    buffer_load_dwordx4 v11, s[24:27], s39 offen offset:3072 nt lds
    v_mfma_f32_16x16x32_bf16 v[208:211], a[152:155], a[104:107], 0
    s_add_u32 m0, s42, 114688
    v_mfma_f32_16x16x32_bf16 v[240:243], a[152:155], a[108:111], 0
    s_waitcnt lgkmcnt(4)
    v_mfma_f32_16x16x32_bf16 v[244:247], a[156:159], a[108:111], 0
    ds_read_b64_tr_b16 a[152:153], v3 offset:3072
    v_mfma_f32_16x16x32_bf16 v[212:215], a[156:159], a[104:107], 0
    v_mfma_f32_16x16x32_bf16 v[180:183], a[156:159], a[100:103], 0
    buffer_load_dwordx4 v12, s[28:31], s39 offen nt lds
    v_mfma_f32_16x16x32_bf16 v[148:151], a[156:159], a[96:99], 0
    s_add_u32 m0, s41, 110592
    v_mfma_f32_16x16x32_bf16 v[116:119], a[156:159], a[92:95], 0
    ds_read_b64_tr_b16 a[154:155], v3 offset:8192
    v_mfma_f32_16x16x32_bf16 v[84:87], a[156:159], a[88:91], 0
    v_mfma_f32_16x16x32_bf16 v[52:55], a[156:159], a[84:87], 0
    v_mfma_f32_16x16x32_bf16 v[20:23], a[156:159], a[80:83], 0
    s_waitcnt lgkmcnt(4)
    v_mfma_f32_16x16x32_bf16 v[24:27], a[144:147], a[80:83], 0
    ds_read_b64_tr_b16 a[156:157], v5 offset:3072
    v_mfma_f32_16x16x32_bf16 v[56:59], a[144:147], a[84:87], 0
    buffer_load_dwordx4 v7, s[8:11], s36 offen offset:0 sc1 lds
    v_mfma_f32_16x16x32_bf16 v[88:91], a[144:147], a[88:91], 0
    s_add_u32 s39, s39, 229376
    v_mfma_f32_16x16x32_bf16 v[120:123], a[144:147], a[92:95], 0
    v_mfma_f32_16x16x32_bf16 v[152:155], a[144:147], a[96:99], 0
    ds_read_b64_tr_b16 a[158:159], v5 offset:8192
    v_mfma_f32_16x16x32_bf16 v[184:187], a[144:147], a[100:103], 0
    v_mfma_f32_16x16x32_bf16 v[216:219], a[144:147], a[104:107], 0
    buffer_load_dwordx4 v7, s[8:11], s36 offen offset:1024 sc1 lds
    v_mfma_f32_16x16x32_bf16 v[248:251], a[144:147], a[108:111], 0
    s_waitcnt lgkmcnt(4)
    v_mfma_f32_16x16x32_bf16 v[252:255], a[148:151], a[108:111], 0
    ds_read_b64_tr_b16 a[144:145], v3 offset:4096
    v_mfma_f32_16x16x32_bf16 v[220:223], a[148:151], a[104:107], 0
    v_mfma_f32_16x16x32_bf16 v[188:191], a[148:151], a[100:103], 0
    v_mfma_f32_16x16x32_bf16 v[156:159], a[148:151], a[96:99], 0
    v_mfma_f32_16x16x32_bf16 v[124:127], a[148:151], a[92:95], 0
    ds_read_b64_tr_b16 a[146:147], v3 offset:9216
    v_mfma_f32_16x16x32_bf16 v[92:95], a[148:151], a[88:91], 0
    buffer_load_dwordx4 v7, s[8:11], s36 offen offset:2048 sc1 lds
    v_mfma_f32_16x16x32_bf16 v[60:63], a[148:151], a[84:87], 0
    v_mfma_f32_16x16x32_bf16 v[28:31], a[148:151], a[80:83], 0
    s_waitcnt lgkmcnt(4)
    v_mfma_f32_16x16x32_bf16 v[32:35], a[152:155], a[80:83], 0
    ds_read_b64_tr_b16 a[148:149], v5 offset:4096
    v_mfma_f32_16x16x32_bf16 v[64:67], a[152:155], a[84:87], 0
    v_mfma_f32_16x16x32_bf16 v[96:99], a[152:155], a[88:91], 0
    buffer_load_dwordx4 v7, s[8:11], s36 offen offset:3072 sc1 lds
    v_mfma_f32_16x16x32_bf16 v[128:131], a[152:155], a[92:95], 0
    s_add_u32 s36, s36, 16384
    v_mfma_f32_16x16x32_bf16 v[160:163], a[152:155], a[96:99], 0
    ds_read_b64_tr_b16 a[150:151], v5 offset:9216
    v_mfma_f32_16x16x32_bf16 v[192:195], a[152:155], a[100:103], 0
    v_mfma_f32_16x16x32_bf16 v[224:227], a[152:155], a[104:107], 0
    v_mfma_f32_16x16x32_bf16 a[64:67], a[152:155], a[108:111], 0
    s_waitcnt lgkmcnt(4)
    v_mfma_f32_16x16x32_bf16 a[68:71], a[156:159], a[108:111], 0
    s_waitcnt vmcnt(14)
    v_mfma_f32_16x16x32_bf16 v[228:231], a[156:159], a[104:107], 0
    s_waitcnt lgkmcnt(0)
    v_mfma_f32_16x16x32_bf16 v[196:199], a[156:159], a[100:103], 0
    s_barrier
    v_mfma_f32_16x16x32_bf16 v[164:167], a[156:159], a[96:99], 0
    ds_read_b64_tr_b16 a[152:153], v3 offset:36864
    v_mfma_f32_16x16x32_bf16 v[132:135], a[156:159], a[92:95], 0
    ds_read_b64_tr_b16 a[154:155], v3 offset:41984
    v_mfma_f32_16x16x32_bf16 v[100:103], a[156:159], a[88:91], 0
    ds_read_b128 a[112:115], v1 offset:36864
    v_mfma_f32_16x16x32_bf16 v[68:71], a[156:159], a[84:87], 0
    ds_read_b128 a[116:119], v1 offset:37888
    v_mfma_f32_16x16x32_bf16 v[36:39], a[156:159], a[80:83], 0
    ds_read_b128 a[120:123], v1 offset:38912
    v_mfma_f32_16x16x32_bf16 v[40:43], a[144:147], a[80:83], 0
    ds_read_b64_tr_b16 a[156:157], v5 offset:36864
    v_mfma_f32_16x16x32_bf16 v[72:75], a[144:147], a[84:87], 0
    ds_read_b128 a[124:127], v1 offset:39936
    v_mfma_f32_16x16x32_bf16 v[104:107], a[144:147], a[88:91], 0
    ds_read_b128 a[128:131], v1 offset:40960
    v_mfma_f32_16x16x32_bf16 v[136:139], a[144:147], a[92:95], 0
    ds_read_b128 a[132:135], v1 offset:41984
    v_mfma_f32_16x16x32_bf16 v[168:171], a[144:147], a[96:99], 0
    ds_read_b64_tr_b16 a[158:159], v5 offset:41984
    v_mfma_f32_16x16x32_bf16 v[200:203], a[144:147], a[100:103], 0
    ds_read_b128 a[136:139], v1 offset:43008
    v_mfma_f32_16x16x32_bf16 v[232:235], a[144:147], a[104:107], 0
    ds_read_b128 a[140:143], v1 offset:44032
    v_mfma_f32_16x16x32_bf16 a[72:75], a[144:147], a[108:111], 0
    v_mfma_f32_16x16x32_bf16 a[76:79], a[148:151], a[108:111], 0
    ds_read_b64_tr_b16 a[144:145], v3 offset:37888
    v_mfma_f32_16x16x32_bf16 v[236:239], a[148:151], a[104:107], 0
    v_mfma_f32_16x16x32_bf16 v[204:207], a[148:151], a[100:103], 0
    v_mfma_f32_16x16x32_bf16 v[172:175], a[148:151], a[96:99], 0
    v_mfma_f32_16x16x32_bf16 v[140:143], a[148:151], a[92:95], 0
    ds_read_b64_tr_b16 a[146:147], v3 offset:43008
    v_mfma_f32_16x16x32_bf16 v[108:111], a[148:151], a[88:91], 0
    v_mfma_f32_16x16x32_bf16 v[76:79], a[148:151], a[84:87], 0
    s_waitcnt lgkmcnt(2)
    v_mfma_f32_16x16x32_bf16 v[44:47], a[148:151], a[80:83], 0
    s_branch L_gemm1_kernel_s1
L_gemm1_kernel_loop:
    v_mfma_f32_16x16x32_bf16 a[0:3], a[144:147], a[80:83], a[0:3]
    ds_read_b64_tr_b16 a[156:157], v5 offset:1024
    v_mfma_f32_16x16x32_bf16 a[8:11], a[144:147], a[84:87], a[8:11]
    s_add_u32 m0, s42, 110592
    v_mfma_f32_16x16x32_bf16 a[16:19], a[144:147], a[88:91], a[16:19]
    buffer_load_dwordx4 v8, s[12:15], s37 offen nt lds
    v_mfma_f32_16x16x32_bf16 a[24:27], a[144:147], a[92:95], a[24:27]
    v_mfma_f32_16x16x32_bf16 a[32:35], a[144:147], a[96:99], a[32:35]
    ds_read_b64_tr_b16 a[158:159], v5 offset:6144
    v_mfma_f32_16x16x32_bf16 a[40:43], a[144:147], a[100:103], a[40:43]
    v_mfma_f32_16x16x32_bf16 a[48:51], a[144:147], a[104:107], a[48:51]
    v_mfma_f32_16x16x32_bf16 a[56:59], a[144:147], a[108:111], a[56:59]
    v_mfma_f32_16x16x32_bf16 a[60:63], a[148:151], a[108:111], a[60:63]
    ds_read_b64_tr_b16 a[144:145], v3 offset:2048
    v_mfma_f32_16x16x32_bf16 a[52:55], a[148:151], a[104:107], a[52:55]
    buffer_load_dwordx4 v9, s[16:19], s38 offen offset:1024 nt lds
    v_mfma_f32_16x16x32_bf16 a[44:47], a[148:151], a[100:103], a[44:47]
    s_add_u32 s37, s37, 196608
    v_mfma_f32_16x16x32_bf16 a[36:39], a[148:151], a[96:99], a[36:39]
    v_mfma_f32_16x16x32_bf16 a[28:31], a[148:151], a[92:95], a[28:31]
    ds_read_b64_tr_b16 a[146:147], v3 offset:7168
    v_mfma_f32_16x16x32_bf16 a[20:23], a[148:151], a[88:91], a[20:23]
    v_mfma_f32_16x16x32_bf16 a[12:15], a[148:151], a[84:87], a[12:15]
    buffer_load_dwordx4 v10, s[20:23], s38 offen offset:2048 nt lds
    v_mfma_f32_16x16x32_bf16 a[4:7], a[148:151], a[80:83], a[4:7]
    s_add_u32 s38, s38, s40
    s_waitcnt lgkmcnt(4)
    v_mfma_f32_16x16x32_bf16 v[16:19], a[152:155], a[80:83], v[16:19]
    ds_read_b64_tr_b16 a[148:149], v5 offset:2048
    v_mfma_f32_16x16x32_bf16 v[48:51], a[152:155], a[84:87], v[48:51]
    v_mfma_f32_16x16x32_bf16 v[80:83], a[152:155], a[88:91], v[80:83]
    v_mfma_f32_16x16x32_bf16 v[112:115], a[152:155], a[92:95], v[112:115]
    v_mfma_f32_16x16x32_bf16 v[144:147], a[152:155], a[96:99], v[144:147]
    ds_read_b64_tr_b16 a[150:151], v5 offset:7168
    v_mfma_f32_16x16x32_bf16 v[176:179], a[152:155], a[100:103], v[176:179]
    buffer_load_dwordx4 v11, s[24:27], s39 offen offset:3072 nt lds
    v_mfma_f32_16x16x32_bf16 v[208:211], a[152:155], a[104:107], v[208:211]
    s_add_u32 m0, s42, 114688
    v_mfma_f32_16x16x32_bf16 v[240:243], a[152:155], a[108:111], v[240:243]
    s_waitcnt lgkmcnt(4)
    v_mfma_f32_16x16x32_bf16 v[244:247], a[156:159], a[108:111], v[244:247]
    ds_read_b64_tr_b16 a[152:153], v3 offset:3072
    v_mfma_f32_16x16x32_bf16 v[212:215], a[156:159], a[104:107], v[212:215]
    v_mfma_f32_16x16x32_bf16 v[180:183], a[156:159], a[100:103], v[180:183]
    buffer_load_dwordx4 v12, s[28:31], s39 offen nt lds
    v_mfma_f32_16x16x32_bf16 v[148:151], a[156:159], a[96:99], v[148:151]
    s_add_u32 m0, s41, 110592
    v_mfma_f32_16x16x32_bf16 v[116:119], a[156:159], a[92:95], v[116:119]
    ds_read_b64_tr_b16 a[154:155], v3 offset:8192
    v_mfma_f32_16x16x32_bf16 v[84:87], a[156:159], a[88:91], v[84:87]
    v_mfma_f32_16x16x32_bf16 v[52:55], a[156:159], a[84:87], v[52:55]
    v_mfma_f32_16x16x32_bf16 v[20:23], a[156:159], a[80:83], v[20:23]
    s_waitcnt lgkmcnt(4)
    v_mfma_f32_16x16x32_bf16 v[24:27], a[144:147], a[80:83], v[24:27]
    ds_read_b64_tr_b16 a[156:157], v5 offset:3072
    v_mfma_f32_16x16x32_bf16 v[56:59], a[144:147], a[84:87], v[56:59]
    buffer_load_dwordx4 v7, s[8:11], s36 offen offset:0 sc1 lds
    v_mfma_f32_16x16x32_bf16 v[88:91], a[144:147], a[88:91], v[88:91]
    s_add_u32 s39, s39, 229376
    v_mfma_f32_16x16x32_bf16 v[120:123], a[144:147], a[92:95], v[120:123]
    v_mfma_f32_16x16x32_bf16 v[152:155], a[144:147], a[96:99], v[152:155]
    ds_read_b64_tr_b16 a[158:159], v5 offset:8192
    v_mfma_f32_16x16x32_bf16 v[184:187], a[144:147], a[100:103], v[184:187]
    v_mfma_f32_16x16x32_bf16 v[216:219], a[144:147], a[104:107], v[216:219]
    buffer_load_dwordx4 v7, s[8:11], s36 offen offset:1024 sc1 lds
    v_mfma_f32_16x16x32_bf16 v[248:251], a[144:147], a[108:111], v[248:251]
    s_waitcnt lgkmcnt(4)
    v_mfma_f32_16x16x32_bf16 v[252:255], a[148:151], a[108:111], v[252:255]
    ds_read_b64_tr_b16 a[144:145], v3 offset:4096
    v_mfma_f32_16x16x32_bf16 v[220:223], a[148:151], a[104:107], v[220:223]
    v_mfma_f32_16x16x32_bf16 v[188:191], a[148:151], a[100:103], v[188:191]
    v_mfma_f32_16x16x32_bf16 v[156:159], a[148:151], a[96:99], v[156:159]
    v_mfma_f32_16x16x32_bf16 v[124:127], a[148:151], a[92:95], v[124:127]
    ds_read_b64_tr_b16 a[146:147], v3 offset:9216
    s_cmp_lg_u32 s43, 1
    s_cbranch_scc1 L_g1_notouch
    global_load_dword a224, v15, s[74:75]
L_g1_notouch:
    v_mfma_f32_16x16x32_bf16 v[92:95], a[148:151], a[88:91], v[92:95]
    buffer_load_dwordx4 v7, s[8:11], s36 offen offset:2048 sc1 lds
    v_mfma_f32_16x16x32_bf16 v[60:63], a[148:151], a[84:87], v[60:63]
    v_mfma_f32_16x16x32_bf16 v[28:31], a[148:151], a[80:83], v[28:31]
    s_waitcnt lgkmcnt(4)
    v_mfma_f32_16x16x32_bf16 v[32:35], a[152:155], a[80:83], v[32:35]
    ds_read_b64_tr_b16 a[148:149], v5 offset:4096
    v_mfma_f32_16x16x32_bf16 v[64:67], a[152:155], a[84:87], v[64:67]
    v_mfma_f32_16x16x32_bf16 v[96:99], a[152:155], a[88:91], v[96:99]
    buffer_load_dwordx4 v7, s[8:11], s36 offen offset:3072 sc1 lds
    v_mfma_f32_16x16x32_bf16 v[128:131], a[152:155], a[92:95], v[128:131]
    s_add_u32 s36, s36, 16384
    v_mfma_f32_16x16x32_bf16 v[160:163], a[152:155], a[96:99], v[160:163]
    ds_read_b64_tr_b16 a[150:151], v5 offset:9216
    v_mfma_f32_16x16x32_bf16 v[192:195], a[152:155], a[100:103], v[192:195]
    v_mfma_f32_16x16x32_bf16 v[224:227], a[152:155], a[104:107], v[224:227]
    v_mfma_f32_16x16x32_bf16 a[64:67], a[152:155], a[108:111], a[64:67]
    s_waitcnt lgkmcnt(4)
    v_mfma_f32_16x16x32_bf16 a[68:71], a[156:159], a[108:111], a[68:71]
    s_waitcnt vmcnt(18)
    v_mfma_f32_16x16x32_bf16 v[228:231], a[156:159], a[104:107], v[228:231]
    s_waitcnt lgkmcnt(0)
    v_mfma_f32_16x16x32_bf16 v[196:199], a[156:159], a[100:103], v[196:199]
    s_barrier
    v_mfma_f32_16x16x32_bf16 v[164:167], a[156:159], a[96:99], v[164:167]
    ds_read_b64_tr_b16 a[152:153], v3 offset:36864
    v_mfma_f32_16x16x32_bf16 v[132:135], a[156:159], a[92:95], v[132:135]
    ds_read_b64_tr_b16 a[154:155], v3 offset:41984
    v_mfma_f32_16x16x32_bf16 v[100:103], a[156:159], a[88:91], v[100:103]
    ds_read_b128 a[112:115], v1 offset:36864
    v_mfma_f32_16x16x32_bf16 v[68:71], a[156:159], a[84:87], v[68:71]
    ds_read_b128 a[116:119], v1 offset:37888
    v_mfma_f32_16x16x32_bf16 v[36:39], a[156:159], a[80:83], v[36:39]
    ds_read_b128 a[120:123], v1 offset:38912
    v_mfma_f32_16x16x32_bf16 v[40:43], a[144:147], a[80:83], v[40:43]
    ds_read_b64_tr_b16 a[156:157], v5 offset:36864
    v_mfma_f32_16x16x32_bf16 v[72:75], a[144:147], a[84:87], v[72:75]
    ds_read_b128 a[124:127], v1 offset:39936
    v_mfma_f32_16x16x32_bf16 v[104:107], a[144:147], a[88:91], v[104:107]
    ds_read_b128 a[128:131], v1 offset:40960
    v_mfma_f32_16x16x32_bf16 v[136:139], a[144:147], a[92:95], v[136:139]
    ds_read_b128 a[132:135], v1 offset:41984
    v_mfma_f32_16x16x32_bf16 v[168:171], a[144:147], a[96:99], v[168:171]
    ds_read_b64_tr_b16 a[158:159], v5 offset:41984
    v_mfma_f32_16x16x32_bf16 v[200:203], a[144:147], a[100:103], v[200:203]
    ds_read_b128 a[136:139], v1 offset:43008
    v_mfma_f32_16x16x32_bf16 v[232:235], a[144:147], a[104:107], v[232:235]
    ds_read_b128 a[140:143], v1 offset:44032
    v_mfma_f32_16x16x32_bf16 a[72:75], a[144:147], a[108:111], a[72:75]
    v_mfma_f32_16x16x32_bf16 a[76:79], a[148:151], a[108:111], a[76:79]
    ds_read_b64_tr_b16 a[144:145], v3 offset:37888
    v_mfma_f32_16x16x32_bf16 v[236:239], a[148:151], a[104:107], v[236:239]
    v_mfma_f32_16x16x32_bf16 v[204:207], a[148:151], a[100:103], v[204:207]
    v_mfma_f32_16x16x32_bf16 v[172:175], a[148:151], a[96:99], v[172:175]
    v_mfma_f32_16x16x32_bf16 v[140:143], a[148:151], a[92:95], v[140:143]
    ds_read_b64_tr_b16 a[146:147], v3 offset:43008
    v_mfma_f32_16x16x32_bf16 v[108:111], a[148:151], a[88:91], v[108:111]
    v_mfma_f32_16x16x32_bf16 v[76:79], a[148:151], a[84:87], v[76:79]
    s_waitcnt lgkmcnt(2)
    v_mfma_f32_16x16x32_bf16 v[44:47], a[148:151], a[80:83], v[44:47]
L_gemm1_kernel_s1:
    v_mfma_f32_16x16x32_bf16 a[0:3], a[152:155], a[112:115], a[0:3]
    ds_read_b64_tr_b16 a[148:149], v5 offset:37888
    v_mfma_f32_16x16x32_bf16 a[8:11], a[152:155], a[116:119], a[8:11]
    s_add_u32 m0, s42, 0
    v_mfma_f32_16x16x32_bf16 a[16:19], a[152:155], a[120:123], a[16:19]
    buffer_load_dwordx4 v8, s[12:15], s37 offen nt lds
    v_mfma_f32_16x16x32_bf16 a[24:27], a[152:155], a[124:127], a[24:27]
    v_mfma_f32_16x16x32_bf16 a[32:35], a[152:155], a[128:131], a[32:35]
    ds_read_b64_tr_b16 a[150:151], v5 offset:43008
    v_mfma_f32_16x16x32_bf16 a[40:43], a[152:155], a[132:135], a[40:43]
    v_mfma_f32_16x16x32_bf16 a[48:51], a[152:155], a[136:139], a[48:51]
    v_mfma_f32_16x16x32_bf16 a[56:59], a[152:155], a[140:143], a[56:59]
    v_mfma_f32_16x16x32_bf16 a[60:63], a[156:159], a[140:143], a[60:63]
    ds_read_b64_tr_b16 a[152:153], v3 offset:38912
    v_mfma_f32_16x16x32_bf16 a[52:55], a[156:159], a[136:139], a[52:55]
    buffer_load_dwordx4 v9, s[16:19], s38 offen offset:1024 nt lds
    v_mfma_f32_16x16x32_bf16 a[44:47], a[156:159], a[132:135], a[44:47]
    s_add_u32 s37, s37, 196608
    v_mfma_f32_16x16x32_bf16 a[36:39], a[156:159], a[128:131], a[36:39]
    v_mfma_f32_16x16x32_bf16 a[28:31], a[156:159], a[124:127], a[28:31]
    ds_read_b64_tr_b16 a[154:155], v3 offset:44032
    v_mfma_f32_16x16x32_bf16 a[20:23], a[156:159], a[120:123], a[20:23]
    v_mfma_f32_16x16x32_bf16 a[12:15], a[156:159], a[116:119], a[12:15]
    buffer_load_dwordx4 v10, s[20:23], s38 offen offset:2048 nt lds
    v_mfma_f32_16x16x32_bf16 a[4:7], a[156:159], a[112:115], a[4:7]
    s_add_u32 s38, s38, s40
    s_waitcnt lgkmcnt(4)
    v_mfma_f32_16x16x32_bf16 v[16:19], a[144:147], a[112:115], v[16:19]
    ds_read_b64_tr_b16 a[156:157], v5 offset:38912
    v_mfma_f32_16x16x32_bf16 v[48:51], a[144:147], a[116:119], v[48:51]
    v_mfma_f32_16x16x32_bf16 v[80:83], a[144:147], a[120:123], v[80:83]
    v_mfma_f32_16x16x32_bf16 v[112:115], a[144:147], a[124:127], v[112:115]
    v_mfma_f32_16x16x32_bf16 v[144:147], a[144:147], a[128:131], v[144:147]
    ds_read_b64_tr_b16 a[158:159], v5 offset:44032
    v_mfma_f32_16x16x32_bf16 v[176:179], a[144:147], a[132:135], v[176:179]
    buffer_load_dwordx4 v11, s[24:27], s39 offen offset:3072 nt lds
    v_mfma_f32_16x16x32_bf16 v[208:211], a[144:147], a[136:139], v[208:211]
    s_add_u32 m0, s42, 4096
    v_mfma_f32_16x16x32_bf16 v[240:243], a[144:147], a[140:143], v[240:243]
    s_waitcnt lgkmcnt(4)
    v_mfma_f32_16x16x32_bf16 v[244:247], a[148:151], a[140:143], v[244:247]
    ds_read_b64_tr_b16 a[144:145], v3 offset:39936
    v_mfma_f32_16x16x32_bf16 v[212:215], a[148:151], a[136:139], v[212:215]
    v_mfma_f32_16x16x32_bf16 v[180:183], a[148:151], a[132:135], v[180:183]
    buffer_load_dwordx4 v12, s[28:31], s39 offen nt lds
    v_mfma_f32_16x16x32_bf16 v[148:151], a[148:151], a[128:131], v[148:151]
    s_add_u32 m0, s41, 0
    v_mfma_f32_16x16x32_bf16 v[116:119], a[148:151], a[124:127], v[116:119]
    ds_read_b64_tr_b16 a[146:147], v3 offset:45056
    v_mfma_f32_16x16x32_bf16 v[84:87], a[148:151], a[120:123], v[84:87]
    v_mfma_f32_16x16x32_bf16 v[52:55], a[148:151], a[116:119], v[52:55]
    v_mfma_f32_16x16x32_bf16 v[20:23], a[148:151], a[112:115], v[20:23]
    s_waitcnt lgkmcnt(4)
    v_mfma_f32_16x16x32_bf16 v[24:27], a[152:155], a[112:115], v[24:27]
    ds_read_b64_tr_b16 a[148:149], v5 offset:39936
    v_mfma_f32_16x16x32_bf16 v[56:59], a[152:155], a[116:119], v[56:59]
    buffer_load_dwordx4 v7, s[8:11], s36 offen offset:0 sc1 lds
    v_mfma_f32_16x16x32_bf16 v[88:91], a[152:155], a[120:123], v[88:91]
    s_add_u32 s39, s39, 229376
    v_mfma_f32_16x16x32_bf16 v[120:123], a[152:155], a[124:127], v[120:123]
    v_mfma_f32_16x16x32_bf16 v[152:155], a[152:155], a[128:131], v[152:155]
    ds_read_b64_tr_b16 a[150:151], v5 offset:45056
    v_mfma_f32_16x16x32_bf16 v[184:187], a[152:155], a[132:135], v[184:187]
    v_mfma_f32_16x16x32_bf16 v[216:219], a[152:155], a[136:139], v[216:219]
    buffer_load_dwordx4 v7, s[8:11], s36 offen offset:1024 sc1 lds
    v_mfma_f32_16x16x32_bf16 v[248:251], a[152:155], a[140:143], v[248:251]
    s_waitcnt lgkmcnt(4)
    v_mfma_f32_16x16x32_bf16 v[252:255], a[156:159], a[140:143], v[252:255]
    ds_read_b64_tr_b16 a[152:153], v3 offset:40960
    v_mfma_f32_16x16x32_bf16 v[220:223], a[156:159], a[136:139], v[220:223]
    v_mfma_f32_16x16x32_bf16 v[188:191], a[156:159], a[132:135], v[188:191]
    v_mfma_f32_16x16x32_bf16 v[156:159], a[156:159], a[128:131], v[156:159]
    v_mfma_f32_16x16x32_bf16 v[124:127], a[156:159], a[124:127], v[124:127]
    ds_read_b64_tr_b16 a[154:155], v3 offset:46080
    v_mfma_f32_16x16x32_bf16 v[92:95], a[156:159], a[120:123], v[92:95]
    buffer_load_dwordx4 v7, s[8:11], s36 offen offset:2048 sc1 lds
    v_mfma_f32_16x16x32_bf16 v[60:63], a[156:159], a[116:119], v[60:63]
    v_mfma_f32_16x16x32_bf16 v[28:31], a[156:159], a[112:115], v[28:31]
    s_waitcnt lgkmcnt(4)
    v_mfma_f32_16x16x32_bf16 v[32:35], a[144:147], a[112:115], v[32:35]
    ds_read_b64_tr_b16 a[156:157], v5 offset:40960
    v_mfma_f32_16x16x32_bf16 v[64:67], a[144:147], a[116:119], v[64:67]
    v_mfma_f32_16x16x32_bf16 v[96:99], a[144:147], a[120:123], v[96:99]
    buffer_load_dwordx4 v7, s[8:11], s36 offen offset:3072 sc1 lds
    v_mfma_f32_16x16x32_bf16 v[128:131], a[144:147], a[124:127], v[128:131]
    s_add_u32 s36, s36, 16384
    v_mfma_f32_16x16x32_bf16 v[160:163], a[144:147], a[128:131], v[160:163]
    ds_read_b64_tr_b16 a[158:159], v5 offset:46080
    v_mfma_f32_16x16x32_bf16 v[192:195], a[144:147], a[132:135], v[192:195]
    v_mfma_f32_16x16x32_bf16 v[224:227], a[144:147], a[136:139], v[224:227]
    v_mfma_f32_16x16x32_bf16 a[64:67], a[144:147], a[140:143], a[64:67]
    s_waitcnt lgkmcnt(4)
    v_mfma_f32_16x16x32_bf16 a[68:71], a[148:151], a[140:143], a[68:71]
    s_waitcnt vmcnt(18)
    v_mfma_f32_16x16x32_bf16 v[228:231], a[148:151], a[136:139], v[228:231]
    s_waitcnt lgkmcnt(0)
    v_mfma_f32_16x16x32_bf16 v[196:199], a[148:151], a[132:135], v[196:199]
    s_barrier
    v_mfma_f32_16x16x32_bf16 v[164:167], a[148:151], a[128:131], v[164:167]
    ds_read_b64_tr_b16 a[144:145], v4 offset:0
    v_mfma_f32_16x16x32_bf16 v[132:135], a[148:151], a[124:127], v[132:135]
    ds_read_b64_tr_b16 a[146:147], v4 offset:5120
    v_mfma_f32_16x16x32_bf16 v[100:103], a[148:151], a[120:123], v[100:103]
    ds_read_b128 a[80:83], v2 offset:0
    v_mfma_f32_16x16x32_bf16 v[68:71], a[148:151], a[116:119], v[68:71]
    ds_read_b128 a[84:87], v2 offset:1024
    v_mfma_f32_16x16x32_bf16 v[36:39], a[148:151], a[112:115], v[36:39]
    ds_read_b128 a[88:91], v2 offset:2048
    v_mfma_f32_16x16x32_bf16 v[40:43], a[152:155], a[112:115], v[40:43]
    ds_read_b64_tr_b16 a[148:149], v6 offset:0
    v_mfma_f32_16x16x32_bf16 v[72:75], a[152:155], a[116:119], v[72:75]
    ds_read_b128 a[92:95], v2 offset:3072
    v_mfma_f32_16x16x32_bf16 v[104:107], a[152:155], a[120:123], v[104:107]
    ds_read_b128 a[96:99], v2 offset:4096
    v_mfma_f32_16x16x32_bf16 v[136:139], a[152:155], a[124:127], v[136:139]
    ds_read_b128 a[100:103], v2 offset:5120
    v_mfma_f32_16x16x32_bf16 v[168:171], a[152:155], a[128:131], v[168:171]
    ds_read_b64_tr_b16 a[150:151], v6 offset:5120
    v_mfma_f32_16x16x32_bf16 v[200:203], a[152:155], a[132:135], v[200:203]
    ds_read_b128 a[104:107], v2 offset:6144
    v_mfma_f32_16x16x32_bf16 v[232:235], a[152:155], a[136:139], v[232:235]
    ds_read_b128 a[108:111], v2 offset:7168
    v_mfma_f32_16x16x32_bf16 a[72:75], a[152:155], a[140:143], a[72:75]
    v_mfma_f32_16x16x32_bf16 a[76:79], a[156:159], a[140:143], a[76:79]
    ds_read_b64_tr_b16 a[152:153], v4 offset:1024
    v_mfma_f32_16x16x32_bf16 v[236:239], a[156:159], a[136:139], v[236:239]
    v_mfma_f32_16x16x32_bf16 v[204:207], a[156:159], a[132:135], v[204:207]
    v_mfma_f32_16x16x32_bf16 v[172:175], a[156:159], a[128:131], v[172:175]
    v_mfma_f32_16x16x32_bf16 v[140:143], a[156:159], a[124:127], v[140:143]
    ds_read_b64_tr_b16 a[154:155], v4 offset:6144
    v_mfma_f32_16x16x32_bf16 v[108:111], a[156:159], a[120:123], v[108:111]
    v_mfma_f32_16x16x32_bf16 v[76:79], a[156:159], a[116:119], v[76:79]
    s_waitcnt lgkmcnt(2)
    v_mfma_f32_16x16x32_bf16 v[44:47], a[156:159], a[112:115], v[44:47]
    s_cmp_eq_u32 s43, 1
    s_cbranch_scc1 L_gemm1_kernel_epi
    v_mfma_f32_16x16x32_bf16 a[0:3], a[144:147], a[80:83], a[0:3]
    ds_read_b64_tr_b16 a[156:157], v6 offset:1024
    v_mfma_f32_16x16x32_bf16 a[8:11], a[144:147], a[84:87], a[8:11]
    s_add_u32 m0, s42, 36864
    v_mfma_f32_16x16x32_bf16 a[16:19], a[144:147], a[88:91], a[16:19]
    buffer_load_dwordx4 v8, s[12:15], s37 offen nt lds
    v_mfma_f32_16x16x32_bf16 a[24:27], a[144:147], a[92:95], a[24:27]
    v_mfma_f32_16x16x32_bf16 a[32:35], a[144:147], a[96:99], a[32:35]
    ds_read_b64_tr_b16 a[158:159], v6 offset:6144
    v_mfma_f32_16x16x32_bf16 a[40:43], a[144:147], a[100:103], a[40:43]
    v_mfma_f32_16x16x32_bf16 a[48:51], a[144:147], a[104:107], a[48:51]
    v_mfma_f32_16x16x32_bf16 a[56:59], a[144:147], a[108:111], a[56:59]
    v_mfma_f32_16x16x32_bf16 a[60:63], a[148:151], a[108:111], a[60:63]
    ds_read_b64_tr_b16 a[144:145], v4 offset:2048
    v_mfma_f32_16x16x32_bf16 a[52:55], a[148:151], a[104:107], a[52:55]
    buffer_load_dwordx4 v9, s[16:19], s38 offen offset:1024 nt lds
    v_mfma_f32_16x16x32_bf16 a[44:47], a[148:151], a[100:103], a[44:47]
    s_add_u32 s37, s37, 196608
    v_mfma_f32_16x16x32_bf16 a[36:39], a[148:151], a[96:99], a[36:39]
    v_mfma_f32_16x16x32_bf16 a[28:31], a[148:151], a[92:95], a[28:31]
    ds_read_b64_tr_b16 a[146:147], v4 offset:7168
    v_mfma_f32_16x16x32_bf16 a[20:23], a[148:151], a[88:91], a[20:23]
    v_mfma_f32_16x16x32_bf16 a[12:15], a[148:151], a[84:87], a[12:15]
    buffer_load_dwordx4 v10, s[20:23], s38 offen offset:2048 nt lds
    v_mfma_f32_16x16x32_bf16 a[4:7], a[148:151], a[80:83], a[4:7]
    s_add_u32 s38, s38, s40
    s_waitcnt lgkmcnt(4)
    v_mfma_f32_16x16x32_bf16 v[16:19], a[152:155], a[80:83], v[16:19]
    ds_read_b64_tr_b16 a[148:149], v6 offset:2048
    v_mfma_f32_16x16x32_bf16 v[48:51], a[152:155], a[84:87], v[48:51]
    v_mfma_f32_16x16x32_bf16 v[80:83], a[152:155], a[88:91], v[80:83]
    v_mfma_f32_16x16x32_bf16 v[112:115], a[152:155], a[92:95], v[112:115]
    v_mfma_f32_16x16x32_bf16 v[144:147], a[152:155], a[96:99], v[144:147]
    ds_read_b64_tr_b16 a[150:151], v6 offset:7168
    v_mfma_f32_16x16x32_bf16 v[176:179], a[152:155], a[100:103], v[176:179]
    buffer_load_dwordx4 v11, s[24:27], s39 offen offset:3072 nt lds
    v_mfma_f32_16x16x32_bf16 v[208:211], a[152:155], a[104:107], v[208:211]
    s_add_u32 m0, s42, 40960
    v_mfma_f32_16x16x32_bf16 v[240:243], a[152:155], a[108:111], v[240:243]
    s_waitcnt lgkmcnt(4)
    v_mfma_f32_16x16x32_bf16 v[244:247], a[156:159], a[108:111], v[244:247]
    ds_read_b64_tr_b16 a[152:153], v4 offset:3072
    v_mfma_f32_16x16x32_bf16 v[212:215], a[156:159], a[104:107], v[212:215]
    v_mfma_f32_16x16x32_bf16 v[180:183], a[156:159], a[100:103], v[180:183]
    buffer_load_dwordx4 v12, s[28:31], s39 offen nt lds
    v_mfma_f32_16x16x32_bf16 v[148:151], a[156:159], a[96:99], v[148:151]
    s_add_u32 m0, s41, 36864
    v_mfma_f32_16x16x32_bf16 v[116:119], a[156:159], a[92:95], v[116:119]
    ds_read_b64_tr_b16 a[154:155], v4 offset:8192
    v_mfma_f32_16x16x32_bf16 v[84:87], a[156:159], a[88:91], v[84:87]
    v_mfma_f32_16x16x32_bf16 v[52:55], a[156:159], a[84:87], v[52:55]
    v_mfma_f32_16x16x32_bf16 v[20:23], a[156:159], a[80:83], v[20:23]
    s_waitcnt lgkmcnt(4)
    v_mfma_f32_16x16x32_bf16 v[24:27], a[144:147], a[80:83], v[24:27]
    ds_read_b64_tr_b16 a[156:157], v6 offset:3072
    v_mfma_f32_16x16x32_bf16 v[56:59], a[144:147], a[84:87], v[56:59]
    buffer_load_dwordx4 v7, s[8:11], s36 offen offset:0 sc1 lds
    v_mfma_f32_16x16x32_bf16 v[88:91], a[144:147], a[88:91], v[88:91]
    s_add_u32 s39, s39, 229376
    v_mfma_f32_16x16x32_bf16 v[120:123], a[144:147], a[92:95], v[120:123]
    v_mfma_f32_16x16x32_bf16 v[152:155], a[144:147], a[96:99], v[152:155]
    ds_read_b64_tr_b16 a[158:159], v6 offset:8192
    v_mfma_f32_16x16x32_bf16 v[184:187], a[144:147], a[100:103], v[184:187]
    v_mfma_f32_16x16x32_bf16 v[216:219], a[144:147], a[104:107], v[216:219]
    buffer_load_dwordx4 v7, s[8:11], s36 offen offset:1024 sc1 lds
    v_mfma_f32_16x16x32_bf16 v[248:251], a[144:147], a[108:111], v[248:251]
    s_waitcnt lgkmcnt(4)
    v_mfma_f32_16x16x32_bf16 v[252:255], a[148:151], a[108:111], v[252:255]
    ds_read_b64_tr_b16 a[144:145], v4 offset:4096
    v_mfma_f32_16x16x32_bf16 v[220:223], a[148:151], a[104:107], v[220:223]
    v_mfma_f32_16x16x32_bf16 v[188:191], a[148:151], a[100:103], v[188:191]
    v_mfma_f32_16x16x32_bf16 v[156:159], a[148:151], a[96:99], v[156:159]
    v_mfma_f32_16x16x32_bf16 v[124:127], a[148:151], a[92:95], v[124:127]
    ds_read_b64_tr_b16 a[146:147], v4 offset:9216
    v_mfma_f32_16x16x32_bf16 v[92:95], a[148:151], a[88:91], v[92:95]
    buffer_load_dwordx4 v7, s[8:11], s36 offen offset:2048 sc1 lds
    v_mfma_f32_16x16x32_bf16 v[60:63], a[148:151], a[84:87], v[60:63]
    v_mfma_f32_16x16x32_bf16 v[28:31], a[148:151], a[80:83], v[28:31]
    s_waitcnt lgkmcnt(4)
    v_mfma_f32_16x16x32_bf16 v[32:35], a[152:155], a[80:83], v[32:35]
    ds_read_b64_tr_b16 a[148:149], v6 offset:4096
    v_mfma_f32_16x16x32_bf16 v[64:67], a[152:155], a[84:87], v[64:67]
    v_mfma_f32_16x16x32_bf16 v[96:99], a[152:155], a[88:91], v[96:99]
    buffer_load_dwordx4 v7, s[8:11], s36 offen offset:3072 sc1 lds
    v_mfma_f32_16x16x32_bf16 v[128:131], a[152:155], a[92:95], v[128:131]
    s_add_u32 s36, s36, 16384
    v_mfma_f32_16x16x32_bf16 v[160:163], a[152:155], a[96:99], v[160:163]
    ds_read_b64_tr_b16 a[150:151], v6 offset:9216
    v_mfma_f32_16x16x32_bf16 v[192:195], a[152:155], a[100:103], v[192:195]
    v_mfma_f32_16x16x32_bf16 v[224:227], a[152:155], a[104:107], v[224:227]
    v_mfma_f32_16x16x32_bf16 a[64:67], a[152:155], a[108:111], a[64:67]
    s_waitcnt lgkmcnt(4)
    v_mfma_f32_16x16x32_bf16 a[68:71], a[156:159], a[108:111], a[68:71]
    s_waitcnt vmcnt(18)
    v_mfma_f32_16x16x32_bf16 v[228:231], a[156:159], a[104:107], v[228:231]
    s_waitcnt lgkmcnt(0)
    v_mfma_f32_16x16x32_bf16 v[196:199], a[156:159], a[100:103], v[196:199]
    s_barrier
    v_mfma_f32_16x16x32_bf16 v[164:167], a[156:159], a[96:99], v[164:167]
    ds_read_b64_tr_b16 a[152:153], v4 offset:36864
    v_mfma_f32_16x16x32_bf16 v[132:135], a[156:159], a[92:95], v[132:135]
    ds_read_b64_tr_b16 a[154:155], v4 offset:41984
    v_mfma_f32_16x16x32_bf16 v[100:103], a[156:159], a[88:91], v[100:103]
    ds_read_b128 a[112:115], v2 offset:36864
    v_mfma_f32_16x16x32_bf16 v[68:71], a[156:159], a[84:87], v[68:71]
    ds_read_b128 a[116:119], v2 offset:37888
    v_mfma_f32_16x16x32_bf16 v[36:39], a[156:159], a[80:83], v[36:39]
    ds_read_b128 a[120:123], v2 offset:38912
    v_mfma_f32_16x16x32_bf16 v[40:43], a[144:147], a[80:83], v[40:43]
    ds_read_b64_tr_b16 a[156:157], v6 offset:36864
    v_mfma_f32_16x16x32_bf16 v[72:75], a[144:147], a[84:87], v[72:75]
    ds_read_b128 a[124:127], v2 offset:39936
    v_mfma_f32_16x16x32_bf16 v[104:107], a[144:147], a[88:91], v[104:107]
    ds_read_b128 a[128:131], v2 offset:40960
    v_mfma_f32_16x16x32_bf16 v[136:139], a[144:147], a[92:95], v[136:139]
    ds_read_b128 a[132:135], v2 offset:41984
    v_mfma_f32_16x16x32_bf16 v[168:171], a[144:147], a[96:99], v[168:171]
    ds_read_b64_tr_b16 a[158:159], v6 offset:41984
    v_mfma_f32_16x16x32_bf16 v[200:203], a[144:147], a[100:103], v[200:203]
    ds_read_b128 a[136:139], v2 offset:43008
    v_mfma_f32_16x16x32_bf16 v[232:235], a[144:147], a[104:107], v[232:235]
    ds_read_b128 a[140:143], v2 offset:44032
    v_mfma_f32_16x16x32_bf16 a[72:75], a[144:147], a[108:111], a[72:75]
    v_mfma_f32_16x16x32_bf16 a[76:79], a[148:151], a[108:111], a[76:79]
    ds_read_b64_tr_b16 a[144:145], v4 offset:37888
    v_mfma_f32_16x16x32_bf16 v[236:239], a[148:151], a[104:107], v[236:239]
    v_mfma_f32_16x16x32_bf16 v[204:207], a[148:151], a[100:103], v[204:207]
    v_mfma_f32_16x16x32_bf16 v[172:175], a[148:151], a[96:99], v[172:175]
    v_mfma_f32_16x16x32_bf16 v[140:143], a[148:151], a[92:95], v[140:143]
    ds_read_b64_tr_b16 a[146:147], v4 offset:43008
    v_mfma_f32_16x16x32_bf16 v[108:111], a[148:151], a[88:91], v[108:111]
    v_mfma_f32_16x16x32_bf16 v[76:79], a[148:151], a[84:87], v[76:79]
    s_waitcnt lgkmcnt(2)
    v_mfma_f32_16x16x32_bf16 v[44:47], a[148:151], a[80:83], v[44:47]
    v_mfma_f32_16x16x32_bf16 a[0:3], a[152:155], a[112:115], a[0:3]
    ds_read_b64_tr_b16 a[148:149], v6 offset:37888
    v_mfma_f32_16x16x32_bf16 a[8:11], a[152:155], a[116:119], a[8:11]
    s_add_u32 m0, s42, 73728
    v_mfma_f32_16x16x32_bf16 a[16:19], a[152:155], a[120:123], a[16:19]
    buffer_load_dwordx4 v8, s[12:15], s37 offen nt lds
    v_mfma_f32_16x16x32_bf16 a[24:27], a[152:155], a[124:127], a[24:27]
    v_mfma_f32_16x16x32_bf16 a[32:35], a[152:155], a[128:131], a[32:35]
    ds_read_b64_tr_b16 a[150:151], v6 offset:43008
    v_mfma_f32_16x16x32_bf16 a[40:43], a[152:155], a[132:135], a[40:43]
    v_mfma_f32_16x16x32_bf16 a[48:51], a[152:155], a[136:139], a[48:51]
    v_mfma_f32_16x16x32_bf16 a[56:59], a[152:155], a[140:143], a[56:59]
    v_mfma_f32_16x16x32_bf16 a[60:63], a[156:159], a[140:143], a[60:63]
    ds_read_b64_tr_b16 a[152:153], v4 offset:38912
    v_mfma_f32_16x16x32_bf16 a[52:55], a[156:159], a[136:139], a[52:55]
    buffer_load_dwordx4 v9, s[16:19], s38 offen offset:1024 nt lds
    v_mfma_f32_16x16x32_bf16 a[44:47], a[156:159], a[132:135], a[44:47]
    s_add_u32 s37, s37, 196608
    v_mfma_f32_16x16x32_bf16 a[36:39], a[156:159], a[128:131], a[36:39]
    v_mfma_f32_16x16x32_bf16 a[28:31], a[156:159], a[124:127], a[28:31]
    ds_read_b64_tr_b16 a[154:155], v4 offset:44032
    v_mfma_f32_16x16x32_bf16 a[20:23], a[156:159], a[120:123], a[20:23]
    v_mfma_f32_16x16x32_bf16 a[12:15], a[156:159], a[116:119], a[12:15]
    buffer_load_dwordx4 v10, s[20:23], s38 offen offset:2048 nt lds
    v_mfma_f32_16x16x32_bf16 a[4:7], a[156:159], a[112:115], a[4:7]
    s_add_u32 s38, s38, s40
    s_waitcnt lgkmcnt(4)
    v_mfma_f32_16x16x32_bf16 v[16:19], a[144:147], a[112:115], v[16:19]
    ds_read_b64_tr_b16 a[156:157], v6 offset:38912
    v_mfma_f32_16x16x32_bf16 v[48:51], a[144:147], a[116:119], v[48:51]
    v_mfma_f32_16x16x32_bf16 v[80:83], a[144:147], a[120:123], v[80:83]
    v_mfma_f32_16x16x32_bf16 v[112:115], a[144:147], a[124:127], v[112:115]
    v_mfma_f32_16x16x32_bf16 v[144:147], a[144:147], a[128:131], v[144:147]
    ds_read_b64_tr_b16 a[158:159], v6 offset:44032
    v_mfma_f32_16x16x32_bf16 v[176:179], a[144:147], a[132:135], v[176:179]
    buffer_load_dwordx4 v11, s[24:27], s39 offen offset:3072 nt lds
    v_mfma_f32_16x16x32_bf16 v[208:211], a[144:147], a[136:139], v[208:211]
    s_add_u32 m0, s42, 77824
    v_mfma_f32_16x16x32_bf16 v[240:243], a[144:147], a[140:143], v[240:243]
    s_waitcnt lgkmcnt(4)
    v_mfma_f32_16x16x32_bf16 v[244:247], a[148:151], a[140:143], v[244:247]
    ds_read_b64_tr_b16 a[144:145], v4 offset:39936
    v_mfma_f32_16x16x32_bf16 v[212:215], a[148:151], a[136:139], v[212:215]
    v_mfma_f32_16x16x32_bf16 v[180:183], a[148:151], a[132:135], v[180:183]
    buffer_load_dwordx4 v12, s[28:31], s39 offen nt lds
    v_mfma_f32_16x16x32_bf16 v[148:151], a[148:151], a[128:131], v[148:151]
    s_add_u32 m0, s41, 73728
    v_mfma_f32_16x16x32_bf16 v[116:119], a[148:151], a[124:127], v[116:119]
    ds_read_b64_tr_b16 a[146:147], v4 offset:45056
    v_mfma_f32_16x16x32_bf16 v[84:87], a[148:151], a[120:123], v[84:87]
    v_mfma_f32_16x16x32_bf16 v[52:55], a[148:151], a[116:119], v[52:55]
    v_mfma_f32_16x16x32_bf16 v[20:23], a[148:151], a[112:115], v[20:23]
    s_waitcnt lgkmcnt(4)
    v_mfma_f32_16x16x32_bf16 v[24:27], a[152:155], a[112:115], v[24:27]
    ds_read_b64_tr_b16 a[148:149], v6 offset:39936
    v_mfma_f32_16x16x32_bf16 v[56:59], a[152:155], a[116:119], v[56:59]
    buffer_load_dwordx4 v7, s[8:11], s36 offen offset:0 sc1 lds
    v_mfma_f32_16x16x32_bf16 v[88:91], a[152:155], a[120:123], v[88:91]
    s_add_u32 s39, s39, 229376
    v_mfma_f32_16x16x32_bf16 v[120:123], a[152:155], a[124:127], v[120:123]
    v_mfma_f32_16x16x32_bf16 v[152:155], a[152:155], a[128:131], v[152:155]
    ds_read_b64_tr_b16 a[150:151], v6 offset:45056
    v_mfma_f32_16x16x32_bf16 v[184:187], a[152:155], a[132:135], v[184:187]
    v_mfma_f32_16x16x32_bf16 v[216:219], a[152:155], a[136:139], v[216:219]
    buffer_load_dwordx4 v7, s[8:11], s36 offen offset:1024 sc1 lds
    v_mfma_f32_16x16x32_bf16 v[248:251], a[152:155], a[140:143], v[248:251]
    s_waitcnt lgkmcnt(4)
    v_mfma_f32_16x16x32_bf16 v[252:255], a[156:159], a[140:143], v[252:255]
    ds_read_b64_tr_b16 a[152:153], v4 offset:40960
    v_mfma_f32_16x16x32_bf16 v[220:223], a[156:159], a[136:139], v[220:223]
    v_mfma_f32_16x16x32_bf16 v[188:191], a[156:159], a[132:135], v[188:191]
    v_mfma_f32_16x16x32_bf16 v[156:159], a[156:159], a[128:131], v[156:159]
    v_mfma_f32_16x16x32_bf16 v[124:127], a[156:159], a[124:127], v[124:127]
    ds_read_b64_tr_b16 a[154:155], v4 offset:46080
    v_mfma_f32_16x16x32_bf16 v[92:95], a[156:159], a[120:123], v[92:95]
    buffer_load_dwordx4 v7, s[8:11], s36 offen offset:2048 sc1 lds
    v_mfma_f32_16x16x32_bf16 v[60:63], a[156:159], a[116:119], v[60:63]
    v_mfma_f32_16x16x32_bf16 v[28:31], a[156:159], a[112:115], v[28:31]
    s_waitcnt lgkmcnt(4)
    v_mfma_f32_16x16x32_bf16 v[32:35], a[144:147], a[112:115], v[32:35]
    ds_read_b64_tr_b16 a[156:157], v6 offset:40960
    v_mfma_f32_16x16x32_bf16 v[64:67], a[144:147], a[116:119], v[64:67]
    v_mfma_f32_16x16x32_bf16 v[96:99], a[144:147], a[120:123], v[96:99]
    buffer_load_dwordx4 v7, s[8:11], s36 offen offset:3072 sc1 lds
    v_mfma_f32_16x16x32_bf16 v[128:131], a[144:147], a[124:127], v[128:131]
    s_add_u32 s36, s36, 16384
    v_mfma_f32_16x16x32_bf16 v[160:163], a[144:147], a[128:131], v[160:163]
    ds_read_b64_tr_b16 a[158:159], v6 offset:46080
    v_mfma_f32_16x16x32_bf16 v[192:195], a[144:147], a[132:135], v[192:195]
    v_mfma_f32_16x16x32_bf16 v[224:227], a[144:147], a[136:139], v[224:227]
    v_mfma_f32_16x16x32_bf16 a[64:67], a[144:147], a[140:143], a[64:67]
    s_waitcnt lgkmcnt(4)
    v_mfma_f32_16x16x32_bf16 a[68:71], a[148:151], a[140:143], a[68:71]
    s_waitcnt vmcnt(18)
    v_mfma_f32_16x16x32_bf16 v[228:231], a[148:151], a[136:139], v[228:231]
    s_waitcnt lgkmcnt(0)
    v_mfma_f32_16x16x32_bf16 v[196:199], a[148:151], a[132:135], v[196:199]
    s_barrier
    v_mfma_f32_16x16x32_bf16 v[164:167], a[148:151], a[128:131], v[164:167]
    ds_read_b64_tr_b16 a[144:145], v3 offset:0
    v_mfma_f32_16x16x32_bf16 v[132:135], a[148:151], a[124:127], v[132:135]
    ds_read_b64_tr_b16 a[146:147], v3 offset:5120
    v_mfma_f32_16x16x32_bf16 v[100:103], a[148:151], a[120:123], v[100:103]
    ds_read_b128 a[80:83], v1 offset:0
    v_mfma_f32_16x16x32_bf16 v[68:71], a[148:151], a[116:119], v[68:71]
    ds_read_b128 a[84:87], v1 offset:1024
    v_mfma_f32_16x16x32_bf16 v[36:39], a[148:151], a[112:115], v[36:39]
    ds_read_b128 a[88:91], v1 offset:2048
    v_mfma_f32_16x16x32_bf16 v[40:43], a[152:155], a[112:115], v[40:43]
    ds_read_b64_tr_b16 a[148:149], v5 offset:0
    v_mfma_f32_16x16x32_bf16 v[72:75], a[152:155], a[116:119], v[72:75]
    ds_read_b128 a[92:95], v1 offset:3072
    v_mfma_f32_16x16x32_bf16 v[104:107], a[152:155], a[120:123], v[104:107]
    ds_read_b128 a[96:99], v1 offset:4096
    v_mfma_f32_16x16x32_bf16 v[136:139], a[152:155], a[124:127], v[136:139]
    ds_read_b128 a[100:103], v1 offset:5120
    v_mfma_f32_16x16x32_bf16 v[168:171], a[152:155], a[128:131], v[168:171]
    ds_read_b64_tr_b16 a[150:151], v5 offset:5120
    v_mfma_f32_16x16x32_bf16 v[200:203], a[152:155], a[132:135], v[200:203]
    ds_read_b128 a[104:107], v1 offset:6144
    v_mfma_f32_16x16x32_bf16 v[232:235], a[152:155], a[136:139], v[232:235]
    ds_read_b128 a[108:111], v1 offset:7168
    v_mfma_f32_16x16x32_bf16 a[72:75], a[152:155], a[140:143], a[72:75]
    v_mfma_f32_16x16x32_bf16 a[76:79], a[156:159], a[140:143], a[76:79]
    ds_read_b64_tr_b16 a[152:153], v3 offset:1024
    v_mfma_f32_16x16x32_bf16 v[236:239], a[156:159], a[136:139], v[236:239]
    v_mfma_f32_16x16x32_bf16 v[204:207], a[156:159], a[132:135], v[204:207]
    v_mfma_f32_16x16x32_bf16 v[172:175], a[156:159], a[128:131], v[172:175]
    v_mfma_f32_16x16x32_bf16 v[140:143], a[156:159], a[124:127], v[140:143]
    ds_read_b64_tr_b16 a[154:155], v3 offset:6144
    v_mfma_f32_16x16x32_bf16 v[108:111], a[156:159], a[120:123], v[108:111]
    v_mfma_f32_16x16x32_bf16 v[76:79], a[156:159], a[116:119], v[76:79]
    s_waitcnt lgkmcnt(2)
    v_mfma_f32_16x16x32_bf16 v[44:47], a[156:159], a[112:115], v[44:47]
    s_sub_u32 s43, s43, 1
    s_branch L_gemm1_kernel_loop
L_gemm1_kernel_epi:
    s_cmp_eq_u32 s44, 1
    s_cbranch_scc1 L_gemm1_kernel_B
    v_mfma_f32_16x16x32_bf16 a[0:3], a[144:147], a[80:83], a[0:3]
    ds_read_b64_tr_b16 a[156:157], v6 offset:1024
    v_mfma_f32_16x16x32_bf16 a[8:11], a[144:147], a[84:87], a[8:11]
    v_mfma_f32_16x16x32_bf16 a[16:19], a[144:147], a[88:91], a[16:19]
    v_mfma_f32_16x16x32_bf16 a[24:27], a[144:147], a[92:95], a[24:27]
    v_mfma_f32_16x16x32_bf16 a[32:35], a[144:147], a[96:99], a[32:35]
    ds_read_b64_tr_b16 a[158:159], v6 offset:6144
    v_mfma_f32_16x16x32_bf16 a[40:43], a[144:147], a[100:103], a[40:43]
    v_mfma_f32_16x16x32_bf16 a[48:51], a[144:147], a[104:107], a[48:51]
    v_mfma_f32_16x16x32_bf16 a[56:59], a[144:147], a[108:111], a[56:59]
    v_mfma_f32_16x16x32_bf16 a[60:63], a[148:151], a[108:111], a[60:63]
    ds_read_b64_tr_b16 a[144:145], v4 offset:2048
    v_mfma_f32_16x16x32_bf16 a[52:55], a[148:151], a[104:107], a[52:55]
    v_mfma_f32_16x16x32_bf16 a[44:47], a[148:151], a[100:103], a[44:47]
    v_mfma_f32_16x16x32_bf16 a[36:39], a[148:151], a[96:99], a[36:39]
    v_mfma_f32_16x16x32_bf16 a[28:31], a[148:151], a[92:95], a[28:31]
    ds_read_b64_tr_b16 a[146:147], v4 offset:7168
    v_mfma_f32_16x16x32_bf16 a[20:23], a[148:151], a[88:91], a[20:23]
    v_mfma_f32_16x16x32_bf16 a[12:15], a[148:151], a[84:87], a[12:15]
    v_mfma_f32_16x16x32_bf16 a[4:7], a[148:151], a[80:83], a[4:7]
    s_waitcnt lgkmcnt(4)
    v_mfma_f32_16x16x32_bf16 v[16:19], a[152:155], a[80:83], v[16:19]
    ds_read_b64_tr_b16 a[148:149], v6 offset:2048
    v_mfma_f32_16x16x32_bf16 v[48:51], a[152:155], a[84:87], v[48:51]
    v_mfma_f32_16x16x32_bf16 v[80:83], a[152:155], a[88:91], v[80:83]
    v_mfma_f32_16x16x32_bf16 v[112:115], a[152:155], a[92:95], v[112:115]
    v_mfma_f32_16x16x32_bf16 v[144:147], a[152:155], a[96:99], v[144:147]
    ds_read_b64_tr_b16 a[150:151], v6 offset:7168
    v_mfma_f32_16x16x32_bf16 v[176:179], a[152:155], a[100:103], v[176:179]
    s_waitcnt vmcnt(9)
    v_mfma_f32_16x16x32_bf16 v[208:211], a[152:155], a[104:107], v[208:211]
    s_barrier
    v_mfma_f32_16x16x32_bf16 v[240:243], a[152:155], a[108:111], v[240:243]
    s_waitcnt lgkmcnt(4)
    v_mfma_f32_16x16x32_bf16 v[244:247], a[156:159], a[108:111], v[244:247]
    ds_read_b64_tr_b16 a[152:153], v4 offset:37888
    v_mfma_f32_16x16x32_bf16 v[212:215], a[156:159], a[104:107], v[212:215]
    ds_read_b128 a[112:115], v2 offset:36864
    v_mfma_f32_16x16x32_bf16 v[180:183], a[156:159], a[100:103], v[180:183]
    ds_read_b128 a[116:119], v2 offset:37888
    v_mfma_f32_16x16x32_bf16 v[148:151], a[156:159], a[96:99], v[148:151]
    ds_read_b128 a[120:123], v2 offset:38912
    v_mfma_f32_16x16x32_bf16 v[116:119], a[156:159], a[92:95], v[116:119]
    ds_read_b64_tr_b16 a[154:155], v4 offset:43008
    v_mfma_f32_16x16x32_bf16 v[84:87], a[156:159], a[88:91], v[84:87]
    ds_read_b128 a[124:127], v2 offset:39936
    v_mfma_f32_16x16x32_bf16 v[52:55], a[156:159], a[84:87], v[52:55]
    ds_read_b128 a[128:131], v2 offset:40960
    v_mfma_f32_16x16x32_bf16 v[20:23], a[156:159], a[80:83], v[20:23]
    ds_read_b128 a[132:135], v2 offset:41984
    s_waitcnt lgkmcnt(10)
    v_mfma_f32_16x16x32_bf16 v[24:27], a[144:147], a[80:83], v[24:27]
    ds_read_b64_tr_b16 a[156:157], v6 offset:37888
    v_mfma_f32_16x16x32_bf16 v[56:59], a[144:147], a[84:87], v[56:59]
    ds_read_b128 a[136:139], v2 offset:43008
    v_mfma_f32_16x16x32_bf16 v[88:91], a[144:147], a[88:91], v[88:91]
    ds_read_b128 a[140:143], v2 offset:44032
    v_mfma_f32_16x16x32_bf16 v[120:123], a[144:147], a[92:95], v[120:123]
    v_mfma_f32_16x16x32_bf16 v[152:155], a[144:147], a[96:99], v[152:155]
    ds_read_b64_tr_b16 a[158:159], v6 offset:43008
    v_lshlrev_b32 v1, 4, v0
    v_lshrrev_b32 v2, 4, v0
    v_mfma_f32_16x16x32_bf16 v[184:187], a[144:147], a[100:103], v[184:187]
    v_lshlrev_b32 v2, 6, v2
    s_lshl_b32 s67, s53, 4
    v_mfma_f32_16x16x32_bf16 v[216:219], a[144:147], a[104:107], v[216:219]
    s_lshl_b32 s66, s50, 3
    s_add_u32 s67, s67, s66
    v_mfma_f32_16x16x32_bf16 v[248:251], a[144:147], a[108:111], v[248:251]
    s_lshl_b32 s67, s67, 10
    s_add_u32 s67, s67, 4194304
    s_waitcnt lgkmcnt(12)
    v_mfma_f32_16x16x32_bf16 v[252:255], a[148:151], a[108:111], v[252:255]
    ds_read_b64_tr_b16 a[144:145], v4 offset:38912
    s_lshl_b32 s68, s53, 1
    s_add_u32 s68, s68, s50
    v_mfma_f32_16x16x32_bf16 v[220:223], a[148:151], a[104:107], v[220:223]
    s_mul_i32 s68, s68, 1179648
    s_add_u32 s68, s68, 16777216
    v_mfma_f32_16x16x32_bf16 v[188:191], a[148:151], a[100:103], v[188:191]
    s_mov_b32 s64, 3216550459
    s_mov_b32 s65, s64
    v_mfma_f32_16x16x32_bf16 v[156:159], a[148:151], a[96:99], v[156:159]
    s_lshl_b32 s66, s45, 1
    s_add_u32 s66, s66, s51
    v_mfma_f32_16x16x32_bf16 v[124:127], a[148:151], a[92:95], v[124:127]
    ds_read_b64_tr_b16 a[146:147], v4 offset:44032
    s_mul_i32 s66, s66, 131072
    s_add_u32 s69, s66, s67
    v_mfma_f32_16x16x32_bf16 v[92:95], a[148:151], a[88:91], v[92:95]
    s_lshl_b32 s66, s49, 1
    s_add_u32 s66, s66, s51
    v_mfma_f32_16x16x32_bf16 v[60:63], a[148:151], a[84:87], v[60:63]
    s_mul_i32 s66, s66, 8192
    s_add_u32 s62, s66, s68
    v_mfma_f32_16x16x32_bf16 v[28:31], a[148:151], a[80:83], v[28:31]
    s_cmp_lt_u32 s45, 16
    s_cselect_b32 s60, 1048744942, 1.0
    s_waitcnt lgkmcnt(9)
    v_mfma_f32_16x16x32_bf16 v[16:19], a[152:155], a[112:115], v[16:19]
    ds_read_b64_tr_b16 a[148:149], v6 offset:38912
    s_mov_b32 s61, s60
    v_xor_b32 v3, v2, v1
    v_mfma_f32_16x16x32_bf16 v[48:51], a[152:155], a[116:119], v[48:51]
    s_lshl_b32 s66, s46, 1
    s_add_u32 s66, s66, s51
    v_mfma_f32_16x16x32_bf16 v[80:83], a[152:155], a[120:123], v[80:83]
    s_mul_i32 s66, s66, 8192
    s_add_u32 s70, s66, s68
    s_waitcnt lgkmcnt(9)
    v_mfma_f32_16x16x32_bf16 v[112:115], a[152:155], a[124:127], v[112:115]
    s_waitcnt lgkmcnt(8)
    v_mfma_f32_16x16x32_bf16 v[144:147], a[152:155], a[128:131], v[144:147]
    ds_read_b64_tr_b16 a[150:151], v6 offset:44032
    s_waitcnt lgkmcnt(8)
    v_mfma_f32_16x16x32_bf16 v[176:179], a[152:155], a[132:135], v[176:179]
    s_waitcnt lgkmcnt(6)
    v_mfma_f32_16x16x32_bf16 v[208:211], a[152:155], a[136:139], v[208:211]
    s_waitcnt lgkmcnt(5)
    v_mfma_f32_16x16x32_bf16 v[240:243], a[152:155], a[140:143], v[240:243]
    s_waitcnt lgkmcnt(4)
    v_mfma_f32_16x16x32_bf16 v[244:247], a[156:159], a[140:143], v[244:247]
    ds_read_b64_tr_b16 a[152:153], v4 offset:36864
    v_mfma_f32_16x16x32_bf16 v[212:215], a[156:159], a[136:139], v[212:215]
    v_mfma_f32_16x16x32_bf16 v[180:183], a[156:159], a[132:135], v[180:183]
    v_mfma_f32_16x16x32_bf16 v[148:151], a[156:159], a[128:131], v[148:151]
    v_mfma_f32_16x16x32_bf16 v[116:119], a[156:159], a[124:127], v[116:119]
    ds_read_b64_tr_b16 a[154:155], v4 offset:41984
    v_mfma_f32_16x16x32_bf16 v[84:87], a[156:159], a[120:123], v[84:87]
    v_mfma_f32_16x16x32_bf16 v[52:55], a[156:159], a[116:119], v[52:55]
    v_mfma_f32_16x16x32_bf16 v[20:23], a[156:159], a[112:115], v[20:23]
    s_waitcnt lgkmcnt(4)
    v_mfma_f32_16x16x32_bf16 v[24:27], a[144:147], a[112:115], v[24:27]
    ds_read_b64_tr_b16 a[156:157], v6 offset:36864
    v_mfma_f32_16x16x32_bf16 v[56:59], a[144:147], a[116:119], v[56:59]
    v_mfma_f32_16x16x32_bf16 v[88:91], a[144:147], a[120:123], v[88:91]
    v_mfma_f32_16x16x32_bf16 v[120:123], a[144:147], a[124:127], v[120:123]
    v_mfma_f32_16x16x32_bf16 v[152:155], a[144:147], a[128:131], v[152:155]
    ds_read_b64_tr_b16 a[158:159], v6 offset:41984
    v_mfma_f32_16x16x32_bf16 v[184:187], a[144:147], a[132:135], v[184:187]
    v_mfma_f32_16x16x32_bf16 v[216:219], a[144:147], a[136:139], v[216:219]
    v_mfma_f32_16x16x32_bf16 v[248:251], a[144:147], a[140:143], v[248:251]
    s_waitcnt lgkmcnt(4)
    v_mfma_f32_16x16x32_bf16 v[252:255], a[148:151], a[140:143], v[252:255]
    ds_read_b64_tr_b16 a[144:145], v4 offset:3072
    v_mfma_f32_16x16x32_bf16 v[220:223], a[148:151], a[136:139], v[220:223]
    v_mfma_f32_16x16x32_bf16 v[188:191], a[148:151], a[132:135], v[188:191]
    v_mfma_f32_16x16x32_bf16 v[156:159], a[148:151], a[128:131], v[156:159]
    v_mfma_f32_16x16x32_bf16 v[124:127], a[148:151], a[124:127], v[124:127]
    ds_read_b64_tr_b16 a[146:147], v4 offset:8192
    v_mfma_f32_16x16x32_bf16 v[92:95], a[148:151], a[120:123], v[92:95]
    v_mfma_f32_16x16x32_bf16 v[60:63], a[148:151], a[116:119], v[60:63]
    v_mfma_f32_16x16x32_bf16 v[28:31], a[148:151], a[112:115], v[28:31]
    s_waitcnt lgkmcnt(4)
    v_mfma_f32_16x16x32_bf16 a[0:3], a[152:155], a[112:115], a[0:3]
    ds_read_b64_tr_b16 a[148:149], v6 offset:3072
    v_mfma_f32_16x16x32_bf16 a[8:11], a[152:155], a[116:119], a[8:11]
    v_mfma_f32_16x16x32_bf16 a[16:19], a[152:155], a[120:123], a[16:19]
    v_mfma_f32_16x16x32_bf16 a[24:27], a[152:155], a[124:127], a[24:27]
    v_mfma_f32_16x16x32_bf16 a[32:35], a[152:155], a[128:131], a[32:35]
    ds_read_b64_tr_b16 a[150:151], v6 offset:8192
    v_mfma_f32_16x16x32_bf16 a[40:43], a[152:155], a[132:135], a[40:43]
    v_mfma_f32_16x16x32_bf16 a[48:51], a[152:155], a[136:139], a[48:51]
    v_mfma_f32_16x16x32_bf16 a[56:59], a[152:155], a[140:143], a[56:59]
    s_waitcnt lgkmcnt(4)
    v_mfma_f32_16x16x32_bf16 a[60:63], a[156:159], a[140:143], a[60:63]
    ds_read_b64_tr_b16 a[152:153], v4 offset:4096
    v_mfma_f32_16x16x32_bf16 a[52:55], a[156:159], a[136:139], a[52:55]
    v_mfma_f32_16x16x32_bf16 a[44:47], a[156:159], a[132:135], a[44:47]
    v_mfma_f32_16x16x32_bf16 a[36:39], a[156:159], a[128:131], a[36:39]
    v_mfma_f32_16x16x32_bf16 a[28:31], a[156:159], a[124:127], a[28:31]
    ds_read_b64_tr_b16 a[154:155], v4 offset:9216
    v_mfma_f32_16x16x32_bf16 a[20:23], a[156:159], a[120:123], a[20:23]
    v_mfma_f32_16x16x32_bf16 a[12:15], a[156:159], a[116:119], a[12:15]
    v_mfma_f32_16x16x32_bf16 a[4:7], a[156:159], a[112:115], a[4:7]
    s_waitcnt lgkmcnt(4)
    v_mfma_f32_16x16x32_bf16 v[32:35], a[144:147], a[80:83], v[32:35]
    ds_read_b64_tr_b16 a[156:157], v6 offset:4096
    v_mfma_f32_16x16x32_bf16 v[64:67], a[144:147], a[84:87], v[64:67]
    v_mfma_f32_16x16x32_bf16 v[96:99], a[144:147], a[88:91], v[96:99]
    v_mfma_f32_16x16x32_bf16 v[128:131], a[144:147], a[92:95], v[128:131]
    v_mfma_f32_16x16x32_bf16 v[160:163], a[144:147], a[96:99], v[160:163]
    ds_read_b64_tr_b16 a[158:159], v6 offset:9216
    v_accvgpr_read_b32 v8, a0
    v_accvgpr_read_b32 v9, a1
    v_mfma_f32_16x16x32_bf16 v[192:195], a[144:147], a[100:103], v[192:195]
    v_accvgpr_read_b32 v10, a2
    v_accvgpr_read_b32 v11, a3
    v_mfma_f32_16x16x32_bf16 v[224:227], a[144:147], a[104:107], v[224:227]
    v_accvgpr_read_b32 v12, a4
    v_accvgpr_read_b32 v13, a5
    v_mfma_f32_16x16x32_bf16 a[64:67], a[144:147], a[108:111], a[64:67]
    v_accvgpr_read_b32 v14, a6
    v_accvgpr_read_b32 v15, a7
    s_waitcnt lgkmcnt(4)
    v_mfma_f32_16x16x32_bf16 a[68:71], a[148:151], a[108:111], a[68:71]
    ds_read_b64_tr_b16 a[144:145], v4 offset:39936
    v_mul_f32 v8, s60, v8
    v_mul_f32 v9, s60, v9
    v_mfma_f32_16x16x32_bf16 v[228:231], a[148:151], a[104:107], v[228:231]
    v_mul_f32 v10, s60, v10
    v_mul_f32 v11, s60, v11
    v_mfma_f32_16x16x32_bf16 v[196:199], a[148:151], a[100:103], v[196:199]
    v_mul_f32 v12, s60, v12
    v_mul_f32 v13, s60, v13
    v_mfma_f32_16x16x32_bf16 v[164:167], a[148:151], a[96:99], v[164:167]
    v_mul_f32 v14, s60, v14
    v_mul_f32 v15, s60, v15
    v_mfma_f32_16x16x32_bf16 v[132:135], a[148:151], a[92:95], v[132:135]
    ds_read_b64_tr_b16 a[146:147], v4 offset:45056
    v_cvt_pk_bf16_f32 v8, v8, v9
    v_cvt_pk_bf16_f32 v9, v10, v11
    v_mfma_f32_16x16x32_bf16 v[100:103], a[148:151], a[88:91], v[100:103]
    v_cvt_pk_bf16_f32 v10, v12, v13
    v_cvt_pk_bf16_f32 v11, v14, v15
    v_mfma_f32_16x16x32_bf16 v[68:71], a[148:151], a[84:87], v[68:71]
    buffer_store_dwordx4 v[8:11], v1, s[32:35], s69 offen offset:0 sc1
    v_mfma_f32_16x16x32_bf16 v[36:39], a[148:151], a[80:83], v[36:39]
    s_nop 0
    v_accvgpr_read_b32 v8, a8
    v_accvgpr_read_b32 v9, a9
    s_waitcnt lgkmcnt(4)
    v_mfma_f32_16x16x32_bf16 v[40:43], a[152:155], a[80:83], v[40:43]
    ds_read_b64_tr_b16 a[148:149], v6 offset:39936
    v_accvgpr_read_b32 v10, a10
    v_accvgpr_read_b32 v11, a11
    v_mfma_f32_16x16x32_bf16 v[72:75], a[152:155], a[84:87], v[72:75]
    v_accvgpr_read_b32 v12, a12
    v_accvgpr_read_b32 v13, a13
    v_mfma_f32_16x16x32_bf16 v[104:107], a[152:155], a[88:91], v[104:107]
    v_accvgpr_read_b32 v14, a14
    v_accvgpr_read_b32 v15, a15
    v_mfma_f32_16x16x32_bf16 v[136:139], a[152:155], a[92:95], v[136:139]
    v_mul_f32 v8, s60, v8
    v_mul_f32 v9, s60, v9
    v_mfma_f32_16x16x32_bf16 v[168:171], a[152:155], a[96:99], v[168:171]
    ds_read_b64_tr_b16 a[150:151], v6 offset:45056
    v_mul_f32 v10, s60, v10
    v_mul_f32 v11, s60, v11
    v_mfma_f32_16x16x32_bf16 v[200:203], a[152:155], a[100:103], v[200:203]
    v_mul_f32 v12, s60, v12
    v_mul_f32 v13, s60, v13
    v_mfma_f32_16x16x32_bf16 v[232:235], a[152:155], a[104:107], v[232:235]
    v_mul_f32 v14, s60, v14
    v_mul_f32 v15, s60, v15
    v_mfma_f32_16x16x32_bf16 a[72:75], a[152:155], a[108:111], a[72:75]
    v_cvt_pk_bf16_f32 v8, v8, v9
    v_cvt_pk_bf16_f32 v9, v10, v11
    s_waitcnt lgkmcnt(4)
    v_mfma_f32_16x16x32_bf16 a[76:79], a[156:159], a[108:111], a[76:79]
    ds_read_b64_tr_b16 a[152:153], v4 offset:40960
    v_cvt_pk_bf16_f32 v10, v12, v13
    v_cvt_pk_bf16_f32 v11, v14, v15
    v_mfma_f32_16x16x32_bf16 v[236:239], a[156:159], a[104:107], v[236:239]
    buffer_store_dwordx4 v[8:11], v1, s[32:35], s69 offen offset:1024 sc1
    v_mfma_f32_16x16x32_bf16 v[204:207], a[156:159], a[100:103], v[204:207]
    s_nop 0
    v_accvgpr_read_b32 v8, a16
    v_accvgpr_read_b32 v9, a17
    v_mfma_f32_16x16x32_bf16 v[172:175], a[156:159], a[96:99], v[172:175]
    v_accvgpr_read_b32 v10, a18
    v_accvgpr_read_b32 v11, a19
    v_mfma_f32_16x16x32_bf16 v[140:143], a[156:159], a[92:95], v[140:143]
    ds_read_b64_tr_b16 a[154:155], v4 offset:46080
    v_accvgpr_read_b32 v12, a20
    v_accvgpr_read_b32 v13, a21
    v_mfma_f32_16x16x32_bf16 v[108:111], a[156:159], a[88:91], v[108:111]
    v_accvgpr_read_b32 v14, a22
    v_accvgpr_read_b32 v15, a23
    v_mfma_f32_16x16x32_bf16 v[76:79], a[156:159], a[84:87], v[76:79]
    v_mul_f32 v8, s60, v8
    v_mul_f32 v9, s60, v9
    v_mfma_f32_16x16x32_bf16 v[44:47], a[156:159], a[80:83], v[44:47]
    v_mul_f32 v10, s60, v10
    v_mul_f32 v11, s60, v11
    s_waitcnt lgkmcnt(4)
    v_mfma_f32_16x16x32_bf16 v[32:35], a[144:147], a[112:115], v[32:35]
    ds_read_b64_tr_b16 a[156:157], v6 offset:40960
    v_mul_f32 v12, s60, v12
    v_mul_f32 v13, s60, v13
    v_mfma_f32_16x16x32_bf16 v[64:67], a[144:147], a[116:119], v[64:67]
    v_mul_f32 v14, s60, v14
    v_mul_f32 v15, s60, v15
    v_mfma_f32_16x16x32_bf16 v[96:99], a[144:147], a[120:123], v[96:99]
    v_cvt_pk_bf16_f32 v8, v8, v9
    v_cvt_pk_bf16_f32 v9, v10, v11
    v_mfma_f32_16x16x32_bf16 v[128:131], a[144:147], a[124:127], v[128:131]
    v_cvt_pk_bf16_f32 v10, v12, v13
    v_cvt_pk_bf16_f32 v11, v14, v15
    v_mfma_f32_16x16x32_bf16 v[160:163], a[144:147], a[128:131], v[160:163]
    ds_read_b64_tr_b16 a[158:159], v6 offset:46080
    buffer_store_dwordx4 v[8:11], v1, s[32:35], s69 offen offset:2048 sc1
    v_mfma_f32_16x16x32_bf16 v[192:195], a[144:147], a[132:135], v[192:195]
    s_nop 0
    v_accvgpr_read_b32 v8, a24
    v_accvgpr_read_b32 v9, a25
    v_mfma_f32_16x16x32_bf16 v[224:227], a[144:147], a[136:139], v[224:227]
    v_accvgpr_read_b32 v10, a26
    v_accvgpr_read_b32 v11, a27
    v_mfma_f32_16x16x32_bf16 a[64:67], a[144:147], a[140:143], a[64:67]
    v_accvgpr_read_b32 v12, a28
    v_accvgpr_read_b32 v13, a29
    s_waitcnt lgkmcnt(4)
    v_mfma_f32_16x16x32_bf16 a[68:71], a[148:151], a[140:143], a[68:71]
    v_accvgpr_read_b32 v14, a30
    v_accvgpr_read_b32 v15, a31
    v_mfma_f32_16x16x32_bf16 v[228:231], a[148:151], a[136:139], v[228:231]
    v_mul_f32 v8, s60, v8
    v_mul_f32 v9, s60, v9
    v_mfma_f32_16x16x32_bf16 v[196:199], a[148:151], a[132:135], v[196:199]
    v_mul_f32 v10, s60, v10
    v_mul_f32 v11, s60, v11
    v_mfma_f32_16x16x32_bf16 v[164:167], a[148:151], a[128:131], v[164:167]
    v_mul_f32 v12, s60, v12
    v_mul_f32 v13, s60, v13
    v_mfma_f32_16x16x32_bf16 v[132:135], a[148:151], a[124:127], v[132:135]
    v_mul_f32 v14, s60, v14
    v_mul_f32 v15, s60, v15
    v_mfma_f32_16x16x32_bf16 v[100:103], a[148:151], a[120:123], v[100:103]
    v_cvt_pk_bf16_f32 v8, v8, v9
    v_cvt_pk_bf16_f32 v9, v10, v11
    v_mfma_f32_16x16x32_bf16 v[68:71], a[148:151], a[116:119], v[68:71]
    v_cvt_pk_bf16_f32 v10, v12, v13
    v_cvt_pk_bf16_f32 v11, v14, v15
    v_mfma_f32_16x16x32_bf16 v[36:39], a[148:151], a[112:115], v[36:39]
    buffer_store_dwordx4 v[8:11], v1, s[32:35], s69 offen offset:3072 sc1
    s_waitcnt lgkmcnt(2)
    v_mfma_f32_16x16x32_bf16 v[40:43], a[152:155], a[112:115], v[40:43]
    v_mfma_f32_16x16x32_bf16 v[72:75], a[152:155], a[116:119], v[72:75]
    v_mfma_f32_16x16x32_bf16 v[104:107], a[152:155], a[120:123], v[104:107]
    v_mfma_f32_16x16x32_bf16 v[136:139], a[152:155], a[124:127], v[136:139]
    v_mfma_f32_16x16x32_bf16 v[168:171], a[152:155], a[128:131], v[168:171]
    v_mfma_f32_16x16x32_bf16 v[200:203], a[152:155], a[132:135], v[200:203]
    v_mfma_f32_16x16x32_bf16 v[232:235], a[152:155], a[136:139], v[232:235]
    v_mfma_f32_16x16x32_bf16 a[72:75], a[152:155], a[140:143], a[72:75]
    s_waitcnt lgkmcnt(0)
    v_mfma_f32_16x16x32_bf16 a[76:79], a[156:159], a[140:143], a[76:79]
    v_mfma_f32_16x16x32_bf16 v[236:239], a[156:159], a[136:139], v[236:239]
    v_mfma_f32_16x16x32_bf16 v[204:207], a[156:159], a[132:135], v[204:207]
    v_mfma_f32_16x16x32_bf16 v[172:175], a[156:159], a[128:131], v[172:175]
    v_mfma_f32_16x16x32_bf16 v[140:143], a[156:159], a[124:127], v[140:143]
    v_mfma_f32_16x16x32_bf16 v[108:111], a[156:159], a[120:123], v[108:111]
    v_mfma_f32_16x16x32_bf16 v[76:79], a[156:159], a[116:119], v[76:79]
    v_mfma_f32_16x16x32_bf16 v[44:47], a[156:159], a[112:115], v[44:47]
    v_pk_mul_f32 v[4:5], v[16:17], s[64:65]
    v_pk_mul_f32 v[6:7], v[18:19], s[64:65]
    v_pk_mul_f32 v[8:9], v[20:21], s[64:65]
    v_pk_mul_f32 v[10:11], v[22:23], s[64:65]
    v_exp_f32 v4, v4
    v_exp_f32 v5, v5
    v_exp_f32 v6, v6
    v_exp_f32 v7, v7
    v_exp_f32 v8, v8
    v_exp_f32 v9, v9
    v_exp_f32 v10, v10
    v_exp_f32 v11, v11
    v_pk_mul_f32 v[24:25], v[16:17], v[24:25]
    v_pk_mul_f32 v[26:27], v[18:19], v[26:27]
    v_pk_mul_f32 v[28:29], v[20:21], v[28:29]
    v_pk_mul_f32 v[30:31], v[22:23], v[30:31]
    v_pk_add_f32 v[4:5], v[4:5], 1.0 op_sel_hi:[1,0]
    v_pk_add_f32 v[6:7], v[6:7], 1.0 op_sel_hi:[1,0]
    v_pk_add_f32 v[8:9], v[8:9], 1.0 op_sel_hi:[1,0]
    v_pk_add_f32 v[10:11], v[10:11], 1.0 op_sel_hi:[1,0]
    v_rcp_f32 v4, v4
    v_rcp_f32 v5, v5
    v_rcp_f32 v6, v6
    v_rcp_f32 v7, v7
    v_rcp_f32 v8, v8
    v_rcp_f32 v9, v9
    v_rcp_f32 v10, v10
    v_rcp_f32 v11, v11
    v_pk_mul_f32 v[24:25], v[24:25], v[4:5]
    v_pk_mul_f32 v[26:27], v[26:27], v[6:7]
    v_pk_mul_f32 v[28:29], v[28:29], v[8:9]
    v_pk_mul_f32 v[30:31], v[30:31], v[10:11]
    v_cvt_pk_bf16_f32 v16, v24, v25
    v_cvt_pk_bf16_f32 v17, v26, v27
    v_cvt_pk_bf16_f32 v18, v28, v29
    v_cvt_pk_bf16_f32 v19, v30, v31
    buffer_store_dwordx4 v[16:19], v1, s[32:35], s70 offen offset:0 sc1
    v_pk_mul_f32 v[4:5], v[32:33], s[64:65]
    v_pk_mul_f32 v[6:7], v[34:35], s[64:65]
    v_pk_mul_f32 v[8:9], v[36:37], s[64:65]
    v_pk_mul_f32 v[10:11], v[38:39], s[64:65]
    v_exp_f32 v4, v4
    v_exp_f32 v5, v5
    v_exp_f32 v6, v6
    v_exp_f32 v7, v7
    v_exp_f32 v8, v8
    v_exp_f32 v9, v9
    v_exp_f32 v10, v10
    v_exp_f32 v11, v11
    v_pk_mul_f32 v[40:41], v[32:33], v[40:41]
    v_pk_mul_f32 v[42:43], v[34:35], v[42:43]
    v_pk_mul_f32 v[44:45], v[36:37], v[44:45]
    v_pk_mul_f32 v[46:47], v[38:39], v[46:47]
    v_pk_add_f32 v[4:5], v[4:5], 1.0 op_sel_hi:[1,0]
    v_pk_add_f32 v[6:7], v[6:7], 1.0 op_sel_hi:[1,0]
    v_pk_add_f32 v[8:9], v[8:9], 1.0 op_sel_hi:[1,0]
    v_pk_add_f32 v[10:11], v[10:11], 1.0 op_sel_hi:[1,0]
    v_rcp_f32 v4, v4
    v_rcp_f32 v5, v5
    v_rcp_f32 v6, v6
    v_rcp_f32 v7, v7
    v_rcp_f32 v8, v8
    v_rcp_f32 v9, v9
    v_rcp_f32 v10, v10
    v_rcp_f32 v11, v11
    v_pk_mul_f32 v[40:41], v[40:41], v[4:5]
    v_pk_mul_f32 v[42:43], v[42:43], v[6:7]
    v_pk_mul_f32 v[44:45], v[44:45], v[8:9]
    v_pk_mul_f32 v[46:47], v[46:47], v[10:11]
    v_cvt_pk_bf16_f32 v32, v40, v41
    v_cvt_pk_bf16_f32 v33, v42, v43
    v_cvt_pk_bf16_f32 v34, v44, v45
    v_cvt_pk_bf16_f32 v35, v46, v47
    buffer_store_dwordx4 v[32:35], v1, s[32:35], s62 offen offset:0 sc1
    v_pk_mul_f32 v[4:5], v[48:49], s[64:65]
    v_pk_mul_f32 v[6:7], v[50:51], s[64:65]
    v_pk_mul_f32 v[8:9], v[52:53], s[64:65]
    v_pk_mul_f32 v[10:11], v[54:55], s[64:65]
    v_exp_f32 v4, v4
    v_exp_f32 v5, v5
    v_exp_f32 v6, v6
    v_exp_f32 v7, v7
    v_exp_f32 v8, v8
    v_exp_f32 v9, v9
    v_exp_f32 v10, v10
    v_exp_f32 v11, v11
    v_pk_mul_f32 v[56:57], v[48:49], v[56:57]
    v_pk_mul_f32 v[58:59], v[50:51], v[58:59]
    v_pk_mul_f32 v[60:61], v[52:53], v[60:61]
    v_pk_mul_f32 v[62:63], v[54:55], v[62:63]
    v_pk_add_f32 v[4:5], v[4:5], 1.0 op_sel_hi:[1,0]
    v_pk_add_f32 v[6:7], v[6:7], 1.0 op_sel_hi:[1,0]
    v_pk_add_f32 v[8:9], v[8:9], 1.0 op_sel_hi:[1,0]
    v_pk_add_f32 v[10:11], v[10:11], 1.0 op_sel_hi:[1,0]
    v_rcp_f32 v4, v4
    v_rcp_f32 v5, v5
    v_rcp_f32 v6, v6
    v_rcp_f32 v7, v7
    v_rcp_f32 v8, v8
    v_rcp_f32 v9, v9
    v_rcp_f32 v10, v10
    v_rcp_f32 v11, v11
    v_pk_mul_f32 v[56:57], v[56:57], v[4:5]
    v_pk_mul_f32 v[58:59], v[58:59], v[6:7]
    v_pk_mul_f32 v[60:61], v[60:61], v[8:9]
    v_pk_mul_f32 v[62:63], v[62:63], v[10:11]
    v_cvt_pk_bf16_f32 v48, v56, v57
    v_cvt_pk_bf16_f32 v49, v58, v59
    v_cvt_pk_bf16_f32 v50, v60, v61
    v_cvt_pk_bf16_f32 v51, v62, v63
    buffer_store_dwordx4 v[48:51], v1, s[32:35], s70 offen offset:1024 sc1
    v_pk_mul_f32 v[4:5], v[64:65], s[64:65]
    v_pk_mul_f32 v[6:7], v[66:67], s[64:65]
    v_pk_mul_f32 v[8:9], v[68:69], s[64:65]
    v_pk_mul_f32 v[10:11], v[70:71], s[64:65]
    v_exp_f32 v4, v4
    v_exp_f32 v5, v5
    v_exp_f32 v6, v6
    v_exp_f32 v7, v7
    v_exp_f32 v8, v8
    v_exp_f32 v9, v9
    v_exp_f32 v10, v10
    v_exp_f32 v11, v11
    v_pk_mul_f32 v[72:73], v[64:65], v[72:73]
    v_pk_mul_f32 v[74:75], v[66:67], v[74:75]
    v_pk_mul_f32 v[76:77], v[68:69], v[76:77]
    v_pk_mul_f32 v[78:79], v[70:71], v[78:79]
    v_pk_add_f32 v[4:5], v[4:5], 1.0 op_sel_hi:[1,0]
    v_pk_add_f32 v[6:7], v[6:7], 1.0 op_sel_hi:[1,0]
    v_pk_add_f32 v[8:9], v[8:9], 1.0 op_sel_hi:[1,0]
    v_pk_add_f32 v[10:11], v[10:11], 1.0 op_sel_hi:[1,0]
    v_rcp_f32 v4, v4
    v_rcp_f32 v5, v5
    v_rcp_f32 v6, v6
    v_rcp_f32 v7, v7
    v_rcp_f32 v8, v8
    v_rcp_f32 v9, v9
    v_rcp_f32 v10, v10
    v_rcp_f32 v11, v11
    v_pk_mul_f32 v[72:73], v[72:73], v[4:5]
    v_pk_mul_f32 v[74:75], v[74:75], v[6:7]
    v_pk_mul_f32 v[76:77], v[76:77], v[8:9]
    v_pk_mul_f32 v[78:79], v[78:79], v[10:11]
    v_cvt_pk_bf16_f32 v64, v72, v73
    v_cvt_pk_bf16_f32 v65, v74, v75
    v_cvt_pk_bf16_f32 v66, v76, v77
    v_cvt_pk_bf16_f32 v67, v78, v79
    buffer_store_dwordx4 v[64:67], v1, s[32:35], s62 offen offset:1024 sc1
    v_pk_mul_f32 v[4:5], v[80:81], s[64:65]
    v_pk_mul_f32 v[6:7], v[82:83], s[64:65]
    v_pk_mul_f32 v[8:9], v[84:85], s[64:65]
    v_pk_mul_f32 v[10:11], v[86:87], s[64:65]
    v_exp_f32 v4, v4
    v_exp_f32 v5, v5
    v_exp_f32 v6, v6
    v_exp_f32 v7, v7
    v_exp_f32 v8, v8
    v_exp_f32 v9, v9
    v_exp_f32 v10, v10
    v_exp_f32 v11, v11
    v_pk_mul_f32 v[88:89], v[80:81], v[88:89]
    v_pk_mul_f32 v[90:91], v[82:83], v[90:91]
    v_pk_mul_f32 v[92:93], v[84:85], v[92:93]
    v_pk_mul_f32 v[94:95], v[86:87], v[94:95]
    v_pk_add_f32 v[4:5], v[4:5], 1.0 op_sel_hi:[1,0]
    v_pk_add_f32 v[6:7], v[6:7], 1.0 op_sel_hi:[1,0]
    v_pk_add_f32 v[8:9], v[8:9], 1.0 op_sel_hi:[1,0]
    v_pk_add_f32 v[10:11], v[10:11], 1.0 op_sel_hi:[1,0]
    v_rcp_f32 v4, v4
    v_rcp_f32 v5, v5
    v_rcp_f32 v6, v6
    v_rcp_f32 v7, v7
    v_rcp_f32 v8, v8
    v_rcp_f32 v9, v9
    v_rcp_f32 v10, v10
    v_rcp_f32 v11, v11
    v_pk_mul_f32 v[88:89], v[88:89], v[4:5]
    v_pk_mul_f32 v[90:91], v[90:91], v[6:7]
    v_pk_mul_f32 v[92:93], v[92:93], v[8:9]
    v_pk_mul_f32 v[94:95], v[94:95], v[10:11]
    v_cvt_pk_bf16_f32 v80, v88, v89
    v_cvt_pk_bf16_f32 v81, v90, v91
    v_cvt_pk_bf16_f32 v82, v92, v93
    v_cvt_pk_bf16_f32 v83, v94, v95
    buffer_store_dwordx4 v[80:83], v1, s[32:35], s70 offen offset:2048 sc1
    v_pk_mul_f32 v[4:5], v[96:97], s[64:65]
    v_pk_mul_f32 v[6:7], v[98:99], s[64:65]
    v_pk_mul_f32 v[8:9], v[100:101], s[64:65]
    v_pk_mul_f32 v[10:11], v[102:103], s[64:65]
    v_exp_f32 v4, v4
    v_exp_f32 v5, v5
    v_exp_f32 v6, v6
    v_exp_f32 v7, v7
    v_exp_f32 v8, v8
    v_exp_f32 v9, v9
    v_exp_f32 v10, v10
    v_exp_f32 v11, v11
    v_pk_mul_f32 v[104:105], v[96:97], v[104:105]
    v_pk_mul_f32 v[106:107], v[98:99], v[106:107]
    v_pk_mul_f32 v[108:109], v[100:101], v[108:109]
    v_pk_mul_f32 v[110:111], v[102:103], v[110:111]
    v_pk_add_f32 v[4:5], v[4:5], 1.0 op_sel_hi:[1,0]
    v_pk_add_f32 v[6:7], v[6:7], 1.0 op_sel_hi:[1,0]
    v_pk_add_f32 v[8:9], v[8:9], 1.0 op_sel_hi:[1,0]
    v_pk_add_f32 v[10:11], v[10:11], 1.0 op_sel_hi:[1,0]
    v_rcp_f32 v4, v4
    v_rcp_f32 v5, v5
    v_rcp_f32 v6, v6
    v_rcp_f32 v7, v7
    v_rcp_f32 v8, v8
    v_rcp_f32 v9, v9
    v_rcp_f32 v10, v10
    v_rcp_f32 v11, v11
    v_pk_mul_f32 v[104:105], v[104:105], v[4:5]
    v_pk_mul_f32 v[106:107], v[106:107], v[6:7]
    v_pk_mul_f32 v[108:109], v[108:109], v[8:9]
    v_pk_mul_f32 v[110:111], v[110:111], v[10:11]
    v_cvt_pk_bf16_f32 v96, v104, v105
    v_cvt_pk_bf16_f32 v97, v106, v107
    v_cvt_pk_bf16_f32 v98, v108, v109
    v_cvt_pk_bf16_f32 v99, v110, v111
    buffer_store_dwordx4 v[96:99], v1, s[32:35], s62 offen offset:2048 sc1
    v_pk_mul_f32 v[4:5], v[112:113], s[64:65]
    v_pk_mul_f32 v[6:7], v[114:115], s[64:65]
    v_pk_mul_f32 v[8:9], v[116:117], s[64:65]
    v_pk_mul_f32 v[10:11], v[118:119], s[64:65]
    v_exp_f32 v4, v4
    v_exp_f32 v5, v5
    v_exp_f32 v6, v6
    v_exp_f32 v7, v7
    v_exp_f32 v8, v8
    v_exp_f32 v9, v9
    v_exp_f32 v10, v10
    v_exp_f32 v11, v11
    v_pk_mul_f32 v[120:121], v[112:113], v[120:121]
    v_pk_mul_f32 v[122:123], v[114:115], v[122:123]
    v_pk_mul_f32 v[124:125], v[116:117], v[124:125]
    v_pk_mul_f32 v[126:127], v[118:119], v[126:127]
    v_pk_add_f32 v[4:5], v[4:5], 1.0 op_sel_hi:[1,0]
    v_pk_add_f32 v[6:7], v[6:7], 1.0 op_sel_hi:[1,0]
    v_pk_add_f32 v[8:9], v[8:9], 1.0 op_sel_hi:[1,0]
    v_pk_add_f32 v[10:11], v[10:11], 1.0 op_sel_hi:[1,0]
    v_rcp_f32 v4, v4
    v_rcp_f32 v5, v5
    v_rcp_f32 v6, v6
    v_rcp_f32 v7, v7
    v_rcp_f32 v8, v8
    v_rcp_f32 v9, v9
    v_rcp_f32 v10, v10
    v_rcp_f32 v11, v11
    v_pk_mul_f32 v[120:121], v[120:121], v[4:5]
    v_pk_mul_f32 v[122:123], v[122:123], v[6:7]
    v_pk_mul_f32 v[124:125], v[124:125], v[8:9]
    v_pk_mul_f32 v[126:127], v[126:127], v[10:11]
    v_cvt_pk_bf16_f32 v112, v120, v121
    v_cvt_pk_bf16_f32 v113, v122, v123
    v_cvt_pk_bf16_f32 v114, v124, v125
    v_cvt_pk_bf16_f32 v115, v126, v127
    buffer_store_dwordx4 v[112:115], v1, s[32:35], s70 offen offset:3072 sc1
    v_pk_mul_f32 v[4:5], v[128:129], s[64:65]
    v_pk_mul_f32 v[6:7], v[130:131], s[64:65]
    v_pk_mul_f32 v[8:9], v[132:133], s[64:65]
    v_pk_mul_f32 v[10:11], v[134:135], s[64:65]
    v_exp_f32 v4, v4
    v_exp_f32 v5, v5
    v_exp_f32 v6, v6
    v_exp_f32 v7, v7
    v_exp_f32 v8, v8
    v_exp_f32 v9, v9
    v_exp_f32 v10, v10
    v_exp_f32 v11, v11
    v_pk_mul_f32 v[136:137], v[128:129], v[136:137]
    v_pk_mul_f32 v[138:139], v[130:131], v[138:139]
    v_pk_mul_f32 v[140:141], v[132:133], v[140:141]
    v_pk_mul_f32 v[142:143], v[134:135], v[142:143]
    v_pk_add_f32 v[4:5], v[4:5], 1.0 op_sel_hi:[1,0]
    v_pk_add_f32 v[6:7], v[6:7], 1.0 op_sel_hi:[1,0]
    v_pk_add_f32 v[8:9], v[8:9], 1.0 op_sel_hi:[1,0]
    v_pk_add_f32 v[10:11], v[10:11], 1.0 op_sel_hi:[1,0]
    v_rcp_f32 v4, v4
    v_rcp_f32 v5, v5
    v_rcp_f32 v6, v6
    v_rcp_f32 v7, v7
    v_rcp_f32 v8, v8
    v_rcp_f32 v9, v9
    v_rcp_f32 v10, v10
    v_rcp_f32 v11, v11
    v_pk_mul_f32 v[136:137], v[136:137], v[4:5]
    v_pk_mul_f32 v[138:139], v[138:139], v[6:7]
    v_pk_mul_f32 v[140:141], v[140:141], v[8:9]
    v_pk_mul_f32 v[142:143], v[142:143], v[10:11]
    v_cvt_pk_bf16_f32 v128, v136, v137
    v_cvt_pk_bf16_f32 v129, v138, v139
    v_cvt_pk_bf16_f32 v130, v140, v141
    v_cvt_pk_bf16_f32 v131, v142, v143
    buffer_store_dwordx4 v[128:131], v1, s[32:35], s62 offen offset:3072 sc1
    s_add_u32 s69, s69, 4096
    s_add_u32 s70, s70, 4096
    s_add_u32 s62, s62, 4096
    v_accvgpr_read_b32 v4, a32
    v_accvgpr_read_b32 v5, a33
    v_accvgpr_read_b32 v6, a34
    v_accvgpr_read_b32 v7, a35
    v_accvgpr_read_b32 v8, a36
    v_accvgpr_read_b32 v9, a37
    v_accvgpr_read_b32 v10, a38
    v_accvgpr_read_b32 v11, a39
    v_pk_mul_f32 v[4:5], v[4:5], s[60:61]
    v_pk_mul_f32 v[6:7], v[6:7], s[60:61]
    v_pk_mul_f32 v[8:9], v[8:9], s[60:61]
    v_pk_mul_f32 v[10:11], v[10:11], s[60:61]
    v_cvt_pk_bf16_f32 v12, v4, v5
    v_cvt_pk_bf16_f32 v13, v6, v7
    v_cvt_pk_bf16_f32 v14, v8, v9
    v_cvt_pk_bf16_f32 v15, v10, v11
    buffer_store_dwordx4 v[12:15], v1, s[32:35], s69 offen offset:0 sc1
    v_pk_mul_f32 v[4:5], v[144:145], s[64:65]
    v_pk_mul_f32 v[6:7], v[146:147], s[64:65]
    v_pk_mul_f32 v[8:9], v[148:149], s[64:65]
    v_pk_mul_f32 v[10:11], v[150:151], s[64:65]
    v_exp_f32 v4, v4
    v_exp_f32 v5, v5
    v_exp_f32 v6, v6
    v_exp_f32 v7, v7
    v_exp_f32 v8, v8
    v_exp_f32 v9, v9
    v_exp_f32 v10, v10
    v_exp_f32 v11, v11
    v_pk_mul_f32 v[152:153], v[144:145], v[152:153]
    v_pk_mul_f32 v[154:155], v[146:147], v[154:155]
    v_pk_mul_f32 v[156:157], v[148:149], v[156:157]
    v_pk_mul_f32 v[158:159], v[150:151], v[158:159]
    v_pk_add_f32 v[4:5], v[4:5], 1.0 op_sel_hi:[1,0]
    v_pk_add_f32 v[6:7], v[6:7], 1.0 op_sel_hi:[1,0]
    v_pk_add_f32 v[8:9], v[8:9], 1.0 op_sel_hi:[1,0]
    v_pk_add_f32 v[10:11], v[10:11], 1.0 op_sel_hi:[1,0]
    v_rcp_f32 v4, v4
    v_rcp_f32 v5, v5
    v_rcp_f32 v6, v6
    v_rcp_f32 v7, v7
    v_rcp_f32 v8, v8
    v_rcp_f32 v9, v9
    v_rcp_f32 v10, v10
    v_rcp_f32 v11, v11
    v_pk_mul_f32 v[152:153], v[152:153], v[4:5]
    v_pk_mul_f32 v[154:155], v[154:155], v[6:7]
    v_pk_mul_f32 v[156:157], v[156:157], v[8:9]
    v_pk_mul_f32 v[158:159], v[158:159], v[10:11]
    v_cvt_pk_bf16_f32 v144, v152, v153
    v_cvt_pk_bf16_f32 v145, v154, v155
    v_cvt_pk_bf16_f32 v146, v156, v157
    v_cvt_pk_bf16_f32 v147, v158, v159
    buffer_store_dwordx4 v[144:147], v1, s[32:35], s70 offen offset:0 sc1
    v_pk_mul_f32 v[4:5], v[160:161], s[64:65]
    v_pk_mul_f32 v[6:7], v[162:163], s[64:65]
    v_pk_mul_f32 v[8:9], v[164:165], s[64:65]
    v_pk_mul_f32 v[10:11], v[166:167], s[64:65]
    v_exp_f32 v4, v4
    v_exp_f32 v5, v5
    v_exp_f32 v6, v6
    v_exp_f32 v7, v7
    v_exp_f32 v8, v8
    v_exp_f32 v9, v9
    v_exp_f32 v10, v10
    v_exp_f32 v11, v11
    v_pk_mul_f32 v[168:169], v[160:161], v[168:169]
    v_pk_mul_f32 v[170:171], v[162:163], v[170:171]
    v_pk_mul_f32 v[172:173], v[164:165], v[172:173]
    v_pk_mul_f32 v[174:175], v[166:167], v[174:175]
    v_pk_add_f32 v[4:5], v[4:5], 1.0 op_sel_hi:[1,0]
    v_pk_add_f32 v[6:7], v[6:7], 1.0 op_sel_hi:[1,0]
    v_pk_add_f32 v[8:9], v[8:9], 1.0 op_sel_hi:[1,0]
    v_pk_add_f32 v[10:11], v[10:11], 1.0 op_sel_hi:[1,0]
    v_rcp_f32 v4, v4
    v_rcp_f32 v5, v5
    v_rcp_f32 v6, v6
    v_rcp_f32 v7, v7
    v_rcp_f32 v8, v8
    v_rcp_f32 v9, v9
    v_rcp_f32 v10, v10
    v_rcp_f32 v11, v11
    v_pk_mul_f32 v[168:169], v[168:169], v[4:5]
    v_pk_mul_f32 v[170:171], v[170:171], v[6:7]
    v_pk_mul_f32 v[172:173], v[172:173], v[8:9]
    v_pk_mul_f32 v[174:175], v[174:175], v[10:11]
    v_cvt_pk_bf16_f32 v160, v168, v169
    v_cvt_pk_bf16_f32 v161, v170, v171
    v_cvt_pk_bf16_f32 v162, v172, v173
    v_cvt_pk_bf16_f32 v163, v174, v175
    buffer_store_dwordx4 v[160:163], v1, s[32:35], s62 offen offset:0 sc1
    v_accvgpr_read_b32 v4, a40
    v_accvgpr_read_b32 v5, a41
    v_accvgpr_read_b32 v6, a42
    v_accvgpr_read_b32 v7, a43
    v_accvgpr_read_b32 v8, a44
    v_accvgpr_read_b32 v9, a45
    v_accvgpr_read_b32 v10, a46
    v_accvgpr_read_b32 v11, a47
    v_pk_mul_f32 v[4:5], v[4:5], s[60:61]
    v_pk_mul_f32 v[6:7], v[6:7], s[60:61]
    v_pk_mul_f32 v[8:9], v[8:9], s[60:61]
    v_pk_mul_f32 v[10:11], v[10:11], s[60:61]
    v_cvt_pk_bf16_f32 v12, v4, v5
    v_cvt_pk_bf16_f32 v13, v6, v7
    v_cvt_pk_bf16_f32 v14, v8, v9
    v_cvt_pk_bf16_f32 v15, v10, v11
    buffer_store_dwordx4 v[12:15], v1, s[32:35], s69 offen offset:1024 sc1
    v_pk_mul_f32 v[4:5], v[176:177], s[64:65]
    v_pk_mul_f32 v[6:7], v[178:179], s[64:65]
    v_pk_mul_f32 v[8:9], v[180:181], s[64:65]
    v_pk_mul_f32 v[10:11], v[182:183], s[64:65]
    v_exp_f32 v4, v4
    v_exp_f32 v5, v5
    v_exp_f32 v6, v6
    v_exp_f32 v7, v7
    v_exp_f32 v8, v8
    v_exp_f32 v9, v9
    v_exp_f32 v10, v10
    v_exp_f32 v11, v11
    v_pk_mul_f32 v[184:185], v[176:177], v[184:185]
    v_pk_mul_f32 v[186:187], v[178:179], v[186:187]
    v_pk_mul_f32 v[188:189], v[180:181], v[188:189]
    v_pk_mul_f32 v[190:191], v[182:183], v[190:191]
    v_pk_add_f32 v[4:5], v[4:5], 1.0 op_sel_hi:[1,0]
    v_pk_add_f32 v[6:7], v[6:7], 1.0 op_sel_hi:[1,0]
    v_pk_add_f32 v[8:9], v[8:9], 1.0 op_sel_hi:[1,0]
    v_pk_add_f32 v[10:11], v[10:11], 1.0 op_sel_hi:[1,0]
    v_rcp_f32 v4, v4
    v_rcp_f32 v5, v5
    v_rcp_f32 v6, v6
    v_rcp_f32 v7, v7
    v_rcp_f32 v8, v8
    v_rcp_f32 v9, v9
    v_rcp_f32 v10, v10
    v_rcp_f32 v11, v11
    v_pk_mul_f32 v[184:185], v[184:185], v[4:5]
    v_pk_mul_f32 v[186:187], v[186:187], v[6:7]
    v_pk_mul_f32 v[188:189], v[188:189], v[8:9]
    v_pk_mul_f32 v[190:191], v[190:191], v[10:11]
    v_cvt_pk_bf16_f32 v176, v184, v185
    v_cvt_pk_bf16_f32 v177, v186, v187
    v_cvt_pk_bf16_f32 v178, v188, v189
    v_cvt_pk_bf16_f32 v179, v190, v191
    buffer_store_dwordx4 v[176:179], v1, s[32:35], s70 offen offset:1024 sc1
    v_pk_mul_f32 v[4:5], v[192:193], s[64:65]
    v_pk_mul_f32 v[6:7], v[194:195], s[64:65]
    v_pk_mul_f32 v[8:9], v[196:197], s[64:65]
    v_pk_mul_f32 v[10:11], v[198:199], s[64:65]
    v_exp_f32 v4, v4
    v_exp_f32 v5, v5
    v_exp_f32 v6, v6
    v_exp_f32 v7, v7
    v_exp_f32 v8, v8
    v_exp_f32 v9, v9
    v_exp_f32 v10, v10
    v_exp_f32 v11, v11
    v_pk_mul_f32 v[200:201], v[192:193], v[200:201]
    v_pk_mul_f32 v[202:203], v[194:195], v[202:203]
    v_pk_mul_f32 v[204:205], v[196:197], v[204:205]
    v_pk_mul_f32 v[206:207], v[198:199], v[206:207]
    v_pk_add_f32 v[4:5], v[4:5], 1.0 op_sel_hi:[1,0]
    v_pk_add_f32 v[6:7], v[6:7], 1.0 op_sel_hi:[1,0]
    v_pk_add_f32 v[8:9], v[8:9], 1.0 op_sel_hi:[1,0]
    v_pk_add_f32 v[10:11], v[10:11], 1.0 op_sel_hi:[1,0]
    v_rcp_f32 v4, v4
    v_rcp_f32 v5, v5
    v_rcp_f32 v6, v6
    v_rcp_f32 v7, v7
    v_rcp_f32 v8, v8
    v_rcp_f32 v9, v9
    v_rcp_f32 v10, v10
    v_rcp_f32 v11, v11
    v_pk_mul_f32 v[200:201], v[200:201], v[4:5]
    v_pk_mul_f32 v[202:203], v[202:203], v[6:7]
    v_pk_mul_f32 v[204:205], v[204:205], v[8:9]
    v_pk_mul_f32 v[206:207], v[206:207], v[10:11]
    v_cvt_pk_bf16_f32 v192, v200, v201
    v_cvt_pk_bf16_f32 v193, v202, v203
    v_cvt_pk_bf16_f32 v194, v204, v205
    v_cvt_pk_bf16_f32 v195, v206, v207
    buffer_store_dwordx4 v[192:195], v1, s[32:35], s62 offen offset:1024 sc1
    v_accvgpr_read_b32 v4, a48
    v_accvgpr_read_b32 v5, a49
    v_accvgpr_read_b32 v6, a50
    v_accvgpr_read_b32 v7, a51
    v_accvgpr_read_b32 v8, a52
    v_accvgpr_read_b32 v9, a53
    v_accvgpr_read_b32 v10, a54
    v_accvgpr_read_b32 v11, a55
    v_pk_mul_f32 v[4:5], v[4:5], s[60:61]
    v_pk_mul_f32 v[6:7], v[6:7], s[60:61]
    v_pk_mul_f32 v[8:9], v[8:9], s[60:61]
    v_pk_mul_f32 v[10:11], v[10:11], s[60:61]
    v_cvt_pk_bf16_f32 v12, v4, v5
    v_cvt_pk_bf16_f32 v13, v6, v7
    v_cvt_pk_bf16_f32 v14, v8, v9
    v_cvt_pk_bf16_f32 v15, v10, v11
    buffer_store_dwordx4 v[12:15], v1, s[32:35], s69 offen offset:2048 sc1
    v_pk_mul_f32 v[4:5], v[208:209], s[64:65]
    v_pk_mul_f32 v[6:7], v[210:211], s[64:65]
    v_pk_mul_f32 v[8:9], v[212:213], s[64:65]
    v_pk_mul_f32 v[10:11], v[214:215], s[64:65]
    v_exp_f32 v4, v4
    v_exp_f32 v5, v5
    v_exp_f32 v6, v6
    v_exp_f32 v7, v7
    v_exp_f32 v8, v8
    v_exp_f32 v9, v9
    v_exp_f32 v10, v10
    v_exp_f32 v11, v11
    v_pk_mul_f32 v[216:217], v[208:209], v[216:217]
    v_pk_mul_f32 v[218:219], v[210:211], v[218:219]
    v_pk_mul_f32 v[220:221], v[212:213], v[220:221]
    v_pk_mul_f32 v[222:223], v[214:215], v[222:223]
    v_pk_add_f32 v[4:5], v[4:5], 1.0 op_sel_hi:[1,0]
    v_pk_add_f32 v[6:7], v[6:7], 1.0 op_sel_hi:[1,0]
    v_pk_add_f32 v[8:9], v[8:9], 1.0 op_sel_hi:[1,0]
    v_pk_add_f32 v[10:11], v[10:11], 1.0 op_sel_hi:[1,0]
    v_rcp_f32 v4, v4
    v_rcp_f32 v5, v5
    v_rcp_f32 v6, v6
    v_rcp_f32 v7, v7
    v_rcp_f32 v8, v8
    v_rcp_f32 v9, v9
    v_rcp_f32 v10, v10
    v_rcp_f32 v11, v11
    v_pk_mul_f32 v[216:217], v[216:217], v[4:5]
    v_pk_mul_f32 v[218:219], v[218:219], v[6:7]
    v_pk_mul_f32 v[220:221], v[220:221], v[8:9]
    v_pk_mul_f32 v[222:223], v[222:223], v[10:11]
    v_cvt_pk_bf16_f32 v208, v216, v217
    v_cvt_pk_bf16_f32 v209, v218, v219
    v_cvt_pk_bf16_f32 v210, v220, v221
    v_cvt_pk_bf16_f32 v211, v222, v223
    buffer_store_dwordx4 v[208:211], v1, s[32:35], s70 offen offset:2048 sc1
    v_pk_mul_f32 v[4:5], v[224:225], s[64:65]
    v_pk_mul_f32 v[6:7], v[226:227], s[64:65]
    v_pk_mul_f32 v[8:9], v[228:229], s[64:65]
    v_pk_mul_f32 v[10:11], v[230:231], s[64:65]
    v_exp_f32 v4, v4
    v_exp_f32 v5, v5
    v_exp_f32 v6, v6
    v_exp_f32 v7, v7
    v_exp_f32 v8, v8
    v_exp_f32 v9, v9
    v_exp_f32 v10, v10
    v_exp_f32 v11, v11
    v_pk_mul_f32 v[232:233], v[224:225], v[232:233]
    v_pk_mul_f32 v[234:235], v[226:227], v[234:235]
    v_pk_mul_f32 v[236:237], v[228:229], v[236:237]
    v_pk_mul_f32 v[238:239], v[230:231], v[238:239]
    v_pk_add_f32 v[4:5], v[4:5], 1.0 op_sel_hi:[1,0]
    v_pk_add_f32 v[6:7], v[6:7], 1.0 op_sel_hi:[1,0]
    v_pk_add_f32 v[8:9], v[8:9], 1.0 op_sel_hi:[1,0]
    v_pk_add_f32 v[10:11], v[10:11], 1.0 op_sel_hi:[1,0]
    v_rcp_f32 v4, v4
    v_rcp_f32 v5, v5
    v_rcp_f32 v6, v6
    v_rcp_f32 v7, v7
    v_rcp_f32 v8, v8
    v_rcp_f32 v9, v9
    v_rcp_f32 v10, v10
    v_rcp_f32 v11, v11
    v_pk_mul_f32 v[232:233], v[232:233], v[4:5]
    v_pk_mul_f32 v[234:235], v[234:235], v[6:7]
    v_pk_mul_f32 v[236:237], v[236:237], v[8:9]
    v_pk_mul_f32 v[238:239], v[238:239], v[10:11]
    v_cvt_pk_bf16_f32 v224, v232, v233
    v_cvt_pk_bf16_f32 v225, v234, v235
    v_cvt_pk_bf16_f32 v226, v236, v237
    v_cvt_pk_bf16_f32 v227, v238, v239
    buffer_store_dwordx4 v[224:227], v1, s[32:35], s62 offen offset:2048 sc1
    v_accvgpr_read_b32 v4, a56
    v_accvgpr_read_b32 v5, a57
    v_accvgpr_read_b32 v6, a58
    v_accvgpr_read_b32 v7, a59
    v_accvgpr_read_b32 v8, a60
    v_accvgpr_read_b32 v9, a61
    v_accvgpr_read_b32 v10, a62
    v_accvgpr_read_b32 v11, a63
    v_pk_mul_f32 v[4:5], v[4:5], s[60:61]
    v_pk_mul_f32 v[6:7], v[6:7], s[60:61]
    v_pk_mul_f32 v[8:9], v[8:9], s[60:61]
    v_pk_mul_f32 v[10:11], v[10:11], s[60:61]
    v_cvt_pk_bf16_f32 v12, v4, v5
    v_cvt_pk_bf16_f32 v13, v6, v7
    v_cvt_pk_bf16_f32 v14, v8, v9
    v_cvt_pk_bf16_f32 v15, v10, v11
    buffer_store_dwordx4 v[12:15], v1, s[32:35], s69 offen offset:3072 sc1
    v_pk_mul_f32 v[4:5], v[240:241], s[64:65]
    v_pk_mul_f32 v[6:7], v[242:243], s[64:65]
    v_pk_mul_f32 v[8:9], v[244:245], s[64:65]
    v_pk_mul_f32 v[10:11], v[246:247], s[64:65]
    v_exp_f32 v4, v4
    v_exp_f32 v5, v5
    v_exp_f32 v6, v6
    v_exp_f32 v7, v7
    v_exp_f32 v8, v8
    v_exp_f32 v9, v9
    v_exp_f32 v10, v10
    v_exp_f32 v11, v11
    v_pk_mul_f32 v[248:249], v[240:241], v[248:249]
    v_pk_mul_f32 v[250:251], v[242:243], v[250:251]
    v_pk_mul_f32 v[252:253], v[244:245], v[252:253]
    v_pk_mul_f32 v[254:255], v[246:247], v[254:255]
    v_pk_add_f32 v[4:5], v[4:5], 1.0 op_sel_hi:[1,0]
    v_pk_add_f32 v[6:7], v[6:7], 1.0 op_sel_hi:[1,0]
    v_pk_add_f32 v[8:9], v[8:9], 1.0 op_sel_hi:[1,0]
    v_pk_add_f32 v[10:11], v[10:11], 1.0 op_sel_hi:[1,0]
    v_rcp_f32 v4, v4
    v_rcp_f32 v5, v5
    v_rcp_f32 v6, v6
    v_rcp_f32 v7, v7
    v_rcp_f32 v8, v8
    v_rcp_f32 v9, v9
    v_rcp_f32 v10, v10
    v_rcp_f32 v11, v11
    v_pk_mul_f32 v[248:249], v[248:249], v[4:5]
    v_pk_mul_f32 v[250:251], v[250:251], v[6:7]
    v_pk_mul_f32 v[252:253], v[252:253], v[8:9]
    v_pk_mul_f32 v[254:255], v[254:255], v[10:11]
    v_cvt_pk_bf16_f32 v240, v248, v249
    v_cvt_pk_bf16_f32 v241, v250, v251
    v_cvt_pk_bf16_f32 v242, v252, v253
    v_cvt_pk_bf16_f32 v243, v254, v255
    buffer_store_dwordx4 v[240:243], v1, s[32:35], s70 offen offset:3072 sc1
    v_accvgpr_read_b32 v32, a64
    v_accvgpr_read_b32 v33, a65
    v_accvgpr_read_b32 v34, a66
    v_accvgpr_read_b32 v35, a67
    v_accvgpr_read_b32 v36, a68
    v_accvgpr_read_b32 v37, a69
    v_accvgpr_read_b32 v38, a70
    v_accvgpr_read_b32 v39, a71
    v_accvgpr_read_b32 v40, a72
    v_accvgpr_read_b32 v41, a73
    v_accvgpr_read_b32 v42, a74
    v_accvgpr_read_b32 v43, a75
    v_accvgpr_read_b32 v44, a76
    v_accvgpr_read_b32 v45, a77
    v_accvgpr_read_b32 v46, a78
    v_accvgpr_read_b32 v47, a79
    v_pk_mul_f32 v[4:5], v[32:33], s[64:65]
    v_pk_mul_f32 v[6:7], v[34:35], s[64:65]
    v_pk_mul_f32 v[8:9], v[36:37], s[64:65]
    v_pk_mul_f32 v[10:11], v[38:39], s[64:65]
    v_exp_f32 v4, v4
    v_exp_f32 v5, v5
    v_exp_f32 v6, v6
    v_exp_f32 v7, v7
    v_exp_f32 v8, v8
    v_exp_f32 v9, v9
    v_exp_f32 v10, v10
    v_exp_f32 v11, v11
    v_pk_mul_f32 v[40:41], v[32:33], v[40:41]
    v_pk_mul_f32 v[42:43], v[34:35], v[42:43]
    v_pk_mul_f32 v[44:45], v[36:37], v[44:45]
    v_pk_mul_f32 v[46:47], v[38:39], v[46:47]
    v_pk_add_f32 v[4:5], v[4:5], 1.0 op_sel_hi:[1,0]
    v_pk_add_f32 v[6:7], v[6:7], 1.0 op_sel_hi:[1,0]
    v_pk_add_f32 v[8:9], v[8:9], 1.0 op_sel_hi:[1,0]
    v_pk_add_f32 v[10:11], v[10:11], 1.0 op_sel_hi:[1,0]
    v_rcp_f32 v4, v4
    v_rcp_f32 v5, v5
    v_rcp_f32 v6, v6
    v_rcp_f32 v7, v7
    v_rcp_f32 v8, v8
    v_rcp_f32 v9, v9
    v_rcp_f32 v10, v10
    v_rcp_f32 v11, v11
    v_pk_mul_f32 v[40:41], v[40:41], v[4:5]
    v_pk_mul_f32 v[42:43], v[42:43], v[6:7]
    v_pk_mul_f32 v[44:45], v[44:45], v[8:9]
    v_pk_mul_f32 v[46:47], v[46:47], v[10:11]
    v_cvt_pk_bf16_f32 v32, v40, v41
    v_cvt_pk_bf16_f32 v33, v42, v43
    v_cvt_pk_bf16_f32 v34, v44, v45
    v_cvt_pk_bf16_f32 v35, v46, v47
    buffer_store_dwordx4 v[32:35], v1, s[32:35], s62 offen offset:3072 sc1
    s_branch L_gemm1_kernel_C
L_gemm1_kernel_B:
    v_mfma_f32_16x16x32_bf16 a[0:3], a[144:147], a[80:83], a[0:3]
    ds_read_b64_tr_b16 a[156:157], v6 offset:1024
    v_mfma_f32_16x16x32_bf16 a[8:11], a[144:147], a[84:87], a[8:11]
    v_mfma_f32_16x16x32_bf16 a[16:19], a[144:147], a[88:91], a[16:19]
    v_mfma_f32_16x16x32_bf16 a[24:27], a[144:147], a[92:95], a[24:27]
    v_mfma_f32_16x16x32_bf16 a[32:35], a[144:147], a[96:99], a[32:35]
    ds_read_b64_tr_b16 a[158:159], v6 offset:6144
    v_mfma_f32_16x16x32_bf16 a[40:43], a[144:147], a[100:103], a[40:43]
    v_mfma_f32_16x16x32_bf16 a[48:51], a[144:147], a[104:107], a[48:51]
    v_mfma_f32_16x16x32_bf16 a[56:59], a[144:147], a[108:111], a[56:59]
    v_mfma_f32_16x16x32_bf16 a[60:63], a[148:151], a[108:111], a[60:63]
    ds_read_b64_tr_b16 a[144:145], v4 offset:2048
    v_mfma_f32_16x16x32_bf16 a[52:55], a[148:151], a[104:107], a[52:55]
    v_mfma_f32_16x16x32_bf16 a[44:47], a[148:151], a[100:103], a[44:47]
    v_mfma_f32_16x16x32_bf16 a[36:39], a[148:151], a[96:99], a[36:39]
    v_mfma_f32_16x16x32_bf16 a[28:31], a[148:151], a[92:95], a[28:31]
    ds_read_b64_tr_b16 a[146:147], v4 offset:7168
    v_mfma_f32_16x16x32_bf16 a[20:23], a[148:151], a[88:91], a[20:23]
    v_mfma_f32_16x16x32_bf16 a[12:15], a[148:151], a[84:87], a[12:15]
    v_mfma_f32_16x16x32_bf16 a[4:7], a[148:151], a[80:83], a[4:7]
    s_waitcnt lgkmcnt(4)
    v_mfma_f32_16x16x32_bf16 v[16:19], a[152:155], a[80:83], v[16:19]
    ds_read_b64_tr_b16 a[148:149], v6 offset:2048
    v_mfma_f32_16x16x32_bf16 v[48:51], a[152:155], a[84:87], v[48:51]
    v_mfma_f32_16x16x32_bf16 v[80:83], a[152:155], a[88:91], v[80:83]
    v_mfma_f32_16x16x32_bf16 v[112:115], a[152:155], a[92:95], v[112:115]
    v_mfma_f32_16x16x32_bf16 v[144:147], a[152:155], a[96:99], v[144:147]
    ds_read_b64_tr_b16 a[150:151], v6 offset:7168
    v_mfma_f32_16x16x32_bf16 v[176:179], a[152:155], a[100:103], v[176:179]
    s_waitcnt vmcnt(9)
    v_mfma_f32_16x16x32_bf16 v[208:211], a[152:155], a[104:107], v[208:211]
    s_barrier
    v_mfma_f32_16x16x32_bf16 v[240:243], a[152:155], a[108:111], v[240:243]
    s_waitcnt lgkmcnt(4)
    v_mfma_f32_16x16x32_bf16 v[244:247], a[156:159], a[108:111], v[244:247]
    ds_read_b64_tr_b16 a[152:153], v4 offset:37888
    v_mfma_f32_16x16x32_bf16 v[212:215], a[156:159], a[104:107], v[212:215]
    ds_read_b128 a[112:115], v2 offset:36864
    v_mfma_f32_16x16x32_bf16 v[180:183], a[156:159], a[100:103], v[180:183]
    ds_read_b128 a[116:119], v2 offset:37888
    v_mfma_f32_16x16x32_bf16 v[148:151], a[156:159], a[96:99], v[148:151]
    ds_read_b128 a[120:123], v2 offset:38912
    v_mfma_f32_16x16x32_bf16 v[116:119], a[156:159], a[92:95], v[116:119]
    ds_read_b64_tr_b16 a[154:155], v4 offset:43008
    v_mfma_f32_16x16x32_bf16 v[84:87], a[156:159], a[88:91], v[84:87]
    ds_read_b128 a[124:127], v2 offset:39936
    v_mfma_f32_16x16x32_bf16 v[52:55], a[156:159], a[84:87], v[52:55]
    ds_read_b128 a[128:131], v2 offset:40960
    v_mfma_f32_16x16x32_bf16 v[20:23], a[156:159], a[80:83], v[20:23]
    ds_read_b128 a[132:135], v2 offset:41984
    s_waitcnt lgkmcnt(10)
    v_mfma_f32_16x16x32_bf16 v[24:27], a[144:147], a[80:83], v[24:27]
    ds_read_b64_tr_b16 a[156:157], v6 offset:37888
    v_mfma_f32_16x16x32_bf16 v[56:59], a[144:147], a[84:87], v[56:59]
    ds_read_b128 a[136:139], v2 offset:43008
    v_mfma_f32_16x16x32_bf16 v[88:91], a[144:147], a[88:91], v[88:91]
    ds_read_b128 a[140:143], v2 offset:44032
    v_mfma_f32_16x16x32_bf16 v[120:123], a[144:147], a[92:95], v[120:123]
    v_mfma_f32_16x16x32_bf16 v[152:155], a[144:147], a[96:99], v[152:155]
    ds_read_b64_tr_b16 a[158:159], v6 offset:43008
    v_lshlrev_b32 v1, 4, v0
    v_lshrrev_b32 v2, 4, v0
    v_mfma_f32_16x16x32_bf16 v[184:187], a[144:147], a[100:103], v[184:187]
    v_lshlrev_b32 v2, 6, v2
    s_lshl_b32 s67, s53, 4
    v_mfma_f32_16x16x32_bf16 v[216:219], a[144:147], a[104:107], v[216:219]
    s_lshl_b32 s66, s50, 3
    s_add_u32 s67, s67, s66
    v_mfma_f32_16x16x32_bf16 v[248:251], a[144:147], a[108:111], v[248:251]
    s_lshl_b32 s67, s67, 10
    s_add_u32 s67, s67, 4194304
    s_waitcnt lgkmcnt(12)
    v_mfma_f32_16x16x32_bf16 v[252:255], a[148:151], a[108:111], v[252:255]
    ds_read_b64_tr_b16 a[144:145], v4 offset:38912
    s_lshl_b32 s68, s53, 1
    s_add_u32 s68, s68, s50
    v_mfma_f32_16x16x32_bf16 v[220:223], a[148:151], a[104:107], v[220:223]
    s_mul_i32 s68, s68, 1179648
    s_add_u32 s68, s68, 16777216
    v_mfma_f32_16x16x32_bf16 v[188:191], a[148:151], a[100:103], v[188:191]
    s_mov_b32 s64, 3216550459
    s_mov_b32 s65, s64
    v_mfma_f32_16x16x32_bf16 v[156:159], a[148:151], a[96:99], v[156:159]
    s_lshl_b32 s66, s45, 1
    s_add_u32 s66, s66, s51
    v_mfma_f32_16x16x32_bf16 v[124:127], a[148:151], a[92:95], v[124:127]
    ds_read_b64_tr_b16 a[146:147], v4 offset:44032
    s_mul_i32 s66, s66, 131072
    s_add_u32 s69, s66, s67
    v_mfma_f32_16x16x32_bf16 v[92:95], a[148:151], a[88:91], v[92:95]
    s_lshl_b32 s66, s49, 1
    s_add_u32 s66, s66, s51
    v_mfma_f32_16x16x32_bf16 v[60:63], a[148:151], a[84:87], v[60:63]
    s_mul_i32 s66, s66, 8192
    s_add_u32 s62, s66, s68
    v_mfma_f32_16x16x32_bf16 v[28:31], a[148:151], a[80:83], v[28:31]
    s_cmp_lt_u32 s45, 16
    s_cselect_b32 s60, 1048744942, 1.0
    s_waitcnt lgkmcnt(9)
    v_mfma_f32_16x16x32_bf16 v[16:19], a[152:155], a[112:115], v[16:19]
    ds_read_b64_tr_b16 a[148:149], v6 offset:38912
    s_mov_b32 s61, s60
    v_xor_b32 v3, v2, v1
    v_mfma_f32_16x16x32_bf16 v[48:51], a[152:155], a[116:119], v[48:51]
    s_lshl_b32 s66, s46, 1
    s_add_u32 s66, s66, s51
    v_mfma_f32_16x16x32_bf16 v[80:83], a[152:155], a[120:123], v[80:83]
    s_mul_i32 s66, s66, 131072
    s_add_u32 s70, s66, s67
    s_waitcnt lgkmcnt(9)
    v_mfma_f32_16x16x32_bf16 v[112:115], a[152:155], a[124:127], v[112:115]
    s_lshl_b32 s66, s47, 1
    s_add_u32 s66, s66, s51
    s_waitcnt lgkmcnt(8)
    v_mfma_f32_16x16x32_bf16 v[144:147], a[152:155], a[128:131], v[144:147]
    ds_read_b64_tr_b16 a[150:151], v6 offset:44032
    s_mul_i32 s66, s66, 131072
    s_add_u32 s71, s66, s67
    s_waitcnt lgkmcnt(8)
    v_mfma_f32_16x16x32_bf16 v[176:179], a[152:155], a[132:135], v[176:179]
    s_add_u32 s70, s70, 4096
    s_add_u32 s71, s71, 4096
    s_waitcnt lgkmcnt(6)
    v_mfma_f32_16x16x32_bf16 v[208:211], a[152:155], a[136:139], v[208:211]
    s_waitcnt lgkmcnt(5)
    v_mfma_f32_16x16x32_bf16 v[240:243], a[152:155], a[140:143], v[240:243]
    s_waitcnt lgkmcnt(4)
    v_mfma_f32_16x16x32_bf16 v[244:247], a[156:159], a[140:143], v[244:247]
    ds_read_b64_tr_b16 a[152:153], v4 offset:36864
    v_mfma_f32_16x16x32_bf16 v[212:215], a[156:159], a[136:139], v[212:215]
    v_mfma_f32_16x16x32_bf16 v[180:183], a[156:159], a[132:135], v[180:183]
    v_mfma_f32_16x16x32_bf16 v[148:151], a[156:159], a[128:131], v[148:151]
    v_mfma_f32_16x16x32_bf16 v[116:119], a[156:159], a[124:127], v[116:119]
    ds_read_b64_tr_b16 a[154:155], v4 offset:41984
    v_mfma_f32_16x16x32_bf16 v[84:87], a[156:159], a[120:123], v[84:87]
    v_mfma_f32_16x16x32_bf16 v[52:55], a[156:159], a[116:119], v[52:55]
    v_cvt_pk_bf16_f32 v240, v240, v241
    v_cvt_pk_bf16_f32 v241, v242, v243
    v_mfma_f32_16x16x32_bf16 v[20:23], a[156:159], a[112:115], v[20:23]
    v_cvt_pk_bf16_f32 v242, v244, v245
    v_cvt_pk_bf16_f32 v243, v246, v247
    s_waitcnt lgkmcnt(4)
    v_mfma_f32_16x16x32_bf16 v[24:27], a[144:147], a[112:115], v[24:27]
    ds_read_b64_tr_b16 a[156:157], v6 offset:36864
    buffer_store_dwordx4 v[240:243], v3, s[32:35], s70 offen offset:3072 sc1
    v_mfma_f32_16x16x32_bf16 v[56:59], a[144:147], a[116:119], v[56:59]
    v_cvt_pk_bf16_f32 v208, v208, v209
    v_cvt_pk_bf16_f32 v209, v210, v211
    v_mfma_f32_16x16x32_bf16 v[88:91], a[144:147], a[120:123], v[88:91]
    v_cvt_pk_bf16_f32 v210, v212, v213
    v_cvt_pk_bf16_f32 v211, v214, v215
    v_mfma_f32_16x16x32_bf16 v[120:123], a[144:147], a[124:127], v[120:123]
    buffer_store_dwordx4 v[208:211], v3, s[32:35], s70 offen offset:2048 sc1
    v_mfma_f32_16x16x32_bf16 v[152:155], a[144:147], a[128:131], v[152:155]
    ds_read_b64_tr_b16 a[158:159], v6 offset:41984
    v_cvt_pk_bf16_f32 v176, v176, v177
    v_cvt_pk_bf16_f32 v177, v178, v179
    v_mfma_f32_16x16x32_bf16 v[184:187], a[144:147], a[132:135], v[184:187]
    v_cvt_pk_bf16_f32 v178, v180, v181
    v_cvt_pk_bf16_f32 v179, v182, v183
    v_mfma_f32_16x16x32_bf16 v[216:219], a[144:147], a[136:139], v[216:219]
    buffer_store_dwordx4 v[176:179], v3, s[32:35], s70 offen offset:1024 sc1
    v_mfma_f32_16x16x32_bf16 v[248:251], a[144:147], a[140:143], v[248:251]
    v_cvt_pk_bf16_f32 v144, v144, v145
    v_cvt_pk_bf16_f32 v145, v146, v147
    s_waitcnt lgkmcnt(4)
    v_mfma_f32_16x16x32_bf16 v[252:255], a[148:151], a[140:143], v[252:255]
    ds_read_b64_tr_b16 a[144:145], v4 offset:3072
    v_cvt_pk_bf16_f32 v146, v148, v149
    v_cvt_pk_bf16_f32 v147, v150, v151
    v_mfma_f32_16x16x32_bf16 v[220:223], a[148:151], a[136:139], v[220:223]
    buffer_store_dwordx4 v[144:147], v3, s[32:35], s70 offen offset:0 sc1
    v_mfma_f32_16x16x32_bf16 v[188:191], a[148:151], a[132:135], v[188:191]
    s_sub_u32 s70, s70, 4096
    v_cvt_pk_bf16_f32 v112, v112, v113
    v_cvt_pk_bf16_f32 v113, v114, v115
    v_mfma_f32_16x16x32_bf16 v[156:159], a[148:151], a[128:131], v[156:159]
    v_cvt_pk_bf16_f32 v114, v116, v117
    v_cvt_pk_bf16_f32 v115, v118, v119
    v_mfma_f32_16x16x32_bf16 v[124:127], a[148:151], a[124:127], v[124:127]
    ds_read_b64_tr_b16 a[146:147], v4 offset:8192
    buffer_store_dwordx4 v[112:115], v3, s[32:35], s70 offen offset:3072 sc1
    v_mfma_f32_16x16x32_bf16 v[92:95], a[148:151], a[120:123], v[92:95]
    v_cvt_pk_bf16_f32 v80, v80, v81
    v_cvt_pk_bf16_f32 v81, v82, v83
    v_mfma_f32_16x16x32_bf16 v[60:63], a[148:151], a[116:119], v[60:63]
    v_cvt_pk_bf16_f32 v82, v84, v85
    v_cvt_pk_bf16_f32 v83, v86, v87
    v_mfma_f32_16x16x32_bf16 v[28:31], a[148:151], a[112:115], v[28:31]
    buffer_store_dwordx4 v[80:83], v3, s[32:35], s70 offen offset:2048 sc1
    s_waitcnt lgkmcnt(4)
    v_mfma_f32_16x16x32_bf16 a[0:3], a[152:155], a[112:115], a[0:3]
    ds_read_b64_tr_b16 a[148:149], v6 offset:3072
    v_cvt_pk_bf16_f32 v48, v48, v49
    v_cvt_pk_bf16_f32 v49, v50, v51
    v_mfma_f32_16x16x32_bf16 a[8:11], a[152:155], a[116:119], a[8:11]
    v_cvt_pk_bf16_f32 v50, v52, v53
    v_cvt_pk_bf16_f32 v51, v54, v55
    v_mfma_f32_16x16x32_bf16 a[16:19], a[152:155], a[120:123], a[16:19]
    buffer_store_dwordx4 v[48:51], v3, s[32:35], s70 offen offset:1024 sc1
    v_mfma_f32_16x16x32_bf16 a[24:27], a[152:155], a[124:127], a[24:27]
    v_cvt_pk_bf16_f32 v16, v16, v17
    v_cvt_pk_bf16_f32 v17, v18, v19
    v_mfma_f32_16x16x32_bf16 a[32:35], a[152:155], a[128:131], a[32:35]
    ds_read_b64_tr_b16 a[150:151], v6 offset:8192
    v_cvt_pk_bf16_f32 v18, v20, v21
    v_cvt_pk_bf16_f32 v19, v22, v23
    v_mfma_f32_16x16x32_bf16 a[40:43], a[152:155], a[132:135], a[40:43]
    buffer_store_dwordx4 v[16:19], v3, s[32:35], s70 offen offset:0 sc1
    v_mfma_f32_16x16x32_bf16 a[48:51], a[152:155], a[136:139], a[48:51]
    v_cvt_pk_bf16_f32 v248, v248, v249
    v_cvt_pk_bf16_f32 v249, v250, v251
    v_mfma_f32_16x16x32_bf16 a[56:59], a[152:155], a[140:143], a[56:59]
    v_cvt_pk_bf16_f32 v250, v252, v253
    v_cvt_pk_bf16_f32 v251, v254, v255
    s_waitcnt lgkmcnt(4)
    v_mfma_f32_16x16x32_bf16 a[60:63], a[156:159], a[140:143], a[60:63]
    ds_read_b64_tr_b16 a[152:153], v4 offset:4096
    buffer_store_dwordx4 v[248:251], v3, s[32:35], s71 offen offset:3072 sc1
    v_mfma_f32_16x16x32_bf16 a[52:55], a[156:159], a[136:139], a[52:55]
    v_cvt_pk_bf16_f32 v216, v216, v217
    v_cvt_pk_bf16_f32 v217, v218, v219
    v_mfma_f32_16x16x32_bf16 a[44:47], a[156:159], a[132:135], a[44:47]
    v_cvt_pk_bf16_f32 v218, v220, v221
    v_cvt_pk_bf16_f32 v219, v222, v223
    v_mfma_f32_16x16x32_bf16 a[36:39], a[156:159], a[128:131], a[36:39]
    buffer_store_dwordx4 v[216:219], v3, s[32:35], s71 offen offset:2048 sc1
    v_mfma_f32_16x16x32_bf16 a[28:31], a[156:159], a[124:127], a[28:31]
    ds_read_b64_tr_b16 a[154:155], v4 offset:9216
    v_cvt_pk_bf16_f32 v184, v184, v185
    v_cvt_pk_bf16_f32 v185, v186, v187
    v_mfma_f32_16x16x32_bf16 a[20:23], a[156:159], a[120:123], a[20:23]
    v_cvt_pk_bf16_f32 v186, v188, v189
    v_cvt_pk_bf16_f32 v187, v190, v191
    v_mfma_f32_16x16x32_bf16 a[12:15], a[156:159], a[116:119], a[12:15]
    buffer_store_dwordx4 v[184:187], v3, s[32:35], s71 offen offset:1024 sc1
    v_mfma_f32_16x16x32_bf16 a[4:7], a[156:159], a[112:115], a[4:7]
    v_cvt_pk_bf16_f32 v152, v152, v153
    v_cvt_pk_bf16_f32 v153, v154, v155
    s_waitcnt lgkmcnt(4)
    v_mfma_f32_16x16x32_bf16 v[32:35], a[144:147], a[80:83], v[32:35]
    ds_read_b64_tr_b16 a[156:157], v6 offset:4096
    v_cvt_pk_bf16_f32 v154, v156, v157
    v_cvt_pk_bf16_f32 v155, v158, v159
    v_mfma_f32_16x16x32_bf16 v[64:67], a[144:147], a[84:87], v[64:67]
    buffer_store_dwordx4 v[152:155], v3, s[32:35], s71 offen offset:0 sc1
    v_mfma_f32_16x16x32_bf16 v[96:99], a[144:147], a[88:91], v[96:99]
    s_sub_u32 s71, s71, 4096
    v_cvt_pk_bf16_f32 v120, v120, v121
    v_cvt_pk_bf16_f32 v121, v122, v123
    v_mfma_f32_16x16x32_bf16 v[128:131], a[144:147], a[92:95], v[128:131]
    v_cvt_pk_bf16_f32 v122, v124, v125
    v_cvt_pk_bf16_f32 v123, v126, v127
    v_mfma_f32_16x16x32_bf16 v[160:163], a[144:147], a[96:99], v[160:163]
    ds_read_b64_tr_b16 a[158:159], v6 offset:9216
    buffer_store_dwordx4 v[120:123], v3, s[32:35], s71 offen offset:3072 sc1
    v_mfma_f32_16x16x32_bf16 v[192:195], a[144:147], a[100:103], v[192:195]
    v_cvt_pk_bf16_f32 v88, v88, v89
    v_cvt_pk_bf16_f32 v89, v90, v91
    v_mfma_f32_16x16x32_bf16 v[224:227], a[144:147], a[104:107], v[224:227]
    v_cvt_pk_bf16_f32 v90, v92, v93
    v_cvt_pk_bf16_f32 v91, v94, v95
    v_mfma_f32_16x16x32_bf16 a[64:67], a[144:147], a[108:111], a[64:67]
    buffer_store_dwordx4 v[88:91], v3, s[32:35], s71 offen offset:2048 sc1
    s_waitcnt lgkmcnt(4)
    v_mfma_f32_16x16x32_bf16 a[68:71], a[148:151], a[108:111], a[68:71]
    ds_read_b64_tr_b16 a[144:145], v4 offset:39936
    v_cvt_pk_bf16_f32 v56, v56, v57
    v_cvt_pk_bf16_f32 v57, v58, v59
    v_mfma_f32_16x16x32_bf16 v[228:231], a[148:151], a[104:107], v[228:231]
    v_cvt_pk_bf16_f32 v58, v60, v61
    v_cvt_pk_bf16_f32 v59, v62, v63
    v_mfma_f32_16x16x32_bf16 v[196:199], a[148:151], a[100:103], v[196:199]
    buffer_store_dwordx4 v[56:59], v3, s[32:35], s71 offen offset:1024 sc1
    v_mfma_f32_16x16x32_bf16 v[164:167], a[148:151], a[96:99], v[164:167]
    v_cvt_pk_bf16_f32 v24, v24, v25
    v_cvt_pk_bf16_f32 v25, v26, v27
    v_mfma_f32_16x16x32_bf16 v[132:135], a[148:151], a[92:95], v[132:135]
    ds_read_b64_tr_b16 a[146:147], v4 offset:45056
    v_cvt_pk_bf16_f32 v26, v28, v29
    v_cvt_pk_bf16_f32 v27, v30, v31
    v_mfma_f32_16x16x32_bf16 v[100:103], a[148:151], a[88:91], v[100:103]
    buffer_store_dwordx4 v[24:27], v3, s[32:35], s71 offen offset:0 sc1
    v_mfma_f32_16x16x32_bf16 v[68:71], a[148:151], a[84:87], v[68:71]
    v_accvgpr_read_b32 v8, a0
    v_accvgpr_read_b32 v9, a1
    v_mfma_f32_16x16x32_bf16 v[36:39], a[148:151], a[80:83], v[36:39]
    v_accvgpr_read_b32 v10, a2
    v_accvgpr_read_b32 v11, a3
    s_waitcnt lgkmcnt(4)
    v_mfma_f32_16x16x32_bf16 v[40:43], a[152:155], a[80:83], v[40:43]
    ds_read_b64_tr_b16 a[148:149], v6 offset:39936
    v_accvgpr_read_b32 v12, a4
    v_accvgpr_read_b32 v13, a5
    v_mfma_f32_16x16x32_bf16 v[72:75], a[152:155], a[84:87], v[72:75]
    v_accvgpr_read_b32 v14, a6
    v_accvgpr_read_b32 v15, a7
    v_mfma_f32_16x16x32_bf16 v[104:107], a[152:155], a[88:91], v[104:107]
    v_mul_f32 v8, s60, v8
    v_mul_f32 v9, s60, v9
    v_mfma_f32_16x16x32_bf16 v[136:139], a[152:155], a[92:95], v[136:139]
    v_mul_f32 v10, s60, v10
    v_mul_f32 v11, s60, v11
    v_mfma_f32_16x16x32_bf16 v[168:171], a[152:155], a[96:99], v[168:171]
    ds_read_b64_tr_b16 a[150:151], v6 offset:45056
    v_mul_f32 v12, s60, v12
    v_mul_f32 v13, s60, v13
    v_mfma_f32_16x16x32_bf16 v[200:203], a[152:155], a[100:103], v[200:203]
    v_mul_f32 v14, s60, v14
    v_mul_f32 v15, s60, v15
    v_mfma_f32_16x16x32_bf16 v[232:235], a[152:155], a[104:107], v[232:235]
    v_cvt_pk_bf16_f32 v8, v8, v9
    v_cvt_pk_bf16_f32 v9, v10, v11
    v_mfma_f32_16x16x32_bf16 a[72:75], a[152:155], a[108:111], a[72:75]
    v_cvt_pk_bf16_f32 v10, v12, v13
    v_cvt_pk_bf16_f32 v11, v14, v15
    s_waitcnt lgkmcnt(4)
    v_mfma_f32_16x16x32_bf16 a[76:79], a[156:159], a[108:111], a[76:79]
    ds_read_b64_tr_b16 a[152:153], v4 offset:40960
    buffer_store_dwordx4 v[8:11], v1, s[32:35], s69 offen offset:0 sc1
    v_mfma_f32_16x16x32_bf16 v[236:239], a[156:159], a[104:107], v[236:239]
    s_nop 0
    v_accvgpr_read_b32 v8, a8
    v_accvgpr_read_b32 v9, a9
    v_mfma_f32_16x16x32_bf16 v[204:207], a[156:159], a[100:103], v[204:207]
    v_accvgpr_read_b32 v10, a10
    v_accvgpr_read_b32 v11, a11
    v_mfma_f32_16x16x32_bf16 v[172:175], a[156:159], a[96:99], v[172:175]
    v_accvgpr_read_b32 v12, a12
    v_accvgpr_read_b32 v13, a13
    v_mfma_f32_16x16x32_bf16 v[140:143], a[156:159], a[92:95], v[140:143]
    ds_read_b64_tr_b16 a[154:155], v4 offset:46080
    v_accvgpr_read_b32 v14, a14
    v_accvgpr_read_b32 v15, a15
    v_mfma_f32_16x16x32_bf16 v[108:111], a[156:159], a[88:91], v[108:111]
    v_mul_f32 v8, s60, v8
    v_mul_f32 v9, s60, v9
    v_mfma_f32_16x16x32_bf16 v[76:79], a[156:159], a[84:87], v[76:79]
    v_mul_f32 v10, s60, v10
    v_mul_f32 v11, s60, v11
    v_mfma_f32_16x16x32_bf16 v[44:47], a[156:159], a[80:83], v[44:47]
    v_mul_f32 v12, s60, v12
    v_mul_f32 v13, s60, v13
    s_waitcnt lgkmcnt(4)
    v_mfma_f32_16x16x32_bf16 v[32:35], a[144:147], a[112:115], v[32:35]
    ds_read_b64_tr_b16 a[156:157], v6 offset:40960
    v_mul_f32 v14, s60, v14
    v_mul_f32 v15, s60, v15
    v_mfma_f32_16x16x32_bf16 v[64:67], a[144:147], a[116:119], v[64:67]
    v_cvt_pk_bf16_f32 v8, v8, v9
    v_cvt_pk_bf16_f32 v9, v10, v11
    v_mfma_f32_16x16x32_bf16 v[96:99], a[144:147], a[120:123], v[96:99]
    v_cvt_pk_bf16_f32 v10, v12, v13
    v_cvt_pk_bf16_f32 v11, v14, v15
    v_mfma_f32_16x16x32_bf16 v[128:131], a[144:147], a[124:127], v[128:131]
    buffer_store_dwordx4 v[8:11], v1, s[32:35], s69 offen offset:1024 sc1
    v_mfma_f32_16x16x32_bf16 v[160:163], a[144:147], a[128:131], v[160:163]
    ds_read_b64_tr_b16 a[158:159], v6 offset:46080
    v_accvgpr_read_b32 v8, a16
    v_accvgpr_read_b32 v9, a17
    v_mfma_f32_16x16x32_bf16 v[192:195], a[144:147], a[132:135], v[192:195]
    v_accvgpr_read_b32 v10, a18
    v_accvgpr_read_b32 v11, a19
    v_mfma_f32_16x16x32_bf16 v[224:227], a[144:147], a[136:139], v[224:227]
    v_accvgpr_read_b32 v12, a20
    v_accvgpr_read_b32 v13, a21
    v_mfma_f32_16x16x32_bf16 a[64:67], a[144:147], a[140:143], a[64:67]
    v_accvgpr_read_b32 v14, a22
    v_accvgpr_read_b32 v15, a23
    s_waitcnt lgkmcnt(4)
    v_mfma_f32_16x16x32_bf16 a[68:71], a[148:151], a[140:143], a[68:71]
    v_mul_f32 v8, s60, v8
    v_mul_f32 v9, s60, v9
    v_mfma_f32_16x16x32_bf16 v[228:231], a[148:151], a[136:139], v[228:231]
    v_mul_f32 v10, s60, v10
    v_mul_f32 v11, s60, v11
    v_mfma_f32_16x16x32_bf16 v[196:199], a[148:151], a[132:135], v[196:199]
    v_mul_f32 v12, s60, v12
    v_mul_f32 v13, s60, v13
    v_mfma_f32_16x16x32_bf16 v[164:167], a[148:151], a[128:131], v[164:167]
    v_mul_f32 v14, s60, v14
    v_mul_f32 v15, s60, v15
    v_mfma_f32_16x16x32_bf16 v[132:135], a[148:151], a[124:127], v[132:135]
    v_cvt_pk_bf16_f32 v8, v8, v9
    v_cvt_pk_bf16_f32 v9, v10, v11
    v_mfma_f32_16x16x32_bf16 v[100:103], a[148:151], a[120:123], v[100:103]
    v_cvt_pk_bf16_f32 v10, v12, v13
    v_cvt_pk_bf16_f32 v11, v14, v15
    v_mfma_f32_16x16x32_bf16 v[68:71], a[148:151], a[116:119], v[68:71]
    buffer_store_dwordx4 v[8:11], v1, s[32:35], s69 offen offset:2048 sc1
    v_mfma_f32_16x16x32_bf16 v[36:39], a[148:151], a[112:115], v[36:39]
    s_nop 0
    v_accvgpr_read_b32 v8, a24
    v_accvgpr_read_b32 v9, a25
    s_waitcnt lgkmcnt(2)
    v_mfma_f32_16x16x32_bf16 v[40:43], a[152:155], a[112:115], v[40:43]
    v_accvgpr_read_b32 v10, a26
    v_accvgpr_read_b32 v11, a27
    v_mfma_f32_16x16x32_bf16 v[72:75], a[152:155], a[116:119], v[72:75]
    v_accvgpr_read_b32 v12, a28
    v_accvgpr_read_b32 v13, a29
    v_mfma_f32_16x16x32_bf16 v[104:107], a[152:155], a[120:123], v[104:107]
    v_accvgpr_read_b32 v14, a30
    v_accvgpr_read_b32 v15, a31
    v_mfma_f32_16x16x32_bf16 v[136:139], a[152:155], a[124:127], v[136:139]
    v_mul_f32 v8, s60, v8
    v_mul_f32 v9, s60, v9
    v_mfma_f32_16x16x32_bf16 v[168:171], a[152:155], a[128:131], v[168:171]
    v_mul_f32 v10, s60, v10
    v_mul_f32 v11, s60, v11
    v_mfma_f32_16x16x32_bf16 v[200:203], a[152:155], a[132:135], v[200:203]
    v_mul_f32 v12, s60, v12
    v_mul_f32 v13, s60, v13
    v_mfma_f32_16x16x32_bf16 v[232:235], a[152:155], a[136:139], v[232:235]
    v_mul_f32 v14, s60, v14
    v_mul_f32 v15, s60, v15
    v_mfma_f32_16x16x32_bf16 a[72:75], a[152:155], a[140:143], a[72:75]
    v_cvt_pk_bf16_f32 v8, v8, v9
    v_cvt_pk_bf16_f32 v9, v10, v11
    s_waitcnt lgkmcnt(0)
    v_mfma_f32_16x16x32_bf16 a[76:79], a[156:159], a[140:143], a[76:79]
    v_cvt_pk_bf16_f32 v10, v12, v13
    v_cvt_pk_bf16_f32 v11, v14, v15
    v_mfma_f32_16x16x32_bf16 v[236:239], a[156:159], a[136:139], v[236:239]
    buffer_store_dwordx4 v[8:11], v1, s[32:35], s69 offen offset:3072 sc1
    v_mfma_f32_16x16x32_bf16 v[204:207], a[156:159], a[132:135], v[204:207]
    v_mfma_f32_16x16x32_bf16 v[172:175], a[156:159], a[128:131], v[172:175]
    v_mfma_f32_16x16x32_bf16 v[140:143], a[156:159], a[124:127], v[140:143]
    v_mfma_f32_16x16x32_bf16 v[108:111], a[156:159], a[120:123], v[108:111]
    v_mfma_f32_16x16x32_bf16 v[76:79], a[156:159], a[116:119], v[76:79]
    v_mfma_f32_16x16x32_bf16 v[44:47], a[156:159], a[112:115], v[44:47]
    v_pk_mul_f32 v[4:5], v[32:33], s[64:65]
    v_pk_mul_f32 v[6:7], v[34:35], s[64:65]
    v_pk_mul_f32 v[8:9], v[36:37], s[64:65]
    v_pk_mul_f32 v[10:11], v[38:39], s[64:65]
    v_exp_f32 v4, v4
    v_exp_f32 v5, v5
    v_exp_f32 v6, v6
    v_exp_f32 v7, v7
    v_exp_f32 v8, v8
    v_exp_f32 v9, v9
    v_exp_f32 v10, v10
    v_exp_f32 v11, v11
    v_pk_mul_f32 v[40:41], v[32:33], v[40:41]
    v_pk_mul_f32 v[42:43], v[34:35], v[42:43]
    v_pk_mul_f32 v[44:45], v[36:37], v[44:45]
    v_pk_mul_f32 v[46:47], v[38:39], v[46:47]
    v_pk_add_f32 v[4:5], v[4:5], 1.0 op_sel_hi:[1,0]
    v_pk_add_f32 v[6:7], v[6:7], 1.0 op_sel_hi:[1,0]
    v_pk_add_f32 v[8:9], v[8:9], 1.0 op_sel_hi:[1,0]
    v_pk_add_f32 v[10:11], v[10:11], 1.0 op_sel_hi:[1,0]
    v_rcp_f32 v4, v4
    v_rcp_f32 v5, v5
    v_rcp_f32 v6, v6
    v_rcp_f32 v7, v7
    v_rcp_f32 v8, v8
    v_rcp_f32 v9, v9
    v_rcp_f32 v10, v10
    v_rcp_f32 v11, v11
    v_pk_mul_f32 v[40:41], v[40:41], v[4:5]
    v_pk_mul_f32 v[42:43], v[42:43], v[6:7]
    v_pk_mul_f32 v[44:45], v[44:45], v[8:9]
    v_pk_mul_f32 v[46:47], v[46:47], v[10:11]
    v_cvt_pk_bf16_f32 v32, v40, v41
    v_cvt_pk_bf16_f32 v33, v42, v43
    v_cvt_pk_bf16_f32 v34, v44, v45
    v_cvt_pk_bf16_f32 v35, v46, v47
    buffer_store_dwordx4 v[32:35], v1, s[32:35], s62 offen offset:0 sc1
    v_pk_mul_f32 v[4:5], v[64:65], s[64:65]
    v_pk_mul_f32 v[6:7], v[66:67], s[64:65]
    v_pk_mul_f32 v[8:9], v[68:69], s[64:65]
    v_pk_mul_f32 v[10:11], v[70:71], s[64:65]
    v_exp_f32 v4, v4
    v_exp_f32 v5, v5
    v_exp_f32 v6, v6
    v_exp_f32 v7, v7
    v_exp_f32 v8, v8
    v_exp_f32 v9, v9
    v_exp_f32 v10, v10
    v_exp_f32 v11, v11
    v_pk_mul_f32 v[72:73], v[64:65], v[72:73]
    v_pk_mul_f32 v[74:75], v[66:67], v[74:75]
    v_pk_mul_f32 v[76:77], v[68:69], v[76:77]
    v_pk_mul_f32 v[78:79], v[70:71], v[78:79]
    v_pk_add_f32 v[4:5], v[4:5], 1.0 op_sel_hi:[1,0]
    v_pk_add_f32 v[6:7], v[6:7], 1.0 op_sel_hi:[1,0]
    v_pk_add_f32 v[8:9], v[8:9], 1.0 op_sel_hi:[1,0]
    v_pk_add_f32 v[10:11], v[10:11], 1.0 op_sel_hi:[1,0]
    v_rcp_f32 v4, v4
    v_rcp_f32 v5, v5
    v_rcp_f32 v6, v6
    v_rcp_f32 v7, v7
    v_rcp_f32 v8, v8
    v_rcp_f32 v9, v9
    v_rcp_f32 v10, v10
    v_rcp_f32 v11, v11
    v_pk_mul_f32 v[72:73], v[72:73], v[4:5]
    v_pk_mul_f32 v[74:75], v[74:75], v[6:7]
    v_pk_mul_f32 v[76:77], v[76:77], v[8:9]
    v_pk_mul_f32 v[78:79], v[78:79], v[10:11]
    v_cvt_pk_bf16_f32 v64, v72, v73
    v_cvt_pk_bf16_f32 v65, v74, v75
    v_cvt_pk_bf16_f32 v66, v76, v77
    v_cvt_pk_bf16_f32 v67, v78, v79
    buffer_store_dwordx4 v[64:67], v1, s[32:35], s62 offen offset:1024 sc1
    v_pk_mul_f32 v[4:5], v[96:97], s[64:65]
    v_pk_mul_f32 v[6:7], v[98:99], s[64:65]
    v_pk_mul_f32 v[8:9], v[100:101], s[64:65]
    v_pk_mul_f32 v[10:11], v[102:103], s[64:65]
    v_exp_f32 v4, v4
    v_exp_f32 v5, v5
    v_exp_f32 v6, v6
    v_exp_f32 v7, v7
    v_exp_f32 v8, v8
    v_exp_f32 v9, v9
    v_exp_f32 v10, v10
    v_exp_f32 v11, v11
    v_pk_mul_f32 v[104:105], v[96:97], v[104:105]
    v_pk_mul_f32 v[106:107], v[98:99], v[106:107]
    v_pk_mul_f32 v[108:109], v[100:101], v[108:109]
    v_pk_mul_f32 v[110:111], v[102:103], v[110:111]
    v_pk_add_f32 v[4:5], v[4:5], 1.0 op_sel_hi:[1,0]
    v_pk_add_f32 v[6:7], v[6:7], 1.0 op_sel_hi:[1,0]
    v_pk_add_f32 v[8:9], v[8:9], 1.0 op_sel_hi:[1,0]
    v_pk_add_f32 v[10:11], v[10:11], 1.0 op_sel_hi:[1,0]
    v_rcp_f32 v4, v4
    v_rcp_f32 v5, v5
    v_rcp_f32 v6, v6
    v_rcp_f32 v7, v7
    v_rcp_f32 v8, v8
    v_rcp_f32 v9, v9
    v_rcp_f32 v10, v10
    v_rcp_f32 v11, v11
    v_pk_mul_f32 v[104:105], v[104:105], v[4:5]
    v_pk_mul_f32 v[106:107], v[106:107], v[6:7]
    v_pk_mul_f32 v[108:109], v[108:109], v[8:9]
    v_pk_mul_f32 v[110:111], v[110:111], v[10:11]
    v_cvt_pk_bf16_f32 v96, v104, v105
    v_cvt_pk_bf16_f32 v97, v106, v107
    v_cvt_pk_bf16_f32 v98, v108, v109
    v_cvt_pk_bf16_f32 v99, v110, v111
    buffer_store_dwordx4 v[96:99], v1, s[32:35], s62 offen offset:2048 sc1
    v_pk_mul_f32 v[4:5], v[128:129], s[64:65]
    v_pk_mul_f32 v[6:7], v[130:131], s[64:65]
    v_pk_mul_f32 v[8:9], v[132:133], s[64:65]
    v_pk_mul_f32 v[10:11], v[134:135], s[64:65]
    v_exp_f32 v4, v4
    v_exp_f32 v5, v5
    v_exp_f32 v6, v6
    v_exp_f32 v7, v7
    v_exp_f32 v8, v8
    v_exp_f32 v9, v9
    v_exp_f32 v10, v10
    v_exp_f32 v11, v11
    v_pk_mul_f32 v[136:137], v[128:129], v[136:137]
    v_pk_mul_f32 v[138:139], v[130:131], v[138:139]
    v_pk_mul_f32 v[140:141], v[132:133], v[140:141]
    v_pk_mul_f32 v[142:143], v[134:135], v[142:143]
    v_pk_add_f32 v[4:5], v[4:5], 1.0 op_sel_hi:[1,0]
    v_pk_add_f32 v[6:7], v[6:7], 1.0 op_sel_hi:[1,0]
    v_pk_add_f32 v[8:9], v[8:9], 1.0 op_sel_hi:[1,0]
    v_pk_add_f32 v[10:11], v[10:11], 1.0 op_sel_hi:[1,0]
    v_rcp_f32 v4, v4
    v_rcp_f32 v5, v5
    v_rcp_f32 v6, v6
    v_rcp_f32 v7, v7
    v_rcp_f32 v8, v8
    v_rcp_f32 v9, v9
    v_rcp_f32 v10, v10
    v_rcp_f32 v11, v11
    v_pk_mul_f32 v[136:137], v[136:137], v[4:5]
    v_pk_mul_f32 v[138:139], v[138:139], v[6:7]
    v_pk_mul_f32 v[140:141], v[140:141], v[8:9]
    v_pk_mul_f32 v[142:143], v[142:143], v[10:11]
    v_cvt_pk_bf16_f32 v128, v136, v137
    v_cvt_pk_bf16_f32 v129, v138, v139
    v_cvt_pk_bf16_f32 v130, v140, v141
    v_cvt_pk_bf16_f32 v131, v142, v143
    buffer_store_dwordx4 v[128:131], v1, s[32:35], s62 offen offset:3072 sc1
    s_add_u32 s69, s69, 4096
    s_add_u32 s62, s62, 4096
    v_accvgpr_read_b32 v4, a32
    v_accvgpr_read_b32 v5, a33
    v_accvgpr_read_b32 v6, a34
    v_accvgpr_read_b32 v7, a35
    v_accvgpr_read_b32 v8, a36
    v_accvgpr_read_b32 v9, a37
    v_accvgpr_read_b32 v10, a38
    v_accvgpr_read_b32 v11, a39
    v_pk_mul_f32 v[4:5], v[4:5], s[60:61]
    v_pk_mul_f32 v[6:7], v[6:7], s[60:61]
    v_pk_mul_f32 v[8:9], v[8:9], s[60:61]
    v_pk_mul_f32 v[10:11], v[10:11], s[60:61]
    v_cvt_pk_bf16_f32 v12, v4, v5
    v_cvt_pk_bf16_f32 v13, v6, v7
    v_cvt_pk_bf16_f32 v14, v8, v9
    v_cvt_pk_bf16_f32 v15, v10, v11
    buffer_store_dwordx4 v[12:15], v1, s[32:35], s69 offen offset:0 sc1
    v_pk_mul_f32 v[4:5], v[160:161], s[64:65]
    v_pk_mul_f32 v[6:7], v[162:163], s[64:65]
    v_pk_mul_f32 v[8:9], v[164:165], s[64:65]
    v_pk_mul_f32 v[10:11], v[166:167], s[64:65]
    v_exp_f32 v4, v4
    v_exp_f32 v5, v5
    v_exp_f32 v6, v6
    v_exp_f32 v7, v7
    v_exp_f32 v8, v8
    v_exp_f32 v9, v9
    v_exp_f32 v10, v10
    v_exp_f32 v11, v11
    v_pk_mul_f32 v[168:169], v[160:161], v[168:169]
    v_pk_mul_f32 v[170:171], v[162:163], v[170:171]
    v_pk_mul_f32 v[172:173], v[164:165], v[172:173]
    v_pk_mul_f32 v[174:175], v[166:167], v[174:175]
    v_pk_add_f32 v[4:5], v[4:5], 1.0 op_sel_hi:[1,0]
    v_pk_add_f32 v[6:7], v[6:7], 1.0 op_sel_hi:[1,0]
    v_pk_add_f32 v[8:9], v[8:9], 1.0 op_sel_hi:[1,0]
    v_pk_add_f32 v[10:11], v[10:11], 1.0 op_sel_hi:[1,0]
    v_rcp_f32 v4, v4
    v_rcp_f32 v5, v5
    v_rcp_f32 v6, v6
    v_rcp_f32 v7, v7
    v_rcp_f32 v8, v8
    v_rcp_f32 v9, v9
    v_rcp_f32 v10, v10
    v_rcp_f32 v11, v11
    v_pk_mul_f32 v[168:169], v[168:169], v[4:5]
    v_pk_mul_f32 v[170:171], v[170:171], v[6:7]
    v_pk_mul_f32 v[172:173], v[172:173], v[8:9]
    v_pk_mul_f32 v[174:175], v[174:175], v[10:11]
    v_cvt_pk_bf16_f32 v160, v168, v169
    v_cvt_pk_bf16_f32 v161, v170, v171
    v_cvt_pk_bf16_f32 v162, v172, v173
    v_cvt_pk_bf16_f32 v163, v174, v175
    buffer_store_dwordx4 v[160:163], v1, s[32:35], s62 offen offset:0 sc1
    v_accvgpr_read_b32 v4, a40
    v_accvgpr_read_b32 v5, a41
    v_accvgpr_read_b32 v6, a42
    v_accvgpr_read_b32 v7, a43
    v_accvgpr_read_b32 v8, a44
    v_accvgpr_read_b32 v9, a45
    v_accvgpr_read_b32 v10, a46
    v_accvgpr_read_b32 v11, a47
    v_pk_mul_f32 v[4:5], v[4:5], s[60:61]
    v_pk_mul_f32 v[6:7], v[6:7], s[60:61]
    v_pk_mul_f32 v[8:9], v[8:9], s[60:61]
    v_pk_mul_f32 v[10:11], v[10:11], s[60:61]
    v_cvt_pk_bf16_f32 v12, v4, v5
    v_cvt_pk_bf16_f32 v13, v6, v7
    v_cvt_pk_bf16_f32 v14, v8, v9
    v_cvt_pk_bf16_f32 v15, v10, v11
    buffer_store_dwordx4 v[12:15], v1, s[32:35], s69 offen offset:1024 sc1
    v_pk_mul_f32 v[4:5], v[192:193], s[64:65]
    v_pk_mul_f32 v[6:7], v[194:195], s[64:65]
    v_pk_mul_f32 v[8:9], v[196:197], s[64:65]
    v_pk_mul_f32 v[10:11], v[198:199], s[64:65]
    v_exp_f32 v4, v4
    v_exp_f32 v5, v5
    v_exp_f32 v6, v6
    v_exp_f32 v7, v7
    v_exp_f32 v8, v8
    v_exp_f32 v9, v9
    v_exp_f32 v10, v10
    v_exp_f32 v11, v11
    v_pk_mul_f32 v[200:201], v[192:193], v[200:201]
    v_pk_mul_f32 v[202:203], v[194:195], v[202:203]
    v_pk_mul_f32 v[204:205], v[196:197], v[204:205]
    v_pk_mul_f32 v[206:207], v[198:199], v[206:207]
    v_pk_add_f32 v[4:5], v[4:5], 1.0 op_sel_hi:[1,0]
    v_pk_add_f32 v[6:7], v[6:7], 1.0 op_sel_hi:[1,0]
    v_pk_add_f32 v[8:9], v[8:9], 1.0 op_sel_hi:[1,0]
    v_pk_add_f32 v[10:11], v[10:11], 1.0 op_sel_hi:[1,0]
    v_rcp_f32 v4, v4
    v_rcp_f32 v5, v5
    v_rcp_f32 v6, v6
    v_rcp_f32 v7, v7
    v_rcp_f32 v8, v8
    v_rcp_f32 v9, v9
    v_rcp_f32 v10, v10
    v_rcp_f32 v11, v11
    v_pk_mul_f32 v[200:201], v[200:201], v[4:5]
    v_pk_mul_f32 v[202:203], v[202:203], v[6:7]
    v_pk_mul_f32 v[204:205], v[204:205], v[8:9]
    v_pk_mul_f32 v[206:207], v[206:207], v[10:11]
    v_cvt_pk_bf16_f32 v192, v200, v201
    v_cvt_pk_bf16_f32 v193, v202, v203
    v_cvt_pk_bf16_f32 v194, v204, v205
    v_cvt_pk_bf16_f32 v195, v206, v207
    buffer_store_dwordx4 v[192:195], v1, s[32:35], s62 offen offset:1024 sc1
    v_accvgpr_read_b32 v4, a48
    v_accvgpr_read_b32 v5, a49
    v_accvgpr_read_b32 v6, a50
    v_accvgpr_read_b32 v7, a51
    v_accvgpr_read_b32 v8, a52
    v_accvgpr_read_b32 v9, a53
    v_accvgpr_read_b32 v10, a54
    v_accvgpr_read_b32 v11, a55
    v_pk_mul_f32 v[4:5], v[4:5], s[60:61]
    v_pk_mul_f32 v[6:7], v[6:7], s[60:61]
    v_pk_mul_f32 v[8:9], v[8:9], s[60:61]
    v_pk_mul_f32 v[10:11], v[10:11], s[60:61]
    v_cvt_pk_bf16_f32 v12, v4, v5
    v_cvt_pk_bf16_f32 v13, v6, v7
    v_cvt_pk_bf16_f32 v14, v8, v9
    v_cvt_pk_bf16_f32 v15, v10, v11
    buffer_store_dwordx4 v[12:15], v1, s[32:35], s69 offen offset:2048 sc1
    v_pk_mul_f32 v[4:5], v[224:225], s[64:65]
    v_pk_mul_f32 v[6:7], v[226:227], s[64:65]
    v_pk_mul_f32 v[8:9], v[228:229], s[64:65]
    v_pk_mul_f32 v[10:11], v[230:231], s[64:65]
    v_exp_f32 v4, v4
    v_exp_f32 v5, v5
    v_exp_f32 v6, v6
    v_exp_f32 v7, v7
    v_exp_f32 v8, v8
    v_exp_f32 v9, v9
    v_exp_f32 v10, v10
    v_exp_f32 v11, v11
    v_pk_mul_f32 v[232:233], v[224:225], v[232:233]
    v_pk_mul_f32 v[234:235], v[226:227], v[234:235]
    v_pk_mul_f32 v[236:237], v[228:229], v[236:237]
    v_pk_mul_f32 v[238:239], v[230:231], v[238:239]
    v_pk_add_f32 v[4:5], v[4:5], 1.0 op_sel_hi:[1,0]
    v_pk_add_f32 v[6:7], v[6:7], 1.0 op_sel_hi:[1,0]
    v_pk_add_f32 v[8:9], v[8:9], 1.0 op_sel_hi:[1,0]
    v_pk_add_f32 v[10:11], v[10:11], 1.0 op_sel_hi:[1,0]
    v_rcp_f32 v4, v4
    v_rcp_f32 v5, v5
    v_rcp_f32 v6, v6
    v_rcp_f32 v7, v7
    v_rcp_f32 v8, v8
    v_rcp_f32 v9, v9
    v_rcp_f32 v10, v10
    v_rcp_f32 v11, v11
    v_pk_mul_f32 v[232:233], v[232:233], v[4:5]
    v_pk_mul_f32 v[234:235], v[234:235], v[6:7]
    v_pk_mul_f32 v[236:237], v[236:237], v[8:9]
    v_pk_mul_f32 v[238:239], v[238:239], v[10:11]
    v_cvt_pk_bf16_f32 v224, v232, v233
    v_cvt_pk_bf16_f32 v225, v234, v235
    v_cvt_pk_bf16_f32 v226, v236, v237
    v_cvt_pk_bf16_f32 v227, v238, v239
    buffer_store_dwordx4 v[224:227], v1, s[32:35], s62 offen offset:2048 sc1
    v_accvgpr_read_b32 v4, a56
    v_accvgpr_read_b32 v5, a57
    v_accvgpr_read_b32 v6, a58
    v_accvgpr_read_b32 v7, a59
    v_accvgpr_read_b32 v8, a60
    v_accvgpr_read_b32 v9, a61
    v_accvgpr_read_b32 v10, a62
    v_accvgpr_read_b32 v11, a63
    v_pk_mul_f32 v[4:5], v[4:5], s[60:61]
    v_pk_mul_f32 v[6:7], v[6:7], s[60:61]
    v_pk_mul_f32 v[8:9], v[8:9], s[60:61]
    v_pk_mul_f32 v[10:11], v[10:11], s[60:61]
    v_cvt_pk_bf16_f32 v12, v4, v5
    v_cvt_pk_bf16_f32 v13, v6, v7
    v_cvt_pk_bf16_f32 v14, v8, v9
    v_cvt_pk_bf16_f32 v15, v10, v11
    buffer_store_dwordx4 v[12:15], v1, s[32:35], s69 offen offset:3072 sc1
    v_accvgpr_read_b32 v32, a64
    v_accvgpr_read_b32 v33, a65
    v_accvgpr_read_b32 v34, a66
    v_accvgpr_read_b32 v35, a67
    v_accvgpr_read_b32 v36, a68
    v_accvgpr_read_b32 v37, a69
    v_accvgpr_read_b32 v38, a70
    v_accvgpr_read_b32 v39, a71
    v_accvgpr_read_b32 v40, a72
    v_accvgpr_read_b32 v41, a73
    v_accvgpr_read_b32 v42, a74
    v_accvgpr_read_b32 v43, a75
    v_accvgpr_read_b32 v44, a76
    v_accvgpr_read_b32 v45, a77
    v_accvgpr_read_b32 v46, a78
    v_accvgpr_read_b32 v47, a79
    v_pk_mul_f32 v[4:5], v[32:33], s[64:65]
    v_pk_mul_f32 v[6:7], v[34:35], s[64:65]
    v_pk_mul_f32 v[8:9], v[36:37], s[64:65]
    v_pk_mul_f32 v[10:11], v[38:39], s[64:65]
    v_exp_f32 v4, v4
    v_exp_f32 v5, v5
    v_exp_f32 v6, v6
    v_exp_f32 v7, v7
    v_exp_f32 v8, v8
    v_exp_f32 v9, v9
    v_exp_f32 v10, v10
    v_exp_f32 v11, v11
    v_pk_mul_f32 v[40:41], v[32:33], v[40:41]
    v_pk_mul_f32 v[42:43], v[34:35], v[42:43]
    v_pk_mul_f32 v[44:45], v[36:37], v[44:45]
    v_pk_mul_f32 v[46:47], v[38:39], v[46:47]
    v_pk_add_f32 v[4:5], v[4:5], 1.0 op_sel_hi:[1,0]
    v_pk_add_f32 v[6:7], v[6:7], 1.0 op_sel_hi:[1,0]
    v_pk_add_f32 v[8:9], v[8:9], 1.0 op_sel_hi:[1,0]
    v_pk_add_f32 v[10:11], v[10:11], 1.0 op_sel_hi:[1,0]
    v_rcp_f32 v4, v4
    v_rcp_f32 v5, v5
    v_rcp_f32 v6, v6
    v_rcp_f32 v7, v7
    v_rcp_f32 v8, v8
    v_rcp_f32 v9, v9
    v_rcp_f32 v10, v10
    v_rcp_f32 v11, v11
    v_pk_mul_f32 v[40:41], v[40:41], v[4:5]
    v_pk_mul_f32 v[42:43], v[42:43], v[6:7]
    v_pk_mul_f32 v[44:45], v[44:45], v[8:9]
    v_pk_mul_f32 v[46:47], v[46:47], v[10:11]
    v_cvt_pk_bf16_f32 v32, v40, v41
    v_cvt_pk_bf16_f32 v33, v42, v43
    v_cvt_pk_bf16_f32 v34, v44, v45
    v_cvt_pk_bf16_f32 v35, v46, v47
    buffer_store_dwordx4 v[32:35], v1, s[32:35], s62 offen offset:3072 sc1
L_gemm1_kernel_C:
    s_endpgm
L_gemm1_kernel_end:
    s_endpgm
.globl k2_kernel
.p2align 12
.type k2_kernel,@function
k2_kernel:
    s_cmp_ge_u32 s2, 256
    s_cbranch_scc1 L_k2_kernel_end
    s_load_dwordx2 s[4:5], s[0:1], 0
    s_load_dwordx2 s[54:55], s[0:1], 16
    s_load_dwordx4 s[60:63], s[0:1], 48
    s_load_dwordx2 s[6:7], s[0:1], 72
    v_lshrrev_b32 v5, 6, v0
    v_and_b32 v0, 63, v0
    v_readfirstlane_b32 s3, v5
    s_and_b32 s64, s2, 7
    s_lshl_b32 s16, s64, 2
    s_bfe_u32 s65, s2, 0x20003
    s_add_u32 s16, s16, s65
    s_lshr_b32 s15, s2, 5
    v_lshlrev_b32 v5, 2, v0
    v_add_u32 v5, 147456, v5
    v_mov_b32 v6, 0
    ds_write_b32 v5, v6
    ds_write_b32 v5, v6 offset:256
    s_cmp_ge_u32 s3, 4
    s_cbranch_scc1 L_k2_kernel_B
    s_setprio 3
    s_lshl_b32 s32, s16, 17
    s_lshl_b32 s33, s15, 14
    s_lshl_b32 s34, s3, 12
    s_add_u32 s33, s33, s34
    s_add_u32 s12, s32, s33
    s_add_u32 s12, s12, 4194304
    s_lshl_b32 s33, s15, 1
    s_lshr_b32 s34, s3, 1
    s_add_u32 s33, s33, s34
    s_mul_i32 s33, s33, 144
    s_add_u32 s33, s33, s16
    s_add_u32 s33, s33, 112
    s_lshl_b32 s33, s33, 13
    s_and_b32 s34, s3, 1
    s_lshl_b32 s34, s34, 12
    s_add_u32 s33, s33, s34
    s_add_u32 s13, s33, 16777216
    v_bfe_u32 v16, v0, 4, 1
    v_lshrrev_b32 v17, 5, v0
    v_and_b32 v18, 15, v0
    v_lshlrev_b32 v1, 10, v16
    v_lshl_add_u32 v1, v17, 8, v1
    v_lshl_add_u32 v1, v18, 4, v1
    v_lshlrev_b32 v1, 4, v0
    s_waitcnt lgkmcnt(0)
    s_add_u32 s32, s32, 8388608
    s_add_u32 s28, s6, s32
    s_addc_u32 s29, s7, 0
    s_mov_b32 s30, 131072
    s_mov_b32 s31, 0x20000
    s_add_u32 s40, s28, 4194304
    s_addc_u32 s41, s29, 0
    s_mov_b32 s42, 131072
    s_mov_b32 s43, 0x20000
    s_mov_b32 s26, 0
    s_lshl_b32 s27, s3, 11
    v_lshlrev_b32 v4, 4, v0
    v_add_u32 v4, s27, v4
    s_lshl_b32 s27, s3, 11
    s_add_u32 m0, s27, 0
    s_nop 0
    buffer_load_dwordx4 v4, s[28:31], s26 offen lds
    buffer_load_dwordx4 v4, s[28:31], s26 offen offset:1024 lds
    s_add_u32 m0, s27, 8192
    s_nop 0
    buffer_load_dwordx4 v4, s[40:43], s26 offen lds
    buffer_load_dwordx4 v4, s[40:43], s26 offen offset:1024 lds
    s_add_u32 s26, s26, 8192
    s_mov_b32 s8, s6
    s_mov_b32 s9, s7
    s_mov_b32 s10, 39911424
    s_mov_b32 s11, 0x20000
    buffer_load_dwordx4 a[0:3], v1, s[8:11], s12 offen offset:0
    buffer_load_dwordx4 a[4:7], v1, s[8:11], s12 offen offset:1024
    buffer_load_dwordx4 a[8:11], v1, s[8:11], s12 offen offset:2048
    buffer_load_dwordx4 a[12:15], v1, s[8:11], s12 offen offset:3072
    s_barrier
    s_add_u32 m0, s27, 16384
    s_nop 0
    buffer_load_dwordx4 v4, s[28:31], s26 offen lds
    buffer_load_dwordx4 v4, s[28:31], s26 offen offset:1024 lds
    s_add_u32 m0, s27, 24576
    s_nop 0
    buffer_load_dwordx4 v4, s[40:43], s26 offen lds
    buffer_load_dwordx4 v4, s[40:43], s26 offen offset:1024 lds
    s_add_u32 s26, s26, 8192
    s_add_u32 m0, s27, 32768
    s_nop 0
    buffer_load_dwordx4 v4, s[28:31], s26 offen lds
    buffer_load_dwordx4 v4, s[28:31], s26 offen offset:1024 lds
    s_add_u32 m0, s27, 40960
    s_nop 0
    buffer_load_dwordx4 v4, s[40:43], s26 offen lds
    buffer_load_dwordx4 v4, s[40:43], s26 offen offset:1024 lds
    s_add_u32 s26, s26, 8192
    s_mov_b32 s20, s60
    s_mov_b32 s21, s61
    s_mov_b32 s22, 7340032
    s_mov_b32 s23, 0x20000
    s_lshl_b32 s33, s2, 2
    s_add_u32 s33, s33, s3
    s_mul_i32 s33, s33, 2048
    v_mul_u32_u24 v12, 128, v0
    v_add_u32 v12, s33, v12
    v_cmp_gt_u32 vcc, 16, v0
    v_mov_b32 v13, 0x80000000
    s_nop 0
    v_cndmask_b32 v12, v13, v12, vcc
    s_mov_b32 s24, 1048576
    s_mov_b32 s25, 0
    v_and_b32 v18, 3, v0
    v_xor_b32 v17, v17, v18
    v_lshlrev_b32 v2, 8, v18
    v_lshl_add_u32 v2, v17, 6, v2
    v_bfe_u32 v18, v0, 2, 2
    v_lshl_add_u32 v2, v18, 4, v2
    v_lshl_add_u32 v2, v16, 3, v2
    v_xor_b32 v3, 128, v2
    v_bfe_u32 v17, v0, 2, 1
    v_cmp_eq_u32 vcc, v16, v17
    v_mov_b32 v18, 0x3f803f80
    s_nop 0
    v_cndmask_b32 v8, 0, v18, vcc
    v_mov_b32 v9, v8
    v_mov_b32 v10, v8
    v_mov_b32 v11, v8
    v_bfe_u32 v17, v0, 1, 1
    v_lshrrev_b32 v16, 5, v0
    v_cmp_eq_u32 vcc, v16, v17
    s_nop 1
    v_cndmask_b32 v8, 0, v18, vcc
    v_and_b32 v17, 1, v0
    v_mov_b32 v9, v8
    v_mov_b32 v10, v8
    v_mov_b32 v11, v8
    v_mul_u32_u24 v14, 0xaaaa, v17
    v_add_u32 v14, 0x4444, v14
    v_and_b32 v18, 3, v0
    v_lshrrev_b32 v17, 4, v0
    v_xor_b32 v17, v17, v18
    v_lshlrev_b32 v2, 8, v18
    v_lshl_add_u32 v2, v17, 6, v2
    v_bfe_u32 v18, v0, 2, 2
    v_lshl_add_u32 v2, v18, 4, v2
    s_mov_b32 s14, 4
    s_mov_b32 s38, 0x07060302
    v_accvgpr_write_b32 a80, 0
    v_accvgpr_write_b32 a81, 0
    v_accvgpr_write_b32 a82, 0
    v_accvgpr_write_b32 a83, 0
    v_accvgpr_write_b32 a84, 0
    v_accvgpr_write_b32 a85, 0
    v_accvgpr_write_b32 a86, 0
    v_accvgpr_write_b32 a87, 0
    v_mov_b32 v80, 0
    v_mov_b32 v81, 0
    v_mov_b32 v82, 0
    v_mov_b32 v83, 0
    v_mov_b32 v84, 0
    v_mov_b32 v85, 0
    v_mov_b32 v86, 0
    v_mov_b32 v87, 0
    v_mov_b32 v88, 0
    v_mov_b32 v89, 0
    v_mov_b32 v90, 0
    v_mov_b32 v91, 0
    v_mov_b32 v92, 0
    v_mov_b32 v93, 0
    v_mov_b32 v94, 0
    v_mov_b32 v95, 0
    v_mov_b32 v96, 0
    v_mov_b32 v97, 0
    v_mov_b32 v98, 0
    v_mov_b32 v99, 0
    v_mov_b32 v100, 0
    v_mov_b32 v101, 0
    v_mov_b32 v102, 0
    v_mov_b32 v103, 0
    v_mov_b32 v104, 0
    v_mov_b32 v105, 0
    v_mov_b32 v106, 0
    v_mov_b32 v107, 0
    v_mov_b32 v108, 0
    v_mov_b32 v109, 0
    v_mov_b32 v110, 0
    v_mov_b32 v111, 0
    v_mov_b32 v112, 0
    v_mov_b32 v113, 0
    v_mov_b32 v114, 0
    v_mov_b32 v115, 0
    v_mov_b32 v116, 0
    v_mov_b32 v117, 0
    v_mov_b32 v118, 0
    v_mov_b32 v119, 0
    v_mov_b32 v72, 0
    v_mov_b32 v73, 0
    v_mov_b32 v74, 0
    v_mov_b32 v75, 0
    v_mov_b32 v76, 0
    v_mov_b32 v77, 0
    v_mov_b32 v78, 0
    v_mov_b32 v79, 0
    v_mov_b32 v48, 0
    v_mov_b32 v49, 0
    v_mov_b32 v50, 0
    v_mov_b32 v51, 0
    v_mov_b32 v52, 0
    v_mov_b32 v53, 0
    v_mov_b32 v54, 0
    v_mov_b32 v55, 0
    v_mov_b32 v56, 0
    v_mov_b32 v57, 0
    v_mov_b32 v58, 0
    v_mov_b32 v59, 0
    v_mov_b32 v60, 0
    v_mov_b32 v61, 0
    v_mov_b32 v62, 0
    v_mov_b32 v63, 0
    v_mov_b32 v6, 1
    s_mov_b32 s36, 4
    s_nop 0
    s_waitcnt vmcnt(12)
    ds_add_u32 v5, v6
    ds_read_b32 v7, v5
    s_waitcnt lgkmcnt(0)
    v_readfirstlane_b32 s37, v7
    s_nop 0
    s_cmp_ge_u32 s37, s36
    s_cbranch_scc0 L_k2_kernel_spinp
L_k2_kernel_okp:
    s_setprio 2
    ds_read_b128 a[56:59], v1 offset:0
    ds_read_b128 a[60:63], v1 offset:1024
    ds_read_b128 a[64:67], v1 offset:2048
    ds_read_b128 a[68:71], v1 offset:3072
    ds_read_b64_tr_b16 a[72:73], v2 offset:8192
    ds_read_b64_tr_b16 a[74:75], v2 offset:9216
    ds_read_b64_tr_b16 a[76:77], v2 offset:8200
    ds_read_b64_tr_b16 a[78:79], v2 offset:9224
    s_waitcnt vmcnt(11) lgkmcnt(7)
    v_mfma_f32_16x16x32_bf16 v[16:19], a[56:59], a[0:3], 0
    s_waitcnt lgkmcnt(6)
    v_mfma_f32_16x16x32_bf16 v[20:23], a[60:63], a[0:3], 0
    s_waitcnt vmcnt(10)
    v_mfma_f32_16x16x32_bf16 v[28:31], a[60:63], a[4:7], 0
    v_mfma_f32_16x16x32_bf16 v[24:27], a[56:59], a[4:7], 0
    s_waitcnt lgkmcnt(0)
    s_waitcnt vmcnt(8)
    s_nop 9
L_k2_kernel_aloop:
    v_mfma_f32_16x16x32_bf16 v[32:35], a[56:59], a[8:11], 0
    v_exp_f32 v48, v16
    v_mfma_f32_16x16x32_bf16 v[36:39], a[60:63], a[8:11], 0
    v_mov_b32_sdwa v79, v62 dst_sel:WORD_0 dst_unused:UNUSED_PRESERVE src0_sel:WORD_1
    v_exp_f32 v64, v17
    v_mfma_f32_16x16x32_bf16 v[44:47], a[60:63], a[12:15], 0
    buffer_load_dword v13, v12, s[20:23], s24 offen
    v_exp_f32 v50, v18
    v_mfma_f32_16x16x32_bf16 v[40:43], a[56:59], a[12:15], 0
    v_mov_b32_sdwa v64, v48 dst_sel:WORD_0 dst_unused:UNUSED_PRESERVE src0_sel:WORD_1
    v_exp_f32 v65, v19
    v_mfma_f32_16x16x32_bf16 v[96:99], a[80:83], v[72:75], v[96:99]
    s_add_u32 s24, s24, 2097152
    v_exp_f32 v52, v20
    v_mfma_f32_16x16x32_bf16 v[100:103], a[84:87], v[72:75], v[100:103]
    v_mov_b32_sdwa v65, v50 dst_sel:WORD_0 dst_unused:UNUSED_PRESERVE src0_sel:WORD_1
    v_exp_f32 v66, v21
    v_mfma_f32_16x16x32_bf16 v[108:111], a[84:87], v[76:79], v[108:111]
    v_exp_f32 v54, v22
    v_mfma_f32_16x16x32_bf16 v[104:107], a[80:83], v[76:79], v[104:107]
    v_mov_b32_sdwa v66, v52 dst_sel:WORD_0 dst_unused:UNUSED_PRESERVE src0_sel:WORD_1
    v_exp_f32 v67, v23
    v_smfmac_f32_16x16x64_bf16 v[116:119], v[8:11], v[72:79], v14
    s_waitcnt lgkmcnt(0)
    v_exp_f32 v56, v24
    v_mov_b32_sdwa v67, v54 dst_sel:WORD_0 dst_unused:UNUSED_PRESERVE src0_sel:WORD_1
    v_exp_f32 v68, v25
    v_exp_f32 v58, v26
    v_mov_b32_sdwa v68, v56 dst_sel:WORD_0 dst_unused:UNUSED_PRESERVE src0_sel:WORD_1
    v_exp_f32 v69, v27
    v_exp_f32 v60, v28
    v_mov_b32_sdwa v69, v58 dst_sel:WORD_0 dst_unused:UNUSED_PRESERVE src0_sel:WORD_1
    v_exp_f32 v70, v29
    v_exp_f32 v62, v30
    v_mov_b32_sdwa v70, v60 dst_sel:WORD_0 dst_unused:UNUSED_PRESERVE src0_sel:WORD_1
    v_exp_f32 v71, v31
    v_mfma_f32_16x16x32_bf16 v[16:19], a[64:67], a[0:3], 0
    ds_read_b128 a[56:59], v1 offset:4096
    v_exp_f32 v48, v32
    v_mfma_f32_16x16x32_bf16 v[20:23], a[68:71], a[0:3], 0
    v_mov_b32_sdwa v71, v62 dst_sel:WORD_0 dst_unused:UNUSED_PRESERVE src0_sel:WORD_1
    v_exp_f32 v72, v33
    v_mfma_f32_16x16x32_bf16 v[28:31], a[68:71], a[4:7], 0
    ds_read_b128 a[60:63], v1 offset:5120
    v_exp_f32 v50, v34
    v_mfma_f32_16x16x32_bf16 v[24:27], a[64:67], a[4:7], 0
    v_mov_b32_sdwa v72, v48 dst_sel:WORD_0 dst_unused:UNUSED_PRESERVE src0_sel:WORD_1
    v_exp_f32 v73, v35
    v_mfma_f32_16x16x32_bf16 v[80:83], a[72:75], v[64:67], v[80:83]
    ds_read_b64_tr_b16 a[80:81], v2 offset:10240
    v_exp_f32 v52, v36
    v_mfma_f32_16x16x32_bf16 v[84:87], a[76:79], v[64:67], v[84:87]
    ds_read_b64_tr_b16 a[82:83], v2 offset:11264
    v_mov_b32_sdwa v73, v50 dst_sel:WORD_0 dst_unused:UNUSED_PRESERVE src0_sel:WORD_1
    v_mfma_f32_16x16x32_bf16 v[92:95], a[76:79], v[68:71], v[92:95]
    ds_read_b64_tr_b16 a[84:85], v2 offset:10248
    v_exp_f32 v74, v37
    v_mfma_f32_16x16x32_bf16 v[88:91], a[72:75], v[68:71], v[88:91]
    v_exp_f32 v54, v38
    v_smfmac_f32_16x16x64_bf16 v[112:115], v[8:11], v[64:71], v14
    ds_read_b64_tr_b16 a[86:87], v2 offset:11272
    v_mov_b32_sdwa v74, v52 dst_sel:WORD_0 dst_unused:UNUSED_PRESERVE src0_sel:WORD_1
    v_exp_f32 v75, v39
    v_exp_f32 v56, v40
    v_mov_b32_sdwa v75, v54 dst_sel:WORD_0 dst_unused:UNUSED_PRESERVE src0_sel:WORD_1
    v_exp_f32 v76, v41
    v_exp_f32 v58, v42
    v_mov_b32_sdwa v76, v56 dst_sel:WORD_0 dst_unused:UNUSED_PRESERVE src0_sel:WORD_1
    v_exp_f32 v77, v43
    v_exp_f32 v60, v44
    v_mov_b32_sdwa v77, v58 dst_sel:WORD_0 dst_unused:UNUSED_PRESERVE src0_sel:WORD_1
    v_exp_f32 v78, v45
    v_exp_f32 v62, v46
    v_mov_b32_sdwa v78, v60 dst_sel:WORD_0 dst_unused:UNUSED_PRESERVE src0_sel:WORD_1
    v_exp_f32 v79, v47
    v_mfma_f32_16x16x32_bf16 v[32:35], a[64:67], a[8:11], 0
    s_waitcnt vmcnt(5)
    v_exp_f32 v48, v16
    v_mfma_f32_16x16x32_bf16 v[36:39], a[68:71], a[8:11], 0
    v_mov_b32_sdwa v79, v62 dst_sel:WORD_0 dst_unused:UNUSED_PRESERVE src0_sel:WORD_1
    v_exp_f32 v64, v17
    v_mfma_f32_16x16x32_bf16 v[44:47], a[68:71], a[12:15], 0
    ds_add_u32 v5, v6
    v_exp_f32 v50, v18
    v_mfma_f32_16x16x32_bf16 v[40:43], a[64:67], a[12:15], 0
    v_mov_b32_sdwa v64, v48 dst_sel:WORD_0 dst_unused:UNUSED_PRESERVE src0_sel:WORD_1
    v_exp_f32 v65, v19
    v_mfma_f32_16x16x32_bf16 v[96:99], a[72:75], v[72:75], v[96:99]
    s_add_u32 s36, s36, 4
    v_exp_f32 v52, v20
    v_mfma_f32_16x16x32_bf16 v[100:103], a[76:79], v[72:75], v[100:103]
    v_mov_b32_sdwa v65, v50 dst_sel:WORD_0 dst_unused:UNUSED_PRESERVE src0_sel:WORD_1
    v_exp_f32 v66, v21
    v_mfma_f32_16x16x32_bf16 v[108:111], a[76:79], v[76:79], v[108:111]
    v_exp_f32 v54, v22
    v_mfma_f32_16x16x32_bf16 v[104:107], a[72:75], v[76:79], v[104:107]
    v_mov_b32_sdwa v66, v52 dst_sel:WORD_0 dst_unused:UNUSED_PRESERVE src0_sel:WORD_1
    v_exp_f32 v67, v23
    v_smfmac_f32_16x16x64_bf16 v[116:119], v[8:11], v[72:79], v14
    s_waitcnt lgkmcnt(0)
    v_exp_f32 v56, v24
    v_mov_b32_sdwa v67, v54 dst_sel:WORD_0 dst_unused:UNUSED_PRESERVE src0_sel:WORD_1
    v_exp_f32 v68, v25
    v_exp_f32 v58, v26
    v_mov_b32_sdwa v68, v56 dst_sel:WORD_0 dst_unused:UNUSED_PRESERVE src0_sel:WORD_1
    v_exp_f32 v69, v27
    v_exp_f32 v60, v28
    v_mov_b32_sdwa v69, v58 dst_sel:WORD_0 dst_unused:UNUSED_PRESERVE src0_sel:WORD_1
    v_exp_f32 v70, v29
    v_exp_f32 v62, v30
    v_mov_b32_sdwa v70, v60 dst_sel:WORD_0 dst_unused:UNUSED_PRESERVE src0_sel:WORD_1
    v_exp_f32 v71, v31
    v_mfma_f32_16x16x32_bf16 v[16:19], a[56:59], a[0:3], 0
    ds_read_b128 a[64:67], v1 offset:6144
    v_exp_f32 v48, v32
    v_mfma_f32_16x16x32_bf16 v[20:23], a[60:63], a[0:3], 0
    v_mov_b32_sdwa v71, v62 dst_sel:WORD_0 dst_unused:UNUSED_PRESERVE src0_sel:WORD_1
    v_exp_f32 v72, v33
    v_mfma_f32_16x16x32_bf16 v[28:31], a[60:63], a[4:7], 0
    ds_read_b128 a[68:71], v1 offset:7168
    v_exp_f32 v50, v34
    v_mfma_f32_16x16x32_bf16 v[24:27], a[56:59], a[4:7], 0
    v_mov_b32_sdwa v72, v48 dst_sel:WORD_0 dst_unused:UNUSED_PRESERVE src0_sel:WORD_1
    v_exp_f32 v73, v35
    v_mfma_f32_16x16x32_bf16 v[80:83], a[80:83], v[64:67], v[80:83]
    ds_read_b64_tr_b16 a[72:73], v2 offset:12288
    v_exp_f32 v52, v36
    v_mfma_f32_16x16x32_bf16 v[84:87], a[84:87], v[64:67], v[84:87]
    ds_read_b64_tr_b16 a[74:75], v2 offset:13312
    v_mov_b32_sdwa v73, v50 dst_sel:WORD_0 dst_unused:UNUSED_PRESERVE src0_sel:WORD_1
    v_mfma_f32_16x16x32_bf16 v[92:95], a[84:87], v[68:71], v[92:95]
    ds_read_b64_tr_b16 a[76:77], v2 offset:12296
    v_exp_f32 v74, v37
    v_mfma_f32_16x16x32_bf16 v[88:91], a[80:83], v[68:71], v[88:91]
    v_exp_f32 v54, v38
    v_smfmac_f32_16x16x64_bf16 v[112:115], v[8:11], v[64:71], v14
    ds_read_b64_tr_b16 a[78:79], v2 offset:13320
    v_mov_b32_sdwa v74, v52 dst_sel:WORD_0 dst_unused:UNUSED_PRESERVE src0_sel:WORD_1
    v_exp_f32 v75, v39
    v_exp_f32 v56, v40
    v_mov_b32_sdwa v75, v54 dst_sel:WORD_0 dst_unused:UNUSED_PRESERVE src0_sel:WORD_1
    v_exp_f32 v76, v41
    v_exp_f32 v58, v42
    v_mov_b32_sdwa v76, v56 dst_sel:WORD_0 dst_unused:UNUSED_PRESERVE src0_sel:WORD_1
    v_exp_f32 v77, v43
    v_exp_f32 v60, v44
    v_mov_b32_sdwa v77, v58 dst_sel:WORD_0 dst_unused:UNUSED_PRESERVE src0_sel:WORD_1
    v_exp_f32 v78, v45
    v_exp_f32 v62, v46
    v_mov_b32_sdwa v78, v60 dst_sel:WORD_0 dst_unused:UNUSED_PRESERVE src0_sel:WORD_1
    v_exp_f32 v79, v47
    v_mfma_f32_16x16x32_bf16 v[32:35], a[56:59], a[8:11], 0
    ds_read_b32 v7, v5
    v_exp_f32 v48, v16
    v_mfma_f32_16x16x32_bf16 v[36:39], a[60:63], a[8:11], 0
    v_mov_b32_sdwa v79, v62 dst_sel:WORD_0 dst_unused:UNUSED_PRESERVE src0_sel:WORD_1
    v_exp_f32 v64, v17
    v_mfma_f32_16x16x32_bf16 v[44:47], a[60:63], a[12:15], 0
    v_exp_f32 v50, v18
    v_mfma_f32_16x16x32_bf16 v[40:43], a[56:59], a[12:15], 0
    v_mov_b32_sdwa v64, v48 dst_sel:WORD_0 dst_unused:UNUSED_PRESERVE src0_sel:WORD_1
    v_exp_f32 v65, v19
    v_mfma_f32_16x16x32_bf16 v[96:99], a[80:83], v[72:75], v[96:99]
    v_exp_f32 v52, v20
    v_mfma_f32_16x16x32_bf16 v[100:103], a[84:87], v[72:75], v[100:103]
    v_mov_b32_sdwa v65, v50 dst_sel:WORD_0 dst_unused:UNUSED_PRESERVE src0_sel:WORD_1
    v_exp_f32 v66, v21
    v_mfma_f32_16x16x32_bf16 v[108:111], a[84:87], v[76:79], v[108:111]
    v_exp_f32 v54, v22
    v_mfma_f32_16x16x32_bf16 v[104:107], a[80:83], v[76:79], v[104:107]
    v_mov_b32_sdwa v66, v52 dst_sel:WORD_0 dst_unused:UNUSED_PRESERVE src0_sel:WORD_1
    v_exp_f32 v67, v23
    v_smfmac_f32_16x16x64_bf16 v[116:119], v[8:11], v[72:79], v14
    s_waitcnt lgkmcnt(0)
    v_readfirstlane_b32 s37, v7
    v_exp_f32 v56, v24
    s_cmp_ge_u32 s37, s36
    s_cbranch_scc0 L_k2_kernel_spin0
L_k2_kernel_ok0:
    v_mov_b32_sdwa v67, v54 dst_sel:WORD_0 dst_unused:UNUSED_PRESERVE src0_sel:WORD_1
    v_exp_f32 v68, v25
    v_exp_f32 v58, v26
    v_mov_b32_sdwa v68, v56 dst_sel:WORD_0 dst_unused:UNUSED_PRESERVE src0_sel:WORD_1
    v_exp_f32 v69, v27
    v_exp_f32 v60, v28
    v_mov_b32_sdwa v69, v58 dst_sel:WORD_0 dst_unused:UNUSED_PRESERVE src0_sel:WORD_1
    v_exp_f32 v70, v29
    v_exp_f32 v62, v30
    v_mov_b32_sdwa v70, v60 dst_sel:WORD_0 dst_unused:UNUSED_PRESERVE src0_sel:WORD_1
    v_exp_f32 v71, v31
    v_mfma_f32_16x16x32_bf16 v[16:19], a[64:67], a[0:3], 0
    ds_read_b128 a[56:59], v1 offset:16384
    v_exp_f32 v48, v32
    v_mfma_f32_16x16x32_bf16 v[20:23], a[68:71], a[0:3], 0
    v_mov_b32_sdwa v71, v62 dst_sel:WORD_0 dst_unused:UNUSED_PRESERVE src0_sel:WORD_1
    v_exp_f32 v72, v33
    v_mfma_f32_16x16x32_bf16 v[28:31], a[68:71], a[4:7], 0
    ds_read_b128 a[60:63], v1 offset:17408
    v_exp_f32 v50, v34
    v_mfma_f32_16x16x32_bf16 v[24:27], a[64:67], a[4:7], 0
    v_mov_b32_sdwa v72, v48 dst_sel:WORD_0 dst_unused:UNUSED_PRESERVE src0_sel:WORD_1
    v_exp_f32 v73, v35
    v_mfma_f32_16x16x32_bf16 v[80:83], a[72:75], v[64:67], v[80:83]
    ds_read_b64_tr_b16 a[80:81], v2 offset:14336
    v_exp_f32 v52, v36
    v_mfma_f32_16x16x32_bf16 v[84:87], a[76:79], v[64:67], v[84:87]
    ds_read_b64_tr_b16 a[82:83], v2 offset:15360
    v_mov_b32_sdwa v73, v50 dst_sel:WORD_0 dst_unused:UNUSED_PRESERVE src0_sel:WORD_1
    v_mfma_f32_16x16x32_bf16 v[92:95], a[76:79], v[68:71], v[92:95]
    ds_read_b64_tr_b16 a[84:85], v2 offset:14344
    v_exp_f32 v74, v37
    v_mfma_f32_16x16x32_bf16 v[88:91], a[72:75], v[68:71], v[88:91]
    v_exp_f32 v54, v38
    v_smfmac_f32_16x16x64_bf16 v[112:115], v[8:11], v[64:71], v14
    ds_read_b64_tr_b16 a[86:87], v2 offset:15368
    v_mov_b32_sdwa v74, v52 dst_sel:WORD_0 dst_unused:UNUSED_PRESERVE src0_sel:WORD_1
    v_exp_f32 v75, v39
    v_exp_f32 v56, v40
    v_mov_b32_sdwa v75, v54 dst_sel:WORD_0 dst_unused:UNUSED_PRESERVE src0_sel:WORD_1
    v_exp_f32 v76, v41
    v_exp_f32 v58, v42
    v_mov_b32_sdwa v76, v56 dst_sel:WORD_0 dst_unused:UNUSED_PRESERVE src0_sel:WORD_1
    v_exp_f32 v77, v43
    v_exp_f32 v60, v44
    v_mov_b32_sdwa v77, v58 dst_sel:WORD_0 dst_unused:UNUSED_PRESERVE src0_sel:WORD_1
    v_exp_f32 v78, v45
    v_exp_f32 v62, v46
    v_mov_b32_sdwa v78, v60 dst_sel:WORD_0 dst_unused:UNUSED_PRESERVE src0_sel:WORD_1
    v_exp_f32 v79, v47
    v_mfma_f32_16x16x32_bf16 v[32:35], a[64:67], a[8:11], 0
    s_add_u32 m0, s27, 49152
    v_exp_f32 v48, v16
    v_mfma_f32_16x16x32_bf16 v[36:39], a[68:71], a[8:11], 0
    v_mov_b32_sdwa v79, v62 dst_sel:WORD_0 dst_unused:UNUSED_PRESERVE src0_sel:WORD_1
    v_exp_f32 v64, v17
    v_mfma_f32_16x16x32_bf16 v[44:47], a[68:71], a[12:15], 0
    buffer_load_dwordx4 v4, s[28:31], s26 offen lds
    buffer_load_dwordx4 v4, s[28:31], s26 offen offset:1024 lds
    v_exp_f32 v50, v18
    v_mfma_f32_16x16x32_bf16 v[40:43], a[64:67], a[12:15], 0
    v_mov_b32_sdwa v64, v48 dst_sel:WORD_0 dst_unused:UNUSED_PRESERVE src0_sel:WORD_1
    v_exp_f32 v65, v19
    v_mfma_f32_16x16x32_bf16 v[96:99], a[72:75], v[72:75], v[96:99]
    s_add_u32 m0, s27, 57344
    v_exp_f32 v52, v20
    v_mfma_f32_16x16x32_bf16 v[100:103], a[76:79], v[72:75], v[100:103]
    buffer_load_dwordx4 v4, s[40:43], s26 offen lds
    buffer_load_dwordx4 v4, s[40:43], s26 offen offset:1024 lds
    v_mov_b32_sdwa v65, v50 dst_sel:WORD_0 dst_unused:UNUSED_PRESERVE src0_sel:WORD_1
    v_exp_f32 v66, v21
    v_mfma_f32_16x16x32_bf16 v[108:111], a[76:79], v[76:79], v[108:111]
    s_add_u32 s26, s26, 8192
    v_exp_f32 v54, v22
    v_mfma_f32_16x16x32_bf16 v[104:107], a[72:75], v[76:79], v[104:107]
    v_mov_b32_sdwa v66, v52 dst_sel:WORD_0 dst_unused:UNUSED_PRESERVE src0_sel:WORD_1
    v_exp_f32 v67, v23
    v_smfmac_f32_16x16x64_bf16 v[116:119], v[8:11], v[72:79], v14
    s_waitcnt lgkmcnt(0)
    v_exp_f32 v56, v24
    v_mov_b32_sdwa v67, v54 dst_sel:WORD_0 dst_unused:UNUSED_PRESERVE src0_sel:WORD_1
    v_exp_f32 v68, v25
    v_exp_f32 v58, v26
    v_mov_b32_sdwa v68, v56 dst_sel:WORD_0 dst_unused:UNUSED_PRESERVE src0_sel:WORD_1
    v_exp_f32 v69, v27
    v_exp_f32 v60, v28
    v_mov_b32_sdwa v69, v58 dst_sel:WORD_0 dst_unused:UNUSED_PRESERVE src0_sel:WORD_1
    v_exp_f32 v70, v29
    v_exp_f32 v62, v30
    v_mov_b32_sdwa v70, v60 dst_sel:WORD_0 dst_unused:UNUSED_PRESERVE src0_sel:WORD_1
    v_exp_f32 v71, v31
    v_mfma_f32_16x16x32_bf16 v[16:19], a[56:59], a[0:3], 0
    ds_read_b128 a[64:67], v1 offset:18432
    v_exp_f32 v48, v32
    v_mfma_f32_16x16x32_bf16 v[20:23], a[60:63], a[0:3], 0
    v_mov_b32_sdwa v71, v62 dst_sel:WORD_0 dst_unused:UNUSED_PRESERVE src0_sel:WORD_1
    v_exp_f32 v72, v33
    v_mfma_f32_16x16x32_bf16 v[28:31], a[60:63], a[4:7], 0
    ds_read_b128 a[68:71], v1 offset:19456
    v_exp_f32 v50, v34
    v_mfma_f32_16x16x32_bf16 v[24:27], a[56:59], a[4:7], 0
    v_mov_b32_sdwa v72, v48 dst_sel:WORD_0 dst_unused:UNUSED_PRESERVE src0_sel:WORD_1
    v_exp_f32 v73, v35
    v_mfma_f32_16x16x32_bf16 v[80:83], a[80:83], v[64:67], v[80:83]
    ds_read_b64_tr_b16 a[72:73], v2 offset:24576
    v_exp_f32 v52, v36
    v_mfma_f32_16x16x32_bf16 v[84:87], a[84:87], v[64:67], v[84:87]
    ds_read_b64_tr_b16 a[74:75], v2 offset:25600
    v_mov_b32_sdwa v73, v50 dst_sel:WORD_0 dst_unused:UNUSED_PRESERVE src0_sel:WORD_1
    v_mfma_f32_16x16x32_bf16 v[92:95], a[84:87], v[68:71], v[92:95]
    ds_read_b64_tr_b16 a[76:77], v2 offset:24584
    v_exp_f32 v74, v37
    v_mfma_f32_16x16x32_bf16 v[88:91], a[80:83], v[68:71], v[88:91]
    v_exp_f32 v54, v38
    v_smfmac_f32_16x16x64_bf16 v[112:115], v[8:11], v[64:71], v14
    ds_read_b64_tr_b16 a[78:79], v2 offset:25608
    v_mov_b32_sdwa v74, v52 dst_sel:WORD_0 dst_unused:UNUSED_PRESERVE src0_sel:WORD_1
    v_exp_f32 v75, v39
    v_exp_f32 v56, v40
    v_mov_b32_sdwa v75, v54 dst_sel:WORD_0 dst_unused:UNUSED_PRESERVE src0_sel:WORD_1
    v_exp_f32 v76, v41
    v_exp_f32 v58, v42
    v_mov_b32_sdwa v76, v56 dst_sel:WORD_0 dst_unused:UNUSED_PRESERVE src0_sel:WORD_1
    v_exp_f32 v77, v43
    v_exp_f32 v60, v44
    v_mov_b32_sdwa v77, v58 dst_sel:WORD_0 dst_unused:UNUSED_PRESERVE src0_sel:WORD_1
    v_exp_f32 v78, v45
    v_exp_f32 v62, v46
    v_mov_b32_sdwa v78, v60 dst_sel:WORD_0 dst_unused:UNUSED_PRESERVE src0_sel:WORD_1
    v_exp_f32 v79, v47
    v_mfma_f32_16x16x32_bf16 v[32:35], a[56:59], a[8:11], 0
    v_exp_f32 v48, v16
    v_mfma_f32_16x16x32_bf16 v[36:39], a[60:63], a[8:11], 0
    v_mov_b32_sdwa v79, v62 dst_sel:WORD_0 dst_unused:UNUSED_PRESERVE src0_sel:WORD_1
    v_exp_f32 v64, v17
    v_mfma_f32_16x16x32_bf16 v[44:47], a[60:63], a[12:15], 0
    v_exp_f32 v50, v18
    v_mfma_f32_16x16x32_bf16 v[40:43], a[56:59], a[12:15], 0
    v_mov_b32_sdwa v64, v48 dst_sel:WORD_0 dst_unused:UNUSED_PRESERVE src0_sel:WORD_1
    v_exp_f32 v65, v19
    v_mfma_f32_16x16x32_bf16 v[96:99], a[80:83], v[72:75], v[96:99]
    v_exp_f32 v52, v20
    v_mfma_f32_16x16x32_bf16 v[100:103], a[84:87], v[72:75], v[100:103]
    v_mov_b32_sdwa v65, v50 dst_sel:WORD_0 dst_unused:UNUSED_PRESERVE src0_sel:WORD_1
    v_exp_f32 v66, v21
    v_mfma_f32_16x16x32_bf16 v[108:111], a[84:87], v[76:79], v[108:111]
    v_exp_f32 v54, v22
    v_mfma_f32_16x16x32_bf16 v[104:107], a[80:83], v[76:79], v[104:107]
    v_mov_b32_sdwa v66, v52 dst_sel:WORD_0 dst_unused:UNUSED_PRESERVE src0_sel:WORD_1
    v_exp_f32 v67, v23
    v_smfmac_f32_16x16x64_bf16 v[116:119], v[8:11], v[72:79], v14
    s_waitcnt lgkmcnt(0)
    v_exp_f32 v56, v24
    v_mov_b32_sdwa v67, v54 dst_sel:WORD_0 dst_unused:UNUSED_PRESERVE src0_sel:WORD_1
    v_exp_f32 v68, v25
    v_exp_f32 v58, v26
    v_mov_b32_sdwa v68, v56 dst_sel:WORD_0 dst_unused:UNUSED_PRESERVE src0_sel:WORD_1
    v_exp_f32 v69, v27
    v_exp_f32 v60, v28
    v_mov_b32_sdwa v69, v58 dst_sel:WORD_0 dst_unused:UNUSED_PRESERVE src0_sel:WORD_1
    v_exp_f32 v70, v29
    v_exp_f32 v62, v30
    v_mov_b32_sdwa v70, v60 dst_sel:WORD_0 dst_unused:UNUSED_PRESERVE src0_sel:WORD_1
    v_exp_f32 v71, v31
    v_mfma_f32_16x16x32_bf16 v[16:19], a[64:67], a[0:3], 0
    ds_read_b128 a[56:59], v1 offset:20480
    v_exp_f32 v48, v32
    v_mfma_f32_16x16x32_bf16 v[20:23], a[68:71], a[0:3], 0
    v_mov_b32_sdwa v71, v62 dst_sel:WORD_0 dst_unused:UNUSED_PRESERVE src0_sel:WORD_1
    v_exp_f32 v72, v33
    v_mfma_f32_16x16x32_bf16 v[28:31], a[68:71], a[4:7], 0
    ds_read_b128 a[60:63], v1 offset:21504
    v_exp_f32 v50, v34
    v_mfma_f32_16x16x32_bf16 v[24:27], a[64:67], a[4:7], 0
    v_mov_b32_sdwa v72, v48 dst_sel:WORD_0 dst_unused:UNUSED_PRESERVE src0_sel:WORD_1
    v_exp_f32 v73, v35
    v_mfma_f32_16x16x32_bf16 v[80:83], a[72:75], v[64:67], v[80:83]
    ds_read_b64_tr_b16 a[80:81], v2 offset:26624
    v_exp_f32 v52, v36
    v_mfma_f32_16x16x32_bf16 v[84:87], a[76:79], v[64:67], v[84:87]
    ds_read_b64_tr_b16 a[82:83], v2 offset:27648
    v_mov_b32_sdwa v73, v50 dst_sel:WORD_0 dst_unused:UNUSED_PRESERVE src0_sel:WORD_1
    v_mfma_f32_16x16x32_bf16 v[92:95], a[76:79], v[68:71], v[92:95]
    ds_read_b64_tr_b16 a[84:85], v2 offset:26632
    v_exp_f32 v74, v37
    v_mfma_f32_16x16x32_bf16 v[88:91], a[72:75], v[68:71], v[88:91]
    v_exp_f32 v54, v38
    v_smfmac_f32_16x16x64_bf16 v[112:115], v[8:11], v[64:71], v14
    ds_read_b64_tr_b16 a[86:87], v2 offset:27656
    v_mov_b32_sdwa v74, v52 dst_sel:WORD_0 dst_unused:UNUSED_PRESERVE src0_sel:WORD_1
    v_exp_f32 v75, v39
    v_exp_f32 v56, v40
    v_mov_b32_sdwa v75, v54 dst_sel:WORD_0 dst_unused:UNUSED_PRESERVE src0_sel:WORD_1
    v_exp_f32 v76, v41
    v_exp_f32 v58, v42
    v_mov_b32_sdwa v76, v56 dst_sel:WORD_0 dst_unused:UNUSED_PRESERVE src0_sel:WORD_1
    v_exp_f32 v77, v43
    v_exp_f32 v60, v44
    v_mov_b32_sdwa v77, v58 dst_sel:WORD_0 dst_unused:UNUSED_PRESERVE src0_sel:WORD_1
    v_exp_f32 v78, v45
    v_exp_f32 v62, v46
    v_mov_b32_sdwa v78, v60 dst_sel:WORD_0 dst_unused:UNUSED_PRESERVE src0_sel:WORD_1
    v_exp_f32 v79, v47
    v_mfma_f32_16x16x32_bf16 v[32:35], a[64:67], a[8:11], 0
    s_waitcnt vmcnt(5)
    v_exp_f32 v48, v16
    v_mfma_f32_16x16x32_bf16 v[36:39], a[68:71], a[8:11], 0
    v_mov_b32_sdwa v79, v62 dst_sel:WORD_0 dst_unused:UNUSED_PRESERVE src0_sel:WORD_1
    v_exp_f32 v64, v17
    v_mfma_f32_16x16x32_bf16 v[44:47], a[68:71], a[12:15], 0
    ds_add_u32 v5, v6
    v_exp_f32 v50, v18
    v_mfma_f32_16x16x32_bf16 v[40:43], a[64:67], a[12:15], 0
    v_mov_b32_sdwa v64, v48 dst_sel:WORD_0 dst_unused:UNUSED_PRESERVE src0_sel:WORD_1
    v_exp_f32 v65, v19
    v_mfma_f32_16x16x32_bf16 v[96:99], a[72:75], v[72:75], v[96:99]
    s_add_u32 s36, s36, 4
    v_exp_f32 v52, v20
    v_mfma_f32_16x16x32_bf16 v[100:103], a[76:79], v[72:75], v[100:103]
    v_mov_b32_sdwa v65, v50 dst_sel:WORD_0 dst_unused:UNUSED_PRESERVE src0_sel:WORD_1
    v_exp_f32 v66, v21
    v_mfma_f32_16x16x32_bf16 v[108:111], a[76:79], v[76:79], v[108:111]
    v_exp_f32 v54, v22
    v_mfma_f32_16x16x32_bf16 v[104:107], a[72:75], v[76:79], v[104:107]
    v_mov_b32_sdwa v66, v52 dst_sel:WORD_0 dst_unused:UNUSED_PRESERVE src0_sel:WORD_1
    v_exp_f32 v67, v23
    v_smfmac_f32_16x16x64_bf16 v[116:119], v[8:11], v[72:79], v14
    s_waitcnt lgkmcnt(0)
    v_exp_f32 v56, v24
    v_mov_b32_sdwa v67, v54 dst_sel:WORD_0 dst_unused:UNUSED_PRESERVE src0_sel:WORD_1
    v_exp_f32 v68, v25
    v_exp_f32 v58, v26
    v_mov_b32_sdwa v68, v56 dst_sel:WORD_0 dst_unused:UNUSED_PRESERVE src0_sel:WORD_1
    v_exp_f32 v69, v27
    v_exp_f32 v60, v28
    v_mov_b32_sdwa v69, v58 dst_sel:WORD_0 dst_unused:UNUSED_PRESERVE src0_sel:WORD_1
    v_exp_f32 v70, v29
    v_exp_f32 v62, v30
    v_mov_b32_sdwa v70, v60 dst_sel:WORD_0 dst_unused:UNUSED_PRESERVE src0_sel:WORD_1
    v_exp_f32 v71, v31
    v_mfma_f32_16x16x32_bf16 v[16:19], a[56:59], a[0:3], 0
    ds_read_b128 a[64:67], v1 offset:22528
    v_exp_f32 v48, v32
    v_mfma_f32_16x16x32_bf16 v[20:23], a[60:63], a[0:3], 0
    v_mov_b32_sdwa v71, v62 dst_sel:WORD_0 dst_unused:UNUSED_PRESERVE src0_sel:WORD_1
    v_exp_f32 v72, v33
    v_mfma_f32_16x16x32_bf16 v[28:31], a[60:63], a[4:7], 0
    ds_read_b128 a[68:71], v1 offset:23552
    v_exp_f32 v50, v34
    v_mfma_f32_16x16x32_bf16 v[24:27], a[56:59], a[4:7], 0
    v_mov_b32_sdwa v72, v48 dst_sel:WORD_0 dst_unused:UNUSED_PRESERVE src0_sel:WORD_1
    v_exp_f32 v73, v35
    v_mfma_f32_16x16x32_bf16 v[80:83], a[80:83], v[64:67], v[80:83]
    ds_read_b64_tr_b16 a[72:73], v2 offset:28672
    v_exp_f32 v52, v36
    v_mfma_f32_16x16x32_bf16 v[84:87], a[84:87], v[64:67], v[84:87]
    ds_read_b64_tr_b16 a[74:75], v2 offset:29696
    v_mov_b32_sdwa v73, v50 dst_sel:WORD_0 dst_unused:UNUSED_PRESERVE src0_sel:WORD_1
    v_mfma_f32_16x16x32_bf16 v[92:95], a[84:87], v[68:71], v[92:95]
    ds_read_b64_tr_b16 a[76:77], v2 offset:28680
    v_exp_f32 v74, v37
    v_mfma_f32_16x16x32_bf16 v[88:91], a[80:83], v[68:71], v[88:91]
    v_exp_f32 v54, v38
    v_smfmac_f32_16x16x64_bf16 v[112:115], v[8:11], v[64:71], v14
    ds_read_b64_tr_b16 a[78:79], v2 offset:29704
    v_mov_b32_sdwa v74, v52 dst_sel:WORD_0 dst_unused:UNUSED_PRESERVE src0_sel:WORD_1
    v_exp_f32 v75, v39
    v_exp_f32 v56, v40
    v_mov_b32_sdwa v75, v54 dst_sel:WORD_0 dst_unused:UNUSED_PRESERVE src0_sel:WORD_1
    v_exp_f32 v76, v41
    v_exp_f32 v58, v42
    v_mov_b32_sdwa v76, v56 dst_sel:WORD_0 dst_unused:UNUSED_PRESERVE src0_sel:WORD_1
    v_exp_f32 v77, v43
    v_exp_f32 v60, v44
    v_mov_b32_sdwa v77, v58 dst_sel:WORD_0 dst_unused:UNUSED_PRESERVE src0_sel:WORD_1
    v_exp_f32 v78, v45
    v_exp_f32 v62, v46
    v_mov_b32_sdwa v78, v60 dst_sel:WORD_0 dst_unused:UNUSED_PRESERVE src0_sel:WORD_1
    v_exp_f32 v79, v47
    v_mfma_f32_16x16x32_bf16 v[32:35], a[56:59], a[8:11], 0
    ds_read_b32 v7, v5
    v_exp_f32 v48, v16
    v_mfma_f32_16x16x32_bf16 v[36:39], a[60:63], a[8:11], 0
    v_mov_b32_sdwa v79, v62 dst_sel:WORD_0 dst_unused:UNUSED_PRESERVE src0_sel:WORD_1
    v_exp_f32 v64, v17
    v_mfma_f32_16x16x32_bf16 v[44:47], a[60:63], a[12:15], 0
    v_exp_f32 v50, v18
    v_mfma_f32_16x16x32_bf16 v[40:43], a[56:59], a[12:15], 0
    v_mov_b32_sdwa v64, v48 dst_sel:WORD_0 dst_unused:UNUSED_PRESERVE src0_sel:WORD_1
    v_exp_f32 v65, v19
    v_mfma_f32_16x16x32_bf16 v[96:99], a[80:83], v[72:75], v[96:99]
    v_exp_f32 v52, v20
    v_mfma_f32_16x16x32_bf16 v[100:103], a[84:87], v[72:75], v[100:103]
    v_mov_b32_sdwa v65, v50 dst_sel:WORD_0 dst_unused:UNUSED_PRESERVE src0_sel:WORD_1
    v_exp_f32 v66, v21
    v_mfma_f32_16x16x32_bf16 v[108:111], a[84:87], v[76:79], v[108:111]
    v_exp_f32 v54, v22
    v_mfma_f32_16x16x32_bf16 v[104:107], a[80:83], v[76:79], v[104:107]
    v_mov_b32_sdwa v66, v52 dst_sel:WORD_0 dst_unused:UNUSED_PRESERVE src0_sel:WORD_1
    v_exp_f32 v67, v23
    v_smfmac_f32_16x16x64_bf16 v[116:119], v[8:11], v[72:79], v14
    s_waitcnt lgkmcnt(0)
    v_readfirstlane_b32 s37, v7
    v_exp_f32 v56, v24
    s_cmp_ge_u32 s37, s36
    s_cbranch_scc0 L_k2_kernel_spin1
L_k2_kernel_ok1:
    v_mov_b32_sdwa v67, v54 dst_sel:WORD_0 dst_unused:UNUSED_PRESERVE src0_sel:WORD_1
    v_exp_f32 v68, v25
    v_exp_f32 v58, v26
    v_mov_b32_sdwa v68, v56 dst_sel:WORD_0 dst_unused:UNUSED_PRESERVE src0_sel:WORD_1
    v_exp_f32 v69, v27
    v_exp_f32 v60, v28
    v_mov_b32_sdwa v69, v58 dst_sel:WORD_0 dst_unused:UNUSED_PRESERVE src0_sel:WORD_1
    v_exp_f32 v70, v29
    v_exp_f32 v62, v30
    v_mov_b32_sdwa v70, v60 dst_sel:WORD_0 dst_unused:UNUSED_PRESERVE src0_sel:WORD_1
    v_exp_f32 v71, v31
    v_mfma_f32_16x16x32_bf16 v[16:19], a[64:67], a[0:3], 0
    ds_read_b128 a[56:59], v1 offset:32768
    v_exp_f32 v48, v32
    v_mfma_f32_16x16x32_bf16 v[20:23], a[68:71], a[0:3], 0
    v_mov_b32_sdwa v71, v62 dst_sel:WORD_0 dst_unused:UNUSED_PRESERVE src0_sel:WORD_1
    v_exp_f32 v72, v33
    v_mfma_f32_16x16x32_bf16 v[28:31], a[68:71], a[4:7], 0
    ds_read_b128 a[60:63], v1 offset:33792
    v_exp_f32 v50, v34
    v_mfma_f32_16x16x32_bf16 v[24:27], a[64:67], a[4:7], 0
    v_mov_b32_sdwa v72, v48 dst_sel:WORD_0 dst_unused:UNUSED_PRESERVE src0_sel:WORD_1
    v_exp_f32 v73, v35
    v_mfma_f32_16x16x32_bf16 v[80:83], a[72:75], v[64:67], v[80:83]
    ds_read_b64_tr_b16 a[80:81], v2 offset:30720
    v_exp_f32 v52, v36
    v_mfma_f32_16x16x32_bf16 v[84:87], a[76:79], v[64:67], v[84:87]
    ds_read_b64_tr_b16 a[82:83], v2 offset:31744
    v_mov_b32_sdwa v73, v50 dst_sel:WORD_0 dst_unused:UNUSED_PRESERVE src0_sel:WORD_1
    v_mfma_f32_16x16x32_bf16 v[92:95], a[76:79], v[68:71], v[92:95]
    ds_read_b64_tr_b16 a[84:85], v2 offset:30728
    v_exp_f32 v74, v37
    v_mfma_f32_16x16x32_bf16 v[88:91], a[72:75], v[68:71], v[88:91]
    v_exp_f32 v54, v38
    v_smfmac_f32_16x16x64_bf16 v[112:115], v[8:11], v[64:71], v14
    ds_read_b64_tr_b16 a[86:87], v2 offset:31752
    v_mov_b32_sdwa v74, v52 dst_sel:WORD_0 dst_unused:UNUSED_PRESERVE src0_sel:WORD_1
    v_exp_f32 v75, v39
    v_exp_f32 v56, v40
    v_mov_b32_sdwa v75, v54 dst_sel:WORD_0 dst_unused:UNUSED_PRESERVE src0_sel:WORD_1
    v_exp_f32 v76, v41
    v_exp_f32 v58, v42
    v_mov_b32_sdwa v76, v56 dst_sel:WORD_0 dst_unused:UNUSED_PRESERVE src0_sel:WORD_1
    v_exp_f32 v77, v43
    v_exp_f32 v60, v44
    v_mov_b32_sdwa v77, v58 dst_sel:WORD_0 dst_unused:UNUSED_PRESERVE src0_sel:WORD_1
    v_exp_f32 v78, v45
    v_exp_f32 v62, v46
    v_mov_b32_sdwa v78, v60 dst_sel:WORD_0 dst_unused:UNUSED_PRESERVE src0_sel:WORD_1
    v_exp_f32 v79, v47
    v_mfma_f32_16x16x32_bf16 v[32:35], a[64:67], a[8:11], 0
    s_add_u32 m0, s27, 0
    v_exp_f32 v48, v16
    v_mfma_f32_16x16x32_bf16 v[36:39], a[68:71], a[8:11], 0
    v_mov_b32_sdwa v79, v62 dst_sel:WORD_0 dst_unused:UNUSED_PRESERVE src0_sel:WORD_1
    v_exp_f32 v64, v17
    v_mfma_f32_16x16x32_bf16 v[44:47], a[68:71], a[12:15], 0
    buffer_load_dwordx4 v4, s[28:31], s26 offen lds
    buffer_load_dwordx4 v4, s[28:31], s26 offen offset:1024 lds
    v_exp_f32 v50, v18
    v_mfma_f32_16x16x32_bf16 v[40:43], a[64:67], a[12:15], 0
    v_mov_b32_sdwa v64, v48 dst_sel:WORD_0 dst_unused:UNUSED_PRESERVE src0_sel:WORD_1
    v_exp_f32 v65, v19
    v_mfma_f32_16x16x32_bf16 v[96:99], a[72:75], v[72:75], v[96:99]
    s_add_u32 m0, s27, 8192
    v_exp_f32 v52, v20
    v_mfma_f32_16x16x32_bf16 v[100:103], a[76:79], v[72:75], v[100:103]
    buffer_load_dwordx4 v4, s[40:43], s26 offen lds
    buffer_load_dwordx4 v4, s[40:43], s26 offen offset:1024 lds
    v_mov_b32_sdwa v65, v50 dst_sel:WORD_0 dst_unused:UNUSED_PRESERVE src0_sel:WORD_1
    v_exp_f32 v66, v21
    v_mfma_f32_16x16x32_bf16 v[108:111], a[76:79], v[76:79], v[108:111]
    s_add_u32 s26, s26, 8192
    v_exp_f32 v54, v22
    v_mfma_f32_16x16x32_bf16 v[104:107], a[72:75], v[76:79], v[104:107]
    v_mov_b32_sdwa v66, v52 dst_sel:WORD_0 dst_unused:UNUSED_PRESERVE src0_sel:WORD_1
    v_exp_f32 v67, v23
    v_smfmac_f32_16x16x64_bf16 v[116:119], v[8:11], v[72:79], v14
    s_waitcnt lgkmcnt(0)
    v_exp_f32 v56, v24
    v_mov_b32_sdwa v67, v54 dst_sel:WORD_0 dst_unused:UNUSED_PRESERVE src0_sel:WORD_1
    v_exp_f32 v68, v25
    v_exp_f32 v58, v26
    v_mov_b32_sdwa v68, v56 dst_sel:WORD_0 dst_unused:UNUSED_PRESERVE src0_sel:WORD_1
    v_exp_f32 v69, v27
    v_exp_f32 v60, v28
    v_mov_b32_sdwa v69, v58 dst_sel:WORD_0 dst_unused:UNUSED_PRESERVE src0_sel:WORD_1
    v_exp_f32 v70, v29
    v_exp_f32 v62, v30
    v_mov_b32_sdwa v70, v60 dst_sel:WORD_0 dst_unused:UNUSED_PRESERVE src0_sel:WORD_1
    v_exp_f32 v71, v31
    v_mfma_f32_16x16x32_bf16 v[16:19], a[56:59], a[0:3], 0
    ds_read_b128 a[64:67], v1 offset:34816
    v_exp_f32 v48, v32
    v_mfma_f32_16x16x32_bf16 v[20:23], a[60:63], a[0:3], 0
    v_mov_b32_sdwa v71, v62 dst_sel:WORD_0 dst_unused:UNUSED_PRESERVE src0_sel:WORD_1
    v_exp_f32 v72, v33
    v_mfma_f32_16x16x32_bf16 v[28:31], a[60:63], a[4:7], 0
    ds_read_b128 a[68:71], v1 offset:35840
    v_exp_f32 v50, v34
    v_mfma_f32_16x16x32_bf16 v[24:27], a[56:59], a[4:7], 0
    v_mov_b32_sdwa v72, v48 dst_sel:WORD_0 dst_unused:UNUSED_PRESERVE src0_sel:WORD_1
    v_exp_f32 v73, v35
    v_mfma_f32_16x16x32_bf16 v[80:83], a[80:83], v[64:67], v[80:83]
    ds_read_b64_tr_b16 a[72:73], v2 offset:40960
    v_exp_f32 v52, v36
    v_mfma_f32_16x16x32_bf16 v[84:87], a[84:87], v[64:67], v[84:87]
    ds_read_b64_tr_b16 a[74:75], v2 offset:41984
    v_mov_b32_sdwa v73, v50 dst_sel:WORD_0 dst_unused:UNUSED_PRESERVE src0_sel:WORD_1
    v_mfma_f32_16x16x32_bf16 v[92:95], a[84:87], v[68:71], v[92:95]
    ds_read_b64_tr_b16 a[76:77], v2 offset:40968
    v_exp_f32 v74, v37
    v_mfma_f32_16x16x32_bf16 v[88:91], a[80:83], v[68:71], v[88:91]
    v_exp_f32 v54, v38
    v_smfmac_f32_16x16x64_bf16 v[112:115], v[8:11], v[64:71], v14
    ds_read_b64_tr_b16 a[78:79], v2 offset:41992
    v_mov_b32_sdwa v74, v52 dst_sel:WORD_0 dst_unused:UNUSED_PRESERVE src0_sel:WORD_1
    v_exp_f32 v75, v39
    v_exp_f32 v56, v40
    v_mov_b32_sdwa v75, v54 dst_sel:WORD_0 dst_unused:UNUSED_PRESERVE src0_sel:WORD_1
    v_exp_f32 v76, v41
    v_exp_f32 v58, v42
    v_mov_b32_sdwa v76, v56 dst_sel:WORD_0 dst_unused:UNUSED_PRESERVE src0_sel:WORD_1
    v_exp_f32 v77, v43
    v_exp_f32 v60, v44
    v_mov_b32_sdwa v77, v58 dst_sel:WORD_0 dst_unused:UNUSED_PRESERVE src0_sel:WORD_1
    v_exp_f32 v78, v45
    v_exp_f32 v62, v46
    v_mov_b32_sdwa v78, v60 dst_sel:WORD_0 dst_unused:UNUSED_PRESERVE src0_sel:WORD_1
    v_exp_f32 v79, v47
    v_mfma_f32_16x16x32_bf16 v[32:35], a[56:59], a[8:11], 0
    v_exp_f32 v48, v16
    v_mfma_f32_16x16x32_bf16 v[36:39], a[60:63], a[8:11], 0
    v_mov_b32_sdwa v79, v62 dst_sel:WORD_0 dst_unused:UNUSED_PRESERVE src0_sel:WORD_1
    v_exp_f32 v64, v17
    v_mfma_f32_16x16x32_bf16 v[44:47], a[60:63], a[12:15], 0
    buffer_load_dword v13, v12, s[20:23], s24 offen
    v_exp_f32 v50, v18
    v_mfma_f32_16x16x32_bf16 v[40:43], a[56:59], a[12:15], 0
    v_mov_b32_sdwa v64, v48 dst_sel:WORD_0 dst_unused:UNUSED_PRESERVE src0_sel:WORD_1
    v_exp_f32 v65, v19
    v_mfma_f32_16x16x32_bf16 v[96:99], a[80:83], v[72:75], v[96:99]
    s_add_u32 s24, s24, 2097152
    v_exp_f32 v52, v20
    v_mfma_f32_16x16x32_bf16 v[100:103], a[84:87], v[72:75], v[100:103]
    v_mov_b32_sdwa v65, v50 dst_sel:WORD_0 dst_unused:UNUSED_PRESERVE src0_sel:WORD_1
    v_exp_f32 v66, v21
    v_mfma_f32_16x16x32_bf16 v[108:111], a[84:87], v[76:79], v[108:111]
    v_exp_f32 v54, v22
    v_mfma_f32_16x16x32_bf16 v[104:107], a[80:83], v[76:79], v[104:107]
    v_mov_b32_sdwa v66, v52 dst_sel:WORD_0 dst_unused:UNUSED_PRESERVE src0_sel:WORD_1
    v_exp_f32 v67, v23
    v_smfmac_f32_16x16x64_bf16 v[116:119], v[8:11], v[72:79], v14
    s_waitcnt lgkmcnt(0)
    v_exp_f32 v56, v24
    v_mov_b32_sdwa v67, v54 dst_sel:WORD_0 dst_unused:UNUSED_PRESERVE src0_sel:WORD_1
    v_exp_f32 v68, v25
    v_exp_f32 v58, v26
    v_mov_b32_sdwa v68, v56 dst_sel:WORD_0 dst_unused:UNUSED_PRESERVE src0_sel:WORD_1
    v_exp_f32 v69, v27
    v_exp_f32 v60, v28
    v_mov_b32_sdwa v69, v58 dst_sel:WORD_0 dst_unused:UNUSED_PRESERVE src0_sel:WORD_1
    v_exp_f32 v70, v29
    v_exp_f32 v62, v30
    v_mov_b32_sdwa v70, v60 dst_sel:WORD_0 dst_unused:UNUSED_PRESERVE src0_sel:WORD_1
    v_exp_f32 v71, v31
    v_mfma_f32_16x16x32_bf16 v[16:19], a[64:67], a[0:3], 0
    ds_read_b128 a[56:59], v1 offset:36864
    v_exp_f32 v48, v32
    v_mfma_f32_16x16x32_bf16 v[20:23], a[68:71], a[0:3], 0
    v_mov_b32_sdwa v71, v62 dst_sel:WORD_0 dst_unused:UNUSED_PRESERVE src0_sel:WORD_1
    v_exp_f32 v72, v33
    v_mfma_f32_16x16x32_bf16 v[28:31], a[68:71], a[4:7], 0
    ds_read_b128 a[60:63], v1 offset:37888
    v_exp_f32 v50, v34
    v_mfma_f32_16x16x32_bf16 v[24:27], a[64:67], a[4:7], 0
    v_mov_b32_sdwa v72, v48 dst_sel:WORD_0 dst_unused:UNUSED_PRESERVE src0_sel:WORD_1
    v_exp_f32 v73, v35
    v_mfma_f32_16x16x32_bf16 v[80:83], a[72:75], v[64:67], v[80:83]
    ds_read_b64_tr_b16 a[80:81], v2 offset:43008
    v_exp_f32 v52, v36
    v_mfma_f32_16x16x32_bf16 v[84:87], a[76:79], v[64:67], v[84:87]
    ds_read_b64_tr_b16 a[82:83], v2 offset:44032
    v_mov_b32_sdwa v73, v50 dst_sel:WORD_0 dst_unused:UNUSED_PRESERVE src0_sel:WORD_1
    v_mfma_f32_16x16x32_bf16 v[92:95], a[76:79], v[68:71], v[92:95]
    ds_read_b64_tr_b16 a[84:85], v2 offset:43016
    v_exp_f32 v74, v37
    v_mfma_f32_16x16x32_bf16 v[88:91], a[72:75], v[68:71], v[88:91]
    v_exp_f32 v54, v38
    v_smfmac_f32_16x16x64_bf16 v[112:115], v[8:11], v[64:71], v14
    ds_read_b64_tr_b16 a[86:87], v2 offset:44040
    v_mov_b32_sdwa v74, v52 dst_sel:WORD_0 dst_unused:UNUSED_PRESERVE src0_sel:WORD_1
    v_exp_f32 v75, v39
    v_exp_f32 v56, v40
    v_mov_b32_sdwa v75, v54 dst_sel:WORD_0 dst_unused:UNUSED_PRESERVE src0_sel:WORD_1
    v_exp_f32 v76, v41
    v_exp_f32 v58, v42
    v_mov_b32_sdwa v76, v56 dst_sel:WORD_0 dst_unused:UNUSED_PRESERVE src0_sel:WORD_1
    v_exp_f32 v77, v43
    v_exp_f32 v60, v44
    v_mov_b32_sdwa v77, v58 dst_sel:WORD_0 dst_unused:UNUSED_PRESERVE src0_sel:WORD_1
    v_exp_f32 v78, v45
    v_exp_f32 v62, v46
    v_mov_b32_sdwa v78, v60 dst_sel:WORD_0 dst_unused:UNUSED_PRESERVE src0_sel:WORD_1
    v_exp_f32 v79, v47
    v_mfma_f32_16x16x32_bf16 v[32:35], a[64:67], a[8:11], 0
    s_waitcnt vmcnt(5)
    v_exp_f32 v48, v16
    v_mfma_f32_16x16x32_bf16 v[36:39], a[68:71], a[8:11], 0
    v_mov_b32_sdwa v79, v62 dst_sel:WORD_0 dst_unused:UNUSED_PRESERVE src0_sel:WORD_1
    v_exp_f32 v64, v17
    v_mfma_f32_16x16x32_bf16 v[44:47], a[68:71], a[12:15], 0
    ds_add_u32 v5, v6
    v_exp_f32 v50, v18
    v_mfma_f32_16x16x32_bf16 v[40:43], a[64:67], a[12:15], 0
    v_mov_b32_sdwa v64, v48 dst_sel:WORD_0 dst_unused:UNUSED_PRESERVE src0_sel:WORD_1
    v_exp_f32 v65, v19
    v_mfma_f32_16x16x32_bf16 v[96:99], a[72:75], v[72:75], v[96:99]
    s_add_u32 s36, s36, 4
    v_exp_f32 v52, v20
    v_mfma_f32_16x16x32_bf16 v[100:103], a[76:79], v[72:75], v[100:103]
    v_mov_b32_sdwa v65, v50 dst_sel:WORD_0 dst_unused:UNUSED_PRESERVE src0_sel:WORD_1
    v_exp_f32 v66, v21
    v_mfma_f32_16x16x32_bf16 v[108:111], a[76:79], v[76:79], v[108:111]
    v_exp_f32 v54, v22
    v_mfma_f32_16x16x32_bf16 v[104:107], a[72:75], v[76:79], v[104:107]
    v_mov_b32_sdwa v66, v52 dst_sel:WORD_0 dst_unused:UNUSED_PRESERVE src0_sel:WORD_1
    v_exp_f32 v67, v23
    v_smfmac_f32_16x16x64_bf16 v[116:119], v[8:11], v[72:79], v14
    s_waitcnt lgkmcnt(0)
    v_exp_f32 v56, v24
    v_mov_b32_sdwa v67, v54 dst_sel:WORD_0 dst_unused:UNUSED_PRESERVE src0_sel:WORD_1
    v_exp_f32 v68, v25
    v_exp_f32 v58, v26
    v_mov_b32_sdwa v68, v56 dst_sel:WORD_0 dst_unused:UNUSED_PRESERVE src0_sel:WORD_1
    v_exp_f32 v69, v27
    v_exp_f32 v60, v28
    v_mov_b32_sdwa v69, v58 dst_sel:WORD_0 dst_unused:UNUSED_PRESERVE src0_sel:WORD_1
    v_exp_f32 v70, v29
    v_exp_f32 v62, v30
    v_mov_b32_sdwa v70, v60 dst_sel:WORD_0 dst_unused:UNUSED_PRESERVE src0_sel:WORD_1
    v_exp_f32 v71, v31
    v_mfma_f32_16x16x32_bf16 v[16:19], a[56:59], a[0:3], 0
    ds_read_b128 a[64:67], v1 offset:38912
    v_exp_f32 v48, v32
    v_mfma_f32_16x16x32_bf16 v[20:23], a[60:63], a[0:3], 0
    v_mov_b32_sdwa v71, v62 dst_sel:WORD_0 dst_unused:UNUSED_PRESERVE src0_sel:WORD_1
    v_exp_f32 v72, v33
    v_mfma_f32_16x16x32_bf16 v[28:31], a[60:63], a[4:7], 0
    ds_read_b128 a[68:71], v1 offset:39936
    v_exp_f32 v50, v34
    v_mfma_f32_16x16x32_bf16 v[24:27], a[56:59], a[4:7], 0
    v_mov_b32_sdwa v72, v48 dst_sel:WORD_0 dst_unused:UNUSED_PRESERVE src0_sel:WORD_1
    v_exp_f32 v73, v35
    v_mfma_f32_16x16x32_bf16 v[80:83], a[80:83], v[64:67], v[80:83]
    ds_read_b64_tr_b16 a[72:73], v2 offset:45056
    v_exp_f32 v52, v36
    v_mfma_f32_16x16x32_bf16 v[84:87], a[84:87], v[64:67], v[84:87]
    ds_read_b64_tr_b16 a[74:75], v2 offset:46080
    v_mov_b32_sdwa v73, v50 dst_sel:WORD_0 dst_unused:UNUSED_PRESERVE src0_sel:WORD_1
    v_mfma_f32_16x16x32_bf16 v[92:95], a[84:87], v[68:71], v[92:95]
    ds_read_b64_tr_b16 a[76:77], v2 offset:45064
    v_exp_f32 v74, v37
    v_mfma_f32_16x16x32_bf16 v[88:91], a[80:83], v[68:71], v[88:91]
    v_exp_f32 v54, v38
    v_smfmac_f32_16x16x64_bf16 v[112:115], v[8:11], v[64:71], v14
    ds_read_b64_tr_b16 a[78:79], v2 offset:46088
    v_mov_b32_sdwa v74, v52 dst_sel:WORD_0 dst_unused:UNUSED_PRESERVE src0_sel:WORD_1
    v_exp_f32 v75, v39
    v_exp_f32 v56, v40
    v_mov_b32_sdwa v75, v54 dst_sel:WORD_0 dst_unused:UNUSED_PRESERVE src0_sel:WORD_1
    v_exp_f32 v76, v41
    v_exp_f32 v58, v42
    v_mov_b32_sdwa v76, v56 dst_sel:WORD_0 dst_unused:UNUSED_PRESERVE src0_sel:WORD_1
    v_exp_f32 v77, v43
    v_exp_f32 v60, v44
    v_mov_b32_sdwa v77, v58 dst_sel:WORD_0 dst_unused:UNUSED_PRESERVE src0_sel:WORD_1
    v_exp_f32 v78, v45
    v_exp_f32 v62, v46
    v_mov_b32_sdwa v78, v60 dst_sel:WORD_0 dst_unused:UNUSED_PRESERVE src0_sel:WORD_1
    v_exp_f32 v79, v47
    v_mfma_f32_16x16x32_bf16 v[32:35], a[56:59], a[8:11], 0
    ds_read_b32 v7, v5
    v_exp_f32 v48, v16
    v_mfma_f32_16x16x32_bf16 v[36:39], a[60:63], a[8:11], 0
    v_mov_b32_sdwa v79, v62 dst_sel:WORD_0 dst_unused:UNUSED_PRESERVE src0_sel:WORD_1
    v_exp_f32 v64, v17
    v_mfma_f32_16x16x32_bf16 v[44:47], a[60:63], a[12:15], 0
    v_exp_f32 v50, v18
    v_mfma_f32_16x16x32_bf16 v[40:43], a[56:59], a[12:15], 0
    v_mov_b32_sdwa v64, v48 dst_sel:WORD_0 dst_unused:UNUSED_PRESERVE src0_sel:WORD_1
    v_exp_f32 v65, v19
    v_mfma_f32_16x16x32_bf16 v[96:99], a[80:83], v[72:75], v[96:99]
    v_exp_f32 v52, v20
    v_mfma_f32_16x16x32_bf16 v[100:103], a[84:87], v[72:75], v[100:103]
    v_mov_b32_sdwa v65, v50 dst_sel:WORD_0 dst_unused:UNUSED_PRESERVE src0_sel:WORD_1
    v_exp_f32 v66, v21
    v_mfma_f32_16x16x32_bf16 v[108:111], a[84:87], v[76:79], v[108:111]
    v_exp_f32 v54, v22
    v_mfma_f32_16x16x32_bf16 v[104:107], a[80:83], v[76:79], v[104:107]
    v_mov_b32_sdwa v66, v52 dst_sel:WORD_0 dst_unused:UNUSED_PRESERVE src0_sel:WORD_1
    v_exp_f32 v67, v23
    v_smfmac_f32_16x16x64_bf16 v[116:119], v[8:11], v[72:79], v14
    s_waitcnt lgkmcnt(0)
    v_readfirstlane_b32 s37, v7
    v_exp_f32 v56, v24
    s_cmp_ge_u32 s37, s36
    s_cbranch_scc0 L_k2_kernel_spin2
L_k2_kernel_ok2:
    v_mov_b32_sdwa v67, v54 dst_sel:WORD_0 dst_unused:UNUSED_PRESERVE src0_sel:WORD_1
    v_exp_f32 v68, v25
    v_exp_f32 v58, v26
    v_mov_b32_sdwa v68, v56 dst_sel:WORD_0 dst_unused:UNUSED_PRESERVE src0_sel:WORD_1
    v_exp_f32 v69, v27
    v_exp_f32 v60, v28
    v_mov_b32_sdwa v69, v58 dst_sel:WORD_0 dst_unused:UNUSED_PRESERVE src0_sel:WORD_1
    v_exp_f32 v70, v29
    v_exp_f32 v62, v30
    v_mov_b32_sdwa v70, v60 dst_sel:WORD_0 dst_unused:UNUSED_PRESERVE src0_sel:WORD_1
    v_exp_f32 v71, v31
    v_mfma_f32_16x16x32_bf16 v[16:19], a[64:67], a[0:3], 0
    ds_read_b128 a[56:59], v1 offset:49152
    v_exp_f32 v48, v32
    v_mfma_f32_16x16x32_bf16 v[20:23], a[68:71], a[0:3], 0
    v_mov_b32_sdwa v71, v62 dst_sel:WORD_0 dst_unused:UNUSED_PRESERVE src0_sel:WORD_1
    v_exp_f32 v72, v33
    v_mfma_f32_16x16x32_bf16 v[28:31], a[68:71], a[4:7], 0
    ds_read_b128 a[60:63], v1 offset:50176
    v_exp_f32 v50, v34
    v_mfma_f32_16x16x32_bf16 v[24:27], a[64:67], a[4:7], 0
    v_mov_b32_sdwa v72, v48 dst_sel:WORD_0 dst_unused:UNUSED_PRESERVE src0_sel:WORD_1
    v_exp_f32 v73, v35
    v_mfma_f32_16x16x32_bf16 v[80:83], a[72:75], v[64:67], v[80:83]
    ds_read_b64_tr_b16 a[80:81], v2 offset:47104
    v_exp_f32 v52, v36
    v_mfma_f32_16x16x32_bf16 v[84:87], a[76:79], v[64:67], v[84:87]
    ds_read_b64_tr_b16 a[82:83], v2 offset:48128
    v_mov_b32_sdwa v73, v50 dst_sel:WORD_0 dst_unused:UNUSED_PRESERVE src0_sel:WORD_1
    v_mfma_f32_16x16x32_bf16 v[92:95], a[76:79], v[68:71], v[92:95]
    ds_read_b64_tr_b16 a[84:85], v2 offset:47112
    v_exp_f32 v74, v37
    v_mfma_f32_16x16x32_bf16 v[88:91], a[72:75], v[68:71], v[88:91]
    v_exp_f32 v54, v38
    v_smfmac_f32_16x16x64_bf16 v[112:115], v[8:11], v[64:71], v14
    ds_read_b64_tr_b16 a[86:87], v2 offset:48136
    v_mov_b32_sdwa v74, v52 dst_sel:WORD_0 dst_unused:UNUSED_PRESERVE src0_sel:WORD_1
    v_exp_f32 v75, v39
    v_exp_f32 v56, v40
    v_mov_b32_sdwa v75, v54 dst_sel:WORD_0 dst_unused:UNUSED_PRESERVE src0_sel:WORD_1
    v_exp_f32 v76, v41
    v_exp_f32 v58, v42
    v_mov_b32_sdwa v76, v56 dst_sel:WORD_0 dst_unused:UNUSED_PRESERVE src0_sel:WORD_1
    v_exp_f32 v77, v43
    v_exp_f32 v60, v44
    v_mov_b32_sdwa v77, v58 dst_sel:WORD_0 dst_unused:UNUSED_PRESERVE src0_sel:WORD_1
    v_exp_f32 v78, v45
    v_exp_f32 v62, v46
    v_mov_b32_sdwa v78, v60 dst_sel:WORD_0 dst_unused:UNUSED_PRESERVE src0_sel:WORD_1
    v_exp_f32 v79, v47
    v_mfma_f32_16x16x32_bf16 v[32:35], a[64:67], a[8:11], 0
    s_add_u32 m0, s27, 16384
    v_exp_f32 v48, v16
    v_mfma_f32_16x16x32_bf16 v[36:39], a[68:71], a[8:11], 0
    v_mov_b32_sdwa v79, v62 dst_sel:WORD_0 dst_unused:UNUSED_PRESERVE src0_sel:WORD_1
    v_exp_f32 v64, v17
    v_mfma_f32_16x16x32_bf16 v[44:47], a[68:71], a[12:15], 0
    buffer_load_dwordx4 v4, s[28:31], s26 offen lds
    buffer_load_dwordx4 v4, s[28:31], s26 offen offset:1024 lds
    v_exp_f32 v50, v18
    v_mfma_f32_16x16x32_bf16 v[40:43], a[64:67], a[12:15], 0
    v_mov_b32_sdwa v64, v48 dst_sel:WORD_0 dst_unused:UNUSED_PRESERVE src0_sel:WORD_1
    v_exp_f32 v65, v19
    v_mfma_f32_16x16x32_bf16 v[96:99], a[72:75], v[72:75], v[96:99]
    s_add_u32 m0, s27, 24576
    v_exp_f32 v52, v20
    v_mfma_f32_16x16x32_bf16 v[100:103], a[76:79], v[72:75], v[100:103]
    buffer_load_dwordx4 v4, s[40:43], s26 offen lds
    buffer_load_dwordx4 v4, s[40:43], s26 offen offset:1024 lds
    v_mov_b32_sdwa v65, v50 dst_sel:WORD_0 dst_unused:UNUSED_PRESERVE src0_sel:WORD_1
    v_exp_f32 v66, v21
    v_mfma_f32_16x16x32_bf16 v[108:111], a[76:79], v[76:79], v[108:111]
    s_add_u32 s26, s26, 8192
    v_exp_f32 v54, v22
    v_mfma_f32_16x16x32_bf16 v[104:107], a[72:75], v[76:79], v[104:107]
    v_mov_b32_sdwa v66, v52 dst_sel:WORD_0 dst_unused:UNUSED_PRESERVE src0_sel:WORD_1
    v_exp_f32 v67, v23
    v_smfmac_f32_16x16x64_bf16 v[116:119], v[8:11], v[72:79], v14
    s_waitcnt lgkmcnt(0)
    v_exp_f32 v56, v24
    v_mov_b32_sdwa v67, v54 dst_sel:WORD_0 dst_unused:UNUSED_PRESERVE src0_sel:WORD_1
    v_exp_f32 v68, v25
    v_exp_f32 v58, v26
    v_mov_b32_sdwa v68, v56 dst_sel:WORD_0 dst_unused:UNUSED_PRESERVE src0_sel:WORD_1
    v_exp_f32 v69, v27
    v_exp_f32 v60, v28
    v_mov_b32_sdwa v69, v58 dst_sel:WORD_0 dst_unused:UNUSED_PRESERVE src0_sel:WORD_1
    v_exp_f32 v70, v29
    v_exp_f32 v62, v30
    v_mov_b32_sdwa v70, v60 dst_sel:WORD_0 dst_unused:UNUSED_PRESERVE src0_sel:WORD_1
    v_exp_f32 v71, v31
    v_mfma_f32_16x16x32_bf16 v[16:19], a[56:59], a[0:3], 0
    ds_read_b128 a[64:67], v1 offset:51200
    v_exp_f32 v48, v32
    v_mfma_f32_16x16x32_bf16 v[20:23], a[60:63], a[0:3], 0
    v_mov_b32_sdwa v71, v62 dst_sel:WORD_0 dst_unused:UNUSED_PRESERVE src0_sel:WORD_1
    v_exp_f32 v72, v33
    v_mfma_f32_16x16x32_bf16 v[28:31], a[60:63], a[4:7], 0
    ds_read_b128 a[68:71], v1 offset:52224
    v_exp_f32 v50, v34
    v_mfma_f32_16x16x32_bf16 v[24:27], a[56:59], a[4:7], 0
    v_mov_b32_sdwa v72, v48 dst_sel:WORD_0 dst_unused:UNUSED_PRESERVE src0_sel:WORD_1
    v_exp_f32 v73, v35
    v_mfma_f32_16x16x32_bf16 v[80:83], a[80:83], v[64:67], v[80:83]
    ds_read_b64_tr_b16 a[72:73], v2 offset:57344
    v_exp_f32 v52, v36
    v_mfma_f32_16x16x32_bf16 v[84:87], a[84:87], v[64:67], v[84:87]
    ds_read_b64_tr_b16 a[74:75], v2 offset:58368
    v_mov_b32_sdwa v73, v50 dst_sel:WORD_0 dst_unused:UNUSED_PRESERVE src0_sel:WORD_1
    v_mfma_f32_16x16x32_bf16 v[92:95], a[84:87], v[68:71], v[92:95]
    ds_read_b64_tr_b16 a[76:77], v2 offset:57352
    v_exp_f32 v74, v37
    v_mfma_f32_16x16x32_bf16 v[88:91], a[80:83], v[68:71], v[88:91]
    v_exp_f32 v54, v38
    v_smfmac_f32_16x16x64_bf16 v[112:115], v[8:11], v[64:71], v14
    ds_read_b64_tr_b16 a[78:79], v2 offset:58376
    v_mov_b32_sdwa v74, v52 dst_sel:WORD_0 dst_unused:UNUSED_PRESERVE src0_sel:WORD_1
    v_exp_f32 v75, v39
    v_exp_f32 v56, v40
    v_mov_b32_sdwa v75, v54 dst_sel:WORD_0 dst_unused:UNUSED_PRESERVE src0_sel:WORD_1
    v_exp_f32 v76, v41
    v_exp_f32 v58, v42
    v_mov_b32_sdwa v76, v56 dst_sel:WORD_0 dst_unused:UNUSED_PRESERVE src0_sel:WORD_1
    v_exp_f32 v77, v43
    v_exp_f32 v60, v44
    v_mov_b32_sdwa v77, v58 dst_sel:WORD_0 dst_unused:UNUSED_PRESERVE src0_sel:WORD_1
    v_exp_f32 v78, v45
    v_exp_f32 v62, v46
    v_mov_b32_sdwa v78, v60 dst_sel:WORD_0 dst_unused:UNUSED_PRESERVE src0_sel:WORD_1
    v_exp_f32 v79, v47
    v_mfma_f32_16x16x32_bf16 v[32:35], a[56:59], a[8:11], 0
    v_exp_f32 v48, v16
    v_mfma_f32_16x16x32_bf16 v[36:39], a[60:63], a[8:11], 0
    v_mov_b32_sdwa v79, v62 dst_sel:WORD_0 dst_unused:UNUSED_PRESERVE src0_sel:WORD_1
    v_exp_f32 v64, v17
    v_mfma_f32_16x16x32_bf16 v[44:47], a[60:63], a[12:15], 0
    v_exp_f32 v50, v18
    v_mfma_f32_16x16x32_bf16 v[40:43], a[56:59], a[12:15], 0
    v_mov_b32_sdwa v64, v48 dst_sel:WORD_0 dst_unused:UNUSED_PRESERVE src0_sel:WORD_1
    v_exp_f32 v65, v19
    v_mfma_f32_16x16x32_bf16 v[96:99], a[80:83], v[72:75], v[96:99]
    v_exp_f32 v52, v20
    v_mfma_f32_16x16x32_bf16 v[100:103], a[84:87], v[72:75], v[100:103]
    v_mov_b32_sdwa v65, v50 dst_sel:WORD_0 dst_unused:UNUSED_PRESERVE src0_sel:WORD_1
    v_exp_f32 v66, v21
    v_mfma_f32_16x16x32_bf16 v[108:111], a[84:87], v[76:79], v[108:111]
    v_exp_f32 v54, v22
    v_mfma_f32_16x16x32_bf16 v[104:107], a[80:83], v[76:79], v[104:107]
    v_mov_b32_sdwa v66, v52 dst_sel:WORD_0 dst_unused:UNUSED_PRESERVE src0_sel:WORD_1
    v_exp_f32 v67, v23
    v_smfmac_f32_16x16x64_bf16 v[116:119], v[8:11], v[72:79], v14
    s_waitcnt lgkmcnt(0)
    v_exp_f32 v56, v24
    v_mov_b32_sdwa v67, v54 dst_sel:WORD_0 dst_unused:UNUSED_PRESERVE src0_sel:WORD_1
    v_exp_f32 v68, v25
    v_exp_f32 v58, v26
    v_mov_b32_sdwa v68, v56 dst_sel:WORD_0 dst_unused:UNUSED_PRESERVE src0_sel:WORD_1
    v_exp_f32 v69, v27
    v_exp_f32 v60, v28
    v_mov_b32_sdwa v69, v58 dst_sel:WORD_0 dst_unused:UNUSED_PRESERVE src0_sel:WORD_1
    v_exp_f32 v70, v29
    v_exp_f32 v62, v30
    v_mov_b32_sdwa v70, v60 dst_sel:WORD_0 dst_unused:UNUSED_PRESERVE src0_sel:WORD_1
    v_exp_f32 v71, v31
    v_mfma_f32_16x16x32_bf16 v[16:19], a[64:67], a[0:3], 0
    ds_read_b128 a[56:59], v1 offset:53248
    v_exp_f32 v48, v32
    v_mfma_f32_16x16x32_bf16 v[20:23], a[68:71], a[0:3], 0
    v_mov_b32_sdwa v71, v62 dst_sel:WORD_0 dst_unused:UNUSED_PRESERVE src0_sel:WORD_1
    v_exp_f32 v72, v33
    v_mfma_f32_16x16x32_bf16 v[28:31], a[68:71], a[4:7], 0
    ds_read_b128 a[60:63], v1 offset:54272
    v_exp_f32 v50, v34
    v_mfma_f32_16x16x32_bf16 v[24:27], a[64:67], a[4:7], 0
    v_mov_b32_sdwa v72, v48 dst_sel:WORD_0 dst_unused:UNUSED_PRESERVE src0_sel:WORD_1
    v_exp_f32 v73, v35
    v_mfma_f32_16x16x32_bf16 v[80:83], a[72:75], v[64:67], v[80:83]
    ds_read_b64_tr_b16 a[80:81], v2 offset:59392
    v_exp_f32 v52, v36
    v_mfma_f32_16x16x32_bf16 v[84:87], a[76:79], v[64:67], v[84:87]
    ds_read_b64_tr_b16 a[82:83], v2 offset:60416
    v_mov_b32_sdwa v73, v50 dst_sel:WORD_0 dst_unused:UNUSED_PRESERVE src0_sel:WORD_1
    v_mfma_f32_16x16x32_bf16 v[92:95], a[76:79], v[68:71], v[92:95]
    ds_read_b64_tr_b16 a[84:85], v2 offset:59400
    v_exp_f32 v74, v37
    v_mfma_f32_16x16x32_bf16 v[88:91], a[72:75], v[68:71], v[88:91]
    v_exp_f32 v54, v38
    v_smfmac_f32_16x16x64_bf16 v[112:115], v[8:11], v[64:71], v14
    ds_read_b64_tr_b16 a[86:87], v2 offset:60424
    v_mov_b32_sdwa v74, v52 dst_sel:WORD_0 dst_unused:UNUSED_PRESERVE src0_sel:WORD_1
    v_exp_f32 v75, v39
    v_exp_f32 v56, v40
    v_mov_b32_sdwa v75, v54 dst_sel:WORD_0 dst_unused:UNUSED_PRESERVE src0_sel:WORD_1
    v_exp_f32 v76, v41
    v_exp_f32 v58, v42
    v_mov_b32_sdwa v76, v56 dst_sel:WORD_0 dst_unused:UNUSED_PRESERVE src0_sel:WORD_1
    v_exp_f32 v77, v43
    v_exp_f32 v60, v44
    v_mov_b32_sdwa v77, v58 dst_sel:WORD_0 dst_unused:UNUSED_PRESERVE src0_sel:WORD_1
    v_exp_f32 v78, v45
    v_exp_f32 v62, v46
    v_mov_b32_sdwa v78, v60 dst_sel:WORD_0 dst_unused:UNUSED_PRESERVE src0_sel:WORD_1
    v_exp_f32 v79, v47
    v_mfma_f32_16x16x32_bf16 v[32:35], a[64:67], a[8:11], 0
    s_waitcnt vmcnt(5)
    v_exp_f32 v48, v16
    v_mfma_f32_16x16x32_bf16 v[36:39], a[68:71], a[8:11], 0
    v_mov_b32_sdwa v79, v62 dst_sel:WORD_0 dst_unused:UNUSED_PRESERVE src0_sel:WORD_1
    v_exp_f32 v64, v17
    v_mfma_f32_16x16x32_bf16 v[44:47], a[68:71], a[12:15], 0
    ds_add_u32 v5, v6
    v_exp_f32 v50, v18
    v_mfma_f32_16x16x32_bf16 v[40:43], a[64:67], a[12:15], 0
    v_mov_b32_sdwa v64, v48 dst_sel:WORD_0 dst_unused:UNUSED_PRESERVE src0_sel:WORD_1
    v_exp_f32 v65, v19
    v_mfma_f32_16x16x32_bf16 v[96:99], a[72:75], v[72:75], v[96:99]
    s_add_u32 s36, s36, 4
    v_exp_f32 v52, v20
    v_mfma_f32_16x16x32_bf16 v[100:103], a[76:79], v[72:75], v[100:103]
    s_cmp_eq_u32 s14, 3
    s_cselect_b32 s20, s54, s20
    s_cselect_b32 s21, s55, s21
    s_cselect_b32 s22, 2097152, s22
    s_cselect_b32 s24, 0, s24
    v_mov_b32_sdwa v65, v50 dst_sel:WORD_0 dst_unused:UNUSED_PRESERVE src0_sel:WORD_1
    v_exp_f32 v66, v21
    v_mfma_f32_16x16x32_bf16 v[108:111], a[76:79], v[76:79], v[108:111]
    v_exp_f32 v54, v22
    v_mfma_f32_16x16x32_bf16 v[104:107], a[72:75], v[76:79], v[104:107]
    v_mov_b32_sdwa v66, v52 dst_sel:WORD_0 dst_unused:UNUSED_PRESERVE src0_sel:WORD_1
    v_exp_f32 v67, v23
    v_smfmac_f32_16x16x64_bf16 v[116:119], v[8:11], v[72:79], v14
    s_waitcnt lgkmcnt(0)
    v_exp_f32 v56, v24
    v_mov_b32_sdwa v67, v54 dst_sel:WORD_0 dst_unused:UNUSED_PRESERVE src0_sel:WORD_1
    v_exp_f32 v68, v25
    v_exp_f32 v58, v26
    v_mov_b32_sdwa v68, v56 dst_sel:WORD_0 dst_unused:UNUSED_PRESERVE src0_sel:WORD_1
    v_exp_f32 v69, v27
    v_exp_f32 v60, v28
    v_mov_b32_sdwa v69, v58 dst_sel:WORD_0 dst_unused:UNUSED_PRESERVE src0_sel:WORD_1
    v_exp_f32 v70, v29
    v_exp_f32 v62, v30
    v_mov_b32_sdwa v70, v60 dst_sel:WORD_0 dst_unused:UNUSED_PRESERVE src0_sel:WORD_1
    v_exp_f32 v71, v31
    v_mfma_f32_16x16x32_bf16 v[16:19], a[56:59], a[0:3], 0
    ds_read_b128 a[64:67], v1 offset:55296
    v_exp_f32 v48, v32
    v_mfma_f32_16x16x32_bf16 v[20:23], a[60:63], a[0:3], 0
    v_mov_b32_sdwa v71, v62 dst_sel:WORD_0 dst_unused:UNUSED_PRESERVE src0_sel:WORD_1
    v_exp_f32 v72, v33
    v_mfma_f32_16x16x32_bf16 v[28:31], a[60:63], a[4:7], 0
    ds_read_b128 a[68:71], v1 offset:56320
    v_exp_f32 v50, v34
    v_mfma_f32_16x16x32_bf16 v[24:27], a[56:59], a[4:7], 0
    v_mov_b32_sdwa v72, v48 dst_sel:WORD_0 dst_unused:UNUSED_PRESERVE src0_sel:WORD_1
    v_exp_f32 v73, v35
    v_mfma_f32_16x16x32_bf16 v[80:83], a[80:83], v[64:67], v[80:83]
    ds_read_b64_tr_b16 a[72:73], v2 offset:61440
    v_exp_f32 v52, v36
    v_mfma_f32_16x16x32_bf16 v[84:87], a[84:87], v[64:67], v[84:87]
    ds_read_b64_tr_b16 a[74:75], v2 offset:62464
    v_mov_b32_sdwa v73, v50 dst_sel:WORD_0 dst_unused:UNUSED_PRESERVE src0_sel:WORD_1
    v_mfma_f32_16x16x32_bf16 v[92:95], a[84:87], v[68:71], v[92:95]
    ds_read_b64_tr_b16 a[76:77], v2 offset:61448
    v_exp_f32 v74, v37
    v_mfma_f32_16x16x32_bf16 v[88:91], a[80:83], v[68:71], v[88:91]
    v_exp_f32 v54, v38
    v_smfmac_f32_16x16x64_bf16 v[112:115], v[8:11], v[64:71], v14
    ds_read_b64_tr_b16 a[78:79], v2 offset:62472
    v_mov_b32_sdwa v74, v52 dst_sel:WORD_0 dst_unused:UNUSED_PRESERVE src0_sel:WORD_1
    v_exp_f32 v75, v39
    v_exp_f32 v56, v40
    v_mov_b32_sdwa v75, v54 dst_sel:WORD_0 dst_unused:UNUSED_PRESERVE src0_sel:WORD_1
    v_exp_f32 v76, v41
    v_exp_f32 v58, v42
    v_mov_b32_sdwa v76, v56 dst_sel:WORD_0 dst_unused:UNUSED_PRESERVE src0_sel:WORD_1
    v_exp_f32 v77, v43
    v_exp_f32 v60, v44
    v_mov_b32_sdwa v77, v58 dst_sel:WORD_0 dst_unused:UNUSED_PRESERVE src0_sel:WORD_1
    v_exp_f32 v78, v45
    v_exp_f32 v62, v46
    v_mov_b32_sdwa v78, v60 dst_sel:WORD_0 dst_unused:UNUSED_PRESERVE src0_sel:WORD_1
    v_exp_f32 v79, v47
    v_mfma_f32_16x16x32_bf16 v[32:35], a[56:59], a[8:11], 0
    ds_read_b32 v7, v5
    v_exp_f32 v48, v16
    v_mfma_f32_16x16x32_bf16 v[36:39], a[60:63], a[8:11], 0
    v_mov_b32_sdwa v79, v62 dst_sel:WORD_0 dst_unused:UNUSED_PRESERVE src0_sel:WORD_1
    v_exp_f32 v64, v17
    v_mfma_f32_16x16x32_bf16 v[44:47], a[60:63], a[12:15], 0
    v_exp_f32 v50, v18
    v_mfma_f32_16x16x32_bf16 v[40:43], a[56:59], a[12:15], 0
    v_mov_b32_sdwa v64, v48 dst_sel:WORD_0 dst_unused:UNUSED_PRESERVE src0_sel:WORD_1
    v_exp_f32 v65, v19
    v_mfma_f32_16x16x32_bf16 v[96:99], a[80:83], v[72:75], v[96:99]
    v_exp_f32 v52, v20
    v_mfma_f32_16x16x32_bf16 v[100:103], a[84:87], v[72:75], v[100:103]
    v_mov_b32_sdwa v65, v50 dst_sel:WORD_0 dst_unused:UNUSED_PRESERVE src0_sel:WORD_1
    v_exp_f32 v66, v21
    v_mfma_f32_16x16x32_bf16 v[108:111], a[84:87], v[76:79], v[108:111]
    v_exp_f32 v54, v22
    v_mfma_f32_16x16x32_bf16 v[104:107], a[80:83], v[76:79], v[104:107]
    v_mov_b32_sdwa v66, v52 dst_sel:WORD_0 dst_unused:UNUSED_PRESERVE src0_sel:WORD_1
    v_exp_f32 v67, v23
    v_smfmac_f32_16x16x64_bf16 v[116:119], v[8:11], v[72:79], v14
    s_waitcnt lgkmcnt(0)
    v_readfirstlane_b32 s37, v7
    v_exp_f32 v56, v24
    s_cmp_ge_u32 s37, s36
    s_cbranch_scc0 L_k2_kernel_spin3
L_k2_kernel_ok3:
    v_mov_b32_sdwa v67, v54 dst_sel:WORD_0 dst_unused:UNUSED_PRESERVE src0_sel:WORD_1
    v_exp_f32 v68, v25
    v_exp_f32 v58, v26
    v_mov_b32_sdwa v68, v56 dst_sel:WORD_0 dst_unused:UNUSED_PRESERVE src0_sel:WORD_1
    v_exp_f32 v69, v27
    v_exp_f32 v60, v28
    v_mov_b32_sdwa v69, v58 dst_sel:WORD_0 dst_unused:UNUSED_PRESERVE src0_sel:WORD_1
    v_exp_f32 v70, v29
    v_exp_f32 v62, v30
    v_mov_b32_sdwa v70, v60 dst_sel:WORD_0 dst_unused:UNUSED_PRESERVE src0_sel:WORD_1
    v_exp_f32 v71, v31
    v_mfma_f32_16x16x32_bf16 v[16:19], a[64:67], a[0:3], 0
    ds_read_b128 a[56:59], v1 offset:0
    v_exp_f32 v48, v32
    v_mfma_f32_16x16x32_bf16 v[20:23], a[68:71], a[0:3], 0
    v_mov_b32_sdwa v71, v62 dst_sel:WORD_0 dst_unused:UNUSED_PRESERVE src0_sel:WORD_1
    v_exp_f32 v72, v33
    v_mfma_f32_16x16x32_bf16 v[28:31], a[68:71], a[4:7], 0
    ds_read_b128 a[60:63], v1 offset:1024
    v_exp_f32 v50, v34
    v_mfma_f32_16x16x32_bf16 v[24:27], a[64:67], a[4:7], 0
    v_mov_b32_sdwa v72, v48 dst_sel:WORD_0 dst_unused:UNUSED_PRESERVE src0_sel:WORD_1
    v_exp_f32 v73, v35
    v_mfma_f32_16x16x32_bf16 v[80:83], a[72:75], v[64:67], v[80:83]
    ds_read_b64_tr_b16 a[80:81], v2 offset:63488
    v_exp_f32 v52, v36
    v_mfma_f32_16x16x32_bf16 v[84:87], a[76:79], v[64:67], v[84:87]
    ds_read_b64_tr_b16 a[82:83], v2 offset:64512
    v_mov_b32_sdwa v73, v50 dst_sel:WORD_0 dst_unused:UNUSED_PRESERVE src0_sel:WORD_1
    v_mfma_f32_16x16x32_bf16 v[92:95], a[76:79], v[68:71], v[92:95]
    ds_read_b64_tr_b16 a[84:85], v2 offset:63496
    v_exp_f32 v74, v37
    v_mfma_f32_16x16x32_bf16 v[88:91], a[72:75], v[68:71], v[88:91]
    v_exp_f32 v54, v38
    v_smfmac_f32_16x16x64_bf16 v[112:115], v[8:11], v[64:71], v14
    ds_read_b64_tr_b16 a[86:87], v2 offset:64520
    v_mov_b32_sdwa v74, v52 dst_sel:WORD_0 dst_unused:UNUSED_PRESERVE src0_sel:WORD_1
    v_exp_f32 v75, v39
    v_exp_f32 v56, v40
    v_mov_b32_sdwa v75, v54 dst_sel:WORD_0 dst_unused:UNUSED_PRESERVE src0_sel:WORD_1
    v_exp_f32 v76, v41
    v_exp_f32 v58, v42
    v_mov_b32_sdwa v76, v56 dst_sel:WORD_0 dst_unused:UNUSED_PRESERVE src0_sel:WORD_1
    v_exp_f32 v77, v43
    v_exp_f32 v60, v44
    v_mov_b32_sdwa v77, v58 dst_sel:WORD_0 dst_unused:UNUSED_PRESERVE src0_sel:WORD_1
    v_exp_f32 v78, v45
    v_exp_f32 v62, v46
    v_mov_b32_sdwa v78, v60 dst_sel:WORD_0 dst_unused:UNUSED_PRESERVE src0_sel:WORD_1
    v_exp_f32 v79, v47
    v_mfma_f32_16x16x32_bf16 v[32:35], a[64:67], a[8:11], 0
    s_add_u32 m0, s27, 32768
    v_exp_f32 v48, v16
    v_mfma_f32_16x16x32_bf16 v[36:39], a[68:71], a[8:11], 0
    v_mov_b32_sdwa v79, v62 dst_sel:WORD_0 dst_unused:UNUSED_PRESERVE src0_sel:WORD_1
    v_exp_f32 v64, v17
    v_mfma_f32_16x16x32_bf16 v[44:47], a[68:71], a[12:15], 0
    buffer_load_dwordx4 v4, s[28:31], s26 offen lds
    buffer_load_dwordx4 v4, s[28:31], s26 offen offset:1024 lds
    v_exp_f32 v50, v18
    v_mfma_f32_16x16x32_bf16 v[40:43], a[64:67], a[12:15], 0
    v_mov_b32_sdwa v64, v48 dst_sel:WORD_0 dst_unused:UNUSED_PRESERVE src0_sel:WORD_1
    v_exp_f32 v65, v19
    v_mfma_f32_16x16x32_bf16 v[96:99], a[72:75], v[72:75], v[96:99]
    s_add_u32 m0, s27, 40960
    v_exp_f32 v52, v20
    v_mfma_f32_16x16x32_bf16 v[100:103], a[76:79], v[72:75], v[100:103]
    buffer_load_dwordx4 v4, s[40:43], s26 offen lds
    buffer_load_dwordx4 v4, s[40:43], s26 offen offset:1024 lds
    v_mov_b32_sdwa v65, v50 dst_sel:WORD_0 dst_unused:UNUSED_PRESERVE src0_sel:WORD_1
    v_exp_f32 v66, v21
    v_mfma_f32_16x16x32_bf16 v[108:111], a[76:79], v[76:79], v[108:111]
    s_add_u32 s26, s26, 8192
    v_exp_f32 v54, v22
    v_mfma_f32_16x16x32_bf16 v[104:107], a[72:75], v[76:79], v[104:107]
    v_mov_b32_sdwa v66, v52 dst_sel:WORD_0 dst_unused:UNUSED_PRESERVE src0_sel:WORD_1
    v_exp_f32 v67, v23
    v_smfmac_f32_16x16x64_bf16 v[116:119], v[8:11], v[72:79], v14
    s_waitcnt lgkmcnt(0)
    v_exp_f32 v56, v24
    v_mov_b32_sdwa v67, v54 dst_sel:WORD_0 dst_unused:UNUSED_PRESERVE src0_sel:WORD_1
    v_exp_f32 v68, v25
    v_exp_f32 v58, v26
    v_mov_b32_sdwa v68, v56 dst_sel:WORD_0 dst_unused:UNUSED_PRESERVE src0_sel:WORD_1
    v_exp_f32 v69, v27
    v_exp_f32 v60, v28
    v_mov_b32_sdwa v69, v58 dst_sel:WORD_0 dst_unused:UNUSED_PRESERVE src0_sel:WORD_1
    v_exp_f32 v70, v29
    v_exp_f32 v62, v30
    v_mov_b32_sdwa v70, v60 dst_sel:WORD_0 dst_unused:UNUSED_PRESERVE src0_sel:WORD_1
    v_exp_f32 v71, v31
    v_mfma_f32_16x16x32_bf16 v[16:19], a[56:59], a[0:3], 0
    ds_read_b128 a[64:67], v1 offset:2048
    v_exp_f32 v48, v32
    v_mfma_f32_16x16x32_bf16 v[20:23], a[60:63], a[0:3], 0
    v_mov_b32_sdwa v71, v62 dst_sel:WORD_0 dst_unused:UNUSED_PRESERVE src0_sel:WORD_1
    v_exp_f32 v72, v33
    v_mfma_f32_16x16x32_bf16 v[28:31], a[60:63], a[4:7], 0
    ds_read_b128 a[68:71], v1 offset:3072
    v_exp_f32 v50, v34
    v_mfma_f32_16x16x32_bf16 v[24:27], a[56:59], a[4:7], 0
    v_mov_b32_sdwa v72, v48 dst_sel:WORD_0 dst_unused:UNUSED_PRESERVE src0_sel:WORD_1
    v_exp_f32 v73, v35
    v_mfma_f32_16x16x32_bf16 v[80:83], a[80:83], v[64:67], v[80:83]
    ds_read_b64_tr_b16 a[72:73], v2 offset:8192
    v_exp_f32 v52, v36
    v_mfma_f32_16x16x32_bf16 v[84:87], a[84:87], v[64:67], v[84:87]
    ds_read_b64_tr_b16 a[74:75], v2 offset:9216
    v_mov_b32_sdwa v73, v50 dst_sel:WORD_0 dst_unused:UNUSED_PRESERVE src0_sel:WORD_1
    v_mfma_f32_16x16x32_bf16 v[92:95], a[84:87], v[68:71], v[92:95]
    ds_read_b64_tr_b16 a[76:77], v2 offset:8200
    v_exp_f32 v74, v37
    v_mfma_f32_16x16x32_bf16 v[88:91], a[80:83], v[68:71], v[88:91]
    v_exp_f32 v54, v38
    v_smfmac_f32_16x16x64_bf16 v[112:115], v[8:11], v[64:71], v14
    ds_read_b64_tr_b16 a[78:79], v2 offset:9224
    v_mov_b32_sdwa v74, v52 dst_sel:WORD_0 dst_unused:UNUSED_PRESERVE src0_sel:WORD_1
    v_exp_f32 v75, v39
    v_exp_f32 v56, v40
    v_mov_b32_sdwa v75, v54 dst_sel:WORD_0 dst_unused:UNUSED_PRESERVE src0_sel:WORD_1
    v_exp_f32 v76, v41
    v_exp_f32 v58, v42
    v_mov_b32_sdwa v76, v56 dst_sel:WORD_0 dst_unused:UNUSED_PRESERVE src0_sel:WORD_1
    v_exp_f32 v77, v43
    v_exp_f32 v60, v44
    v_mov_b32_sdwa v77, v58 dst_sel:WORD_0 dst_unused:UNUSED_PRESERVE src0_sel:WORD_1
    v_exp_f32 v78, v45
    v_exp_f32 v62, v46
    v_mov_b32_sdwa v78, v60 dst_sel:WORD_0 dst_unused:UNUSED_PRESERVE src0_sel:WORD_1
    v_exp_f32 v79, v47
    s_sub_u32 s14, s14, 1
    s_cmp_lg_u32 s14, 0
    s_cbranch_scc1 L_k2_kernel_aloop
    v_mov_b32_sdwa v79, v62 dst_sel:WORD_0 dst_unused:UNUSED_PRESERVE src0_sel:WORD_1
    v_mfma_f32_16x16x32_bf16 v[96:99], a[80:83], v[72:75], v[96:99]
    v_mfma_f32_16x16x32_bf16 v[100:103], a[84:87], v[72:75], v[100:103]
    v_mfma_f32_16x16x32_bf16 v[108:111], a[84:87], v[76:79], v[108:111]
    v_mfma_f32_16x16x32_bf16 v[104:107], a[80:83], v[76:79], v[104:107]
    v_smfmac_f32_16x16x64_bf16 v[116:119], v[8:11], v[72:79], v14
    s_mov_b32 s50, 0
L_k2_kernel_norm:
    v_add_f32 v120, v112, v113
    v_rcp_f32 v6, v120
    s_nop 0
    v_mul_f32 v80, v80, v6
    v_mul_f32 v81, v81, v6
    v_mul_f32 v82, v82, v6
    v_mul_f32 v83, v83, v6
    v_mul_f32 v84, v84, v6
    v_mul_f32 v85, v85, v6
    v_mul_f32 v86, v86, v6
    v_mul_f32 v87, v87, v6
    v_cvt_pk_bf16_f32 v48, v80, v81
    v_cvt_pk_bf16_f32 v49, v82, v83
    v_cvt_pk_bf16_f32 v50, v84, v85
    v_cvt_pk_bf16_f32 v51, v86, v87
    buffer_store_dwordx4 v[48:51], v1, s[8:11], s13 offen offset:0 sc1
    v_add_f32 v121, v114, v115
    v_rcp_f32 v6, v121
    s_nop 0
    v_mul_f32 v88, v88, v6
    v_mul_f32 v89, v89, v6
    v_mul_f32 v90, v90, v6
    v_mul_f32 v91, v91, v6
    v_mul_f32 v92, v92, v6
    v_mul_f32 v93, v93, v6
    v_mul_f32 v94, v94, v6
    v_mul_f32 v95, v95, v6
    v_cvt_pk_bf16_f32 v52, v88, v89
    v_cvt_pk_bf16_f32 v53, v90, v91
    v_cvt_pk_bf16_f32 v54, v92, v93
    v_cvt_pk_bf16_f32 v55, v94, v95
    buffer_store_dwordx4 v[52:55], v1, s[8:11], s13 offen offset:1024 sc1
    v_add_f32 v122, v116, v117
    v_rcp_f32 v6, v122
    s_nop 0
    v_mul_f32 v96, v96, v6
    v_mul_f32 v97, v97, v6
    v_mul_f32 v98, v98, v6
    v_mul_f32 v99, v99, v6
    v_mul_f32 v100, v100, v6
    v_mul_f32 v101, v101, v6
    v_mul_f32 v102, v102, v6
    v_mul_f32 v103, v103, v6
    v_cvt_pk_bf16_f32 v56, v96, v97
    v_cvt_pk_bf16_f32 v57, v98, v99
    v_cvt_pk_bf16_f32 v58, v100, v101
    v_cvt_pk_bf16_f32 v59, v102, v103
    buffer_store_dwordx4 v[56:59], v1, s[8:11], s13 offen offset:2048 sc1
    v_add_f32 v123, v118, v119
    v_rcp_f32 v6, v123
    s_nop 0
    v_mul_f32 v104, v104, v6
    v_mul_f32 v105, v105, v6
    v_mul_f32 v106, v106, v6
    v_mul_f32 v107, v107, v6
    v_mul_f32 v108, v108, v6
    v_mul_f32 v109, v109, v6
    v_mul_f32 v110, v110, v6
    v_mul_f32 v111, v111, v6
    v_cvt_pk_bf16_f32 v60, v104, v105
    v_cvt_pk_bf16_f32 v61, v106, v107
    v_cvt_pk_bf16_f32 v62, v108, v109
    v_cvt_pk_bf16_f32 v63, v110, v111
    buffer_store_dwordx4 v[60:63], v1, s[8:11], s13 offen offset:3072 sc1
    v_max_f32 v6, |v80|, |v81|
    v_max3_f32 v6, v6, |v82|, |v83|
    v_max3_f32 v6, v6, |v84|, |v85|
    v_max3_f32 v6, v6, |v86|, |v87|
    v_max3_f32 v6, v6, |v88|, |v89|
    v_max3_f32 v6, v6, |v90|, |v91|
    v_max3_f32 v6, v6, |v92|, |v93|
    v_max3_f32 v6, v6, |v94|, |v95|
    v_max3_f32 v6, v6, |v96|, |v97|
    v_max3_f32 v6, v6, |v98|, |v99|
    v_max3_f32 v6, v6, |v100|, |v101|
    v_max3_f32 v6, v6, |v102|, |v103|
    v_max3_f32 v6, v6, |v104|, |v105|
    v_max3_f32 v6, v6, |v106|, |v107|
    v_max3_f32 v6, v6, |v108|, |v109|
    v_max3_f32 v6, v6, |v110|, |v111|
    v_min_f32 v7, v120, v121
    v_min3_f32 v7, v7, v122, v123
    v_max_f32 v12, v120, v121
    v_max3_f32 v12, v12, v122, v123
    v_add_f32 v4, v120, v121
    v_add_f32 v5, v122, v123
    s_mov_b32 s33, 0x1f800000
    s_mov_b32 s34, 0x5f800000
    v_cmp_le_f32 s[44:45], s33, v7
    v_cmp_ge_f32 s[46:47], s34, v12
    v_cmp_o_f32 s[48:49], v4, v5
    v_cmp_gt_f32 vcc, 0x7f800000, v6
    s_and_b64 s[44:45], s[44:45], s[46:47]
    s_and_b64 s[44:45], s[44:45], s[48:49]
    s_and_b64 s[44:45], s[44:45], vcc
    s_cmp_eq_u64 s[44:45], -1
    s_cselect_b32 s33, 1, s50
    s_cmp_eq_u32 s33, 0
    s_cbranch_scc1 L_k2_kernel_slow
    s_lshl_b32 s33, s15, 1
    s_lshr_b32 s34, s3, 1
    s_add_u32 s33, s33, s34
    s_lshl_b32 s33, s33, 8
    s_add_u32 s33, s33, 35651584
    v_mov_b32 v4, 1
    v_mov_b32 v5, 0
    s_waitcnt vmcnt(0)
    s_mov_b64 exec, 1
    buffer_atomic_add v4, v5, s[8:11], s33 offen sc1
    s_mov_b64 exec, -1
L_k2_kernel_owatch:
L_k2_kernel_aend:
    s_endpgm
L_k2_kernel_spinp:
    ds_read_b32 v7, v5
    s_waitcnt lgkmcnt(0)
    v_readfirstlane_b32 s37, v7
    s_nop 0
    s_cmp_ge_u32 s37, s36
    s_cbranch_scc0 L_k2_kernel_spinp
    s_branch L_k2_kernel_okp
L_k2_kernel_spin0:
    ds_read_b32 v7, v5
    s_waitcnt lgkmcnt(0)
    v_readfirstlane_b32 s37, v7
    s_nop 0
    s_cmp_ge_u32 s37, s36
    s_cbranch_scc0 L_k2_kernel_spin0
    s_branch L_k2_kernel_ok0
L_k2_kernel_spin1:
    ds_read_b32 v7, v5
    s_waitcnt lgkmcnt(0)
    v_readfirstlane_b32 s37, v7
    s_nop 0
    s_cmp_ge_u32 s37, s36
    s_cbranch_scc0 L_k2_kernel_spin1
    s_branch L_k2_kernel_ok1
L_k2_kernel_spin2:
    ds_read_b32 v7, v5
    s_waitcnt lgkmcnt(0)
    v_readfirstlane_b32 s37, v7
    s_nop 0
    s_cmp_ge_u32 s37, s36
    s_cbranch_scc0 L_k2_kernel_spin2
    s_branch L_k2_kernel_ok2
L_k2_kernel_spin3:
    ds_read_b32 v7, v5
    s_waitcnt lgkmcnt(0)
    v_readfirstlane_b32 s37, v7
    s_nop 0
    s_cmp_ge_u32 s37, s36
    s_cbranch_scc0 L_k2_kernel_spin3
    s_branch L_k2_kernel_ok3
L_k2_kernel_slow:
    s_waitcnt vmcnt(0) lgkmcnt(0)
    s_add_u32 s33, s27, 16384
    s_mov_b32 m0, s33
    v_add_u32 v4, 0, v1
    v_add_u32 v6, s33, v2
    s_mov_b32 s26, 0
    v_mov_b32 v56, 0xff800000
    v_mov_b32 v57, 0xff800000
    v_mov_b32 v58, 0xff800000
    v_mov_b32 v59, 0xff800000
    v_mov_b32 v60, 0
    v_mov_b32 v61, 0
    v_mov_b32 v62, 0
    v_mov_b32 v63, 0
    v_mov_b32 v80, 0
    v_mov_b32 v81, 0
    v_mov_b32 v82, 0
    v_mov_b32 v83, 0
    v_mov_b32 v84, 0
    v_mov_b32 v85, 0
    v_mov_b32 v86, 0
    v_mov_b32 v87, 0
    v_mov_b32 v88, 0
    v_mov_b32 v89, 0
    v_mov_b32 v90, 0
    v_mov_b32 v91, 0
    v_mov_b32 v92, 0
    v_mov_b32 v93, 0
    v_mov_b32 v94, 0
    v_mov_b32 v95, 0
    v_mov_b32 v96, 0
    v_mov_b32 v97, 0
    v_mov_b32 v98, 0
    v_mov_b32 v99, 0
    v_mov_b32 v100, 0
    v_mov_b32 v101, 0
    v_mov_b32 v102, 0
    v_mov_b32 v103, 0
    v_mov_b32 v104, 0
    v_mov_b32 v105, 0
    v_mov_b32 v106, 0
    v_mov_b32 v107, 0
    v_mov_b32 v108, 0
    v_mov_b32 v109, 0
    v_mov_b32 v110, 0
    v_mov_b32 v111, 0
L_k2_kernel_slowloop:
    buffer_load_dwordx4 v4, s[40:43], s26 offen lds
    buffer_load_dwordx4 v4, s[40:43], s26 offen offset:1024 lds
    buffer_load_dwordx4 v[40:43], v1, s[28:31], s26 offen
    buffer_load_dwordx4 v[44:47], v1, s[28:31], s26 offen offset:1024
    s_waitcnt vmcnt(0)
    ds_read_b64_tr_b16 v[48:49], v6 offset:0
    ds_read_b64_tr_b16 v[50:51], v6 offset:1024
    ds_read_b64_tr_b16 v[52:53], v6 offset:8
    ds_read_b64_tr_b16 v[54:55], v6 offset:1032
    v_mfma_f32_16x16x32_bf16 v[16:19], v[40:43], a[0:3], 0
    v_mfma_f32_16x16x32_bf16 v[20:23], v[44:47], a[0:3], 0
    s_nop 6
    v_max3_f32 v64, v56, v16, v17
    v_max3_f32 v64, v64, v18, v19
    v_max3_f32 v64, v64, v20, v21
    v_max3_f32 v64, v64, v22, v23
    v_mov_b32 v65, v64
    s_nop 1
    v_permlane16_swap_b32 v64, v65
    v_max_f32 v64, v64, v65
    v_mov_b32 v65, v64
    s_nop 1
    v_permlane32_swap_b32 v64, v65
    v_max_f32 v64, v64, v65
    v_sub_f32 v65, v56, v64
    v_exp_f32 v65, v65
    v_mov_b32 v56, v64
    v_sub_f32 v16, v16, v64
    v_sub_f32 v17, v17, v64
    v_sub_f32 v18, v18, v64
    v_sub_f32 v19, v19, v64
    v_sub_f32 v20, v20, v64
    v_sub_f32 v21, v21, v64
    v_sub_f32 v22, v22, v64
    v_sub_f32 v23, v23, v64
    v_exp_f32 v16, v16
    v_exp_f32 v17, v17
    v_exp_f32 v18, v18
    v_exp_f32 v19, v19
    v_exp_f32 v20, v20
    v_exp_f32 v21, v21
    v_exp_f32 v22, v22
    v_exp_f32 v23, v23
    v_mul_f32 v60, v60, v65
    v_mul_f32 v80, v80, v65
    v_mul_f32 v81, v81, v65
    v_mul_f32 v82, v82, v65
    v_mul_f32 v83, v83, v65
    v_mul_f32 v84, v84, v65
    v_mul_f32 v85, v85, v65
    v_mul_f32 v86, v86, v65
    v_mul_f32 v87, v87, v65
    v_cvt_pk_bf16_f32 v24, v16, v17
    v_cvt_pk_bf16_f32 v25, v18, v19
    v_cvt_pk_bf16_f32 v26, v20, v21
    v_cvt_pk_bf16_f32 v27, v22, v23
    v_add_f32 v60, v60, v16
    v_add_f32 v60, v60, v17
    v_add_f32 v60, v60, v18
    v_add_f32 v60, v60, v19
    v_add_f32 v60, v60, v20
    v_add_f32 v60, v60, v21
    v_add_f32 v60, v60, v22
    v_add_f32 v60, v60, v23
    s_waitcnt lgkmcnt(2)
    v_mfma_f32_16x16x32_bf16 v[80:83], v[48:51], v[24:27], v[80:83]
    s_waitcnt lgkmcnt(0)
    v_mfma_f32_16x16x32_bf16 v[84:87], v[52:55], v[24:27], v[84:87]
    v_mfma_f32_16x16x32_bf16 v[16:19], v[40:43], a[4:7], 0
    v_mfma_f32_16x16x32_bf16 v[20:23], v[44:47], a[4:7], 0
    s_nop 6
    v_max3_f32 v64, v57, v16, v17
    v_max3_f32 v64, v64, v18, v19
    v_max3_f32 v64, v64, v20, v21
    v_max3_f32 v64, v64, v22, v23
    v_mov_b32 v65, v64
    s_nop 1
    v_permlane16_swap_b32 v64, v65
    v_max_f32 v64, v64, v65
    v_mov_b32 v65, v64
    s_nop 1
    v_permlane32_swap_b32 v64, v65
    v_max_f32 v64, v64, v65
    v_sub_f32 v65, v57, v64
    v_exp_f32 v65, v65
    v_mov_b32 v57, v64
    v_sub_f32 v16, v16, v64
    v_sub_f32 v17, v17, v64
    v_sub_f32 v18, v18, v64
    v_sub_f32 v19, v19, v64
    v_sub_f32 v20, v20, v64
    v_sub_f32 v21, v21, v64
    v_sub_f32 v22, v22, v64
    v_sub_f32 v23, v23, v64
    v_exp_f32 v16, v16
    v_exp_f32 v17, v17
    v_exp_f32 v18, v18
    v_exp_f32 v19, v19
    v_exp_f32 v20, v20
    v_exp_f32 v21, v21
    v_exp_f32 v22, v22
    v_exp_f32 v23, v23
    v_mul_f32 v61, v61, v65
    v_mul_f32 v88, v88, v65
    v_mul_f32 v89, v89, v65
    v_mul_f32 v90, v90, v65
    v_mul_f32 v91, v91, v65
    v_mul_f32 v92, v92, v65
    v_mul_f32 v93, v93, v65
    v_mul_f32 v94, v94, v65
    v_mul_f32 v95, v95, v65
    v_cvt_pk_bf16_f32 v24, v16, v17
    v_cvt_pk_bf16_f32 v25, v18, v19
    v_cvt_pk_bf16_f32 v26, v20, v21
    v_cvt_pk_bf16_f32 v27, v22, v23
    v_add_f32 v61, v61, v16
    v_add_f32 v61, v61, v17
    v_add_f32 v61, v61, v18
    v_add_f32 v61, v61, v19
    v_add_f32 v61, v61, v20
    v_add_f32 v61, v61, v21
    v_add_f32 v61, v61, v22
    v_add_f32 v61, v61, v23
    v_mfma_f32_16x16x32_bf16 v[88:91], v[48:51], v[24:27], v[88:91]
    v_mfma_f32_16x16x32_bf16 v[92:95], v[52:55], v[24:27], v[92:95]
    v_mfma_f32_16x16x32_bf16 v[16:19], v[40:43], a[8:11], 0
    v_mfma_f32_16x16x32_bf16 v[20:23], v[44:47], a[8:11], 0
    s_nop 6
    v_max3_f32 v64, v58, v16, v17
    v_max3_f32 v64, v64, v18, v19
    v_max3_f32 v64, v64, v20, v21
    v_max3_f32 v64, v64, v22, v23
    v_mov_b32 v65, v64
    s_nop 1
    v_permlane16_swap_b32 v64, v65
    v_max_f32 v64, v64, v65
    v_mov_b32 v65, v64
    s_nop 1
    v_permlane32_swap_b32 v64, v65
    v_max_f32 v64, v64, v65
    v_sub_f32 v65, v58, v64
    v_exp_f32 v65, v65
    v_mov_b32 v58, v64
    v_sub_f32 v16, v16, v64
    v_sub_f32 v17, v17, v64
    v_sub_f32 v18, v18, v64
    v_sub_f32 v19, v19, v64
    v_sub_f32 v20, v20, v64
    v_sub_f32 v21, v21, v64
    v_sub_f32 v22, v22, v64
    v_sub_f32 v23, v23, v64
    v_exp_f32 v16, v16
    v_exp_f32 v17, v17
    v_exp_f32 v18, v18
    v_exp_f32 v19, v19
    v_exp_f32 v20, v20
    v_exp_f32 v21, v21
    v_exp_f32 v22, v22
    v_exp_f32 v23, v23
    v_mul_f32 v62, v62, v65
    v_mul_f32 v96, v96, v65
    v_mul_f32 v97, v97, v65
    v_mul_f32 v98, v98, v65
    v_mul_f32 v99, v99, v65
    v_mul_f32 v100, v100, v65
    v_mul_f32 v101, v101, v65
    v_mul_f32 v102, v102, v65
    v_mul_f32 v103, v103, v65
    v_cvt_pk_bf16_f32 v24, v16, v17
    v_cvt_pk_bf16_f32 v25, v18, v19
    v_cvt_pk_bf16_f32 v26, v20, v21
    v_cvt_pk_bf16_f32 v27, v22, v23
    v_add_f32 v62, v62, v16
    v_add_f32 v62, v62, v17
    v_add_f32 v62, v62, v18
    v_add_f32 v62, v62, v19
    v_add_f32 v62, v62, v20
    v_add_f32 v62, v62, v21
    v_add_f32 v62, v62, v22
    v_add_f32 v62, v62, v23
    v_mfma_f32_16x16x32_bf16 v[96:99], v[48:51], v[24:27], v[96:99]
    v_mfma_f32_16x16x32_bf16 v[100:103], v[52:55], v[24:27], v[100:103]
    v_mfma_f32_16x16x32_bf16 v[16:19], v[40:43], a[12:15], 0
    v_mfma_f32_16x16x32_bf16 v[20:23], v[44:47], a[12:15], 0
    s_nop 6
    v_max3_f32 v64, v59, v16, v17
    v_max3_f32 v64, v64, v18, v19
    v_max3_f32 v64, v64, v20, v21
    v_max3_f32 v64, v64, v22, v23
    v_mov_b32 v65, v64
    s_nop 1
    v_permlane16_swap_b32 v64, v65
    v_max_f32 v64, v64, v65
    v_mov_b32 v65, v64
    s_nop 1
    v_permlane32_swap_b32 v64, v65
    v_max_f32 v64, v64, v65
    v_sub_f32 v65, v59, v64
    v_exp_f32 v65, v65
    v_mov_b32 v59, v64
    v_sub_f32 v16, v16, v64
    v_sub_f32 v17, v17, v64
    v_sub_f32 v18, v18, v64
    v_sub_f32 v19, v19, v64
    v_sub_f32 v20, v20, v64
    v_sub_f32 v21, v21, v64
    v_sub_f32 v22, v22, v64
    v_sub_f32 v23, v23, v64
    v_exp_f32 v16, v16
    v_exp_f32 v17, v17
    v_exp_f32 v18, v18
    v_exp_f32 v19, v19
    v_exp_f32 v20, v20
    v_exp_f32 v21, v21
    v_exp_f32 v22, v22
    v_exp_f32 v23, v23
    v_mul_f32 v63, v63, v65
    v_mul_f32 v104, v104, v65
    v_mul_f32 v105, v105, v65
    v_mul_f32 v106, v106, v65
    v_mul_f32 v107, v107, v65
    v_mul_f32 v108, v108, v65
    v_mul_f32 v109, v109, v65
    v_mul_f32 v110, v110, v65
    v_mul_f32 v111, v111, v65
    v_cvt_pk_bf16_f32 v24, v16, v17
    v_cvt_pk_bf16_f32 v25, v18, v19
    v_cvt_pk_bf16_f32 v26, v20, v21
    v_cvt_pk_bf16_f32 v27, v22, v23
    v_add_f32 v63, v63, v16
    v_add_f32 v63, v63, v17
    v_add_f32 v63, v63, v18
    v_add_f32 v63, v63, v19
    v_add_f32 v63, v63, v20
    v_add_f32 v63, v63, v21
    v_add_f32 v63, v63, v22
    v_add_f32 v63, v63, v23
    v_mfma_f32_16x16x32_bf16 v[104:107], v[48:51], v[24:27], v[104:107]
    v_mfma_f32_16x16x32_bf16 v[108:111], v[52:55], v[24:27], v[108:111]
    s_add_u32 s26, s26, 2048
    s_cmp_lt_u32 s26, 131072
    s_cbranch_scc1 L_k2_kernel_slowloop
    v_mov_b32 v64, v60
    s_nop 1
    v_permlane16_swap_b32 v60, v64
    v_add_f32 v60, v60, v64
    v_mov_b32 v64, v60
    s_nop 1
    v_permlane32_swap_b32 v60, v64
    v_add_f32 v60, v60, v64
    v_mov_b32 v112, v60
    v_mov_b32 v113, 0
    v_mov_b32 v64, v61
    s_nop 1
    v_permlane16_swap_b32 v61, v64
    v_add_f32 v61, v61, v64
    v_mov_b32 v64, v61
    s_nop 1
    v_permlane32_swap_b32 v61, v64
    v_add_f32 v61, v61, v64
    v_mov_b32 v114, v61
    v_mov_b32 v115, 0
    v_mov_b32 v64, v62
    s_nop 1
    v_permlane16_swap_b32 v62, v64
    v_add_f32 v62, v62, v64
    v_mov_b32 v64, v62
    s_nop 1
    v_permlane32_swap_b32 v62, v64
    v_add_f32 v62, v62, v64
    v_mov_b32 v116, v62
    v_mov_b32 v117, 0
    v_mov_b32 v64, v63
    s_nop 1
    v_permlane16_swap_b32 v63, v64
    v_add_f32 v63, v63, v64
    v_mov_b32 v64, v63
    s_nop 1
    v_permlane32_swap_b32 v63, v64
    v_add_f32 v63, v63, v64
    v_mov_b32 v118, v63
    v_mov_b32 v119, 0
    s_mov_b32 s50, 1
    s_branch L_k2_kernel_norm
.p2align 12, , 768
L_k2_kernel_B:
    s_setprio 2
    s_sub_u32 s66, s3, 4
    s_lshr_b32 s67, s2, 3
    s_lshr_b32 s68, s64, 1
    s_lshl_b32 s68, s68, 2
    s_and_b32 s69, s67, 3
    s_add_u32 s68, s68, s69
    s_and_b32 s69, s64, 1
    s_lshl_b32 s69, s69, 3
    s_lshr_b32 s70, s67, 2
    s_add_u32 s69, s69, s70
    s_lshl_b32 s48, s66, 13
    s_lshl_b32 s49, s66, 16
    s_mov_b32 s56, s49
    s_mul_i32 s51, s66, 12288
    s_add_u32 s51, s51, 65536
    s_lshl_b32 s57, s68, 8
    s_add_u32 s57, s57, 35651584
    v_lshlrev_b32 v12, 4, v0
    s_lshl_b32 s71, s66, 11
    v_add_u32 v1, s71, v12
    s_add_u32 s71, s71, 2048
    s_and_b32 s71, s71, 8191
    v_add_u32 v2, s71, v12
    s_add_u32 s71, s71, 2048
    s_and_b32 s71, s71, 8191
    v_add_u32 v7, s71, v12
    s_add_u32 s71, s71, 2048
    s_and_b32 s71, s71, 8191
    v_add_u32 v13, s71, v12
    v_and_b32 v14, 7, v0
    v_bfe_u32 v15, v0, 4, 1
    v_lshlrev_b32 v15, 2, v15
    v_xor_b32 v14, v14, v15
    v_bfe_u32 v15, v0, 5, 1
    v_lshlrev_b32 v15, 1, v15
    v_xor_b32 v14, v14, v15
    v_lshlrev_b32 v14, 4, v14
    v_lshrrev_b32 v12, 3, v0
    v_lshl_add_u32 v14, v12, 11, v14
    s_lshl_b32 s70, s69, 7
    v_add_u32 v3, s70, v14
    v_add_u32 v4, 15360, v3
    v_add_u32 v5, 30720, v3
    v_add_u32 v6, 46080, v3
    s_mul_i32 s71, s68, 1179648
    s_add_u32 s71, s71, 16777216
    s_waitcnt lgkmcnt(0)
    s_add_u32 s20, s6, s71
    s_addc_u32 s21, s7, 0
    s_mov_b32 s22, 1179648
    s_mov_b32 s23, 0x20000
    s_mov_b32 s24, s60
    s_mov_b32 s25, s61
    s_mov_b32 s26, 7340032
    s_mov_b32 s27, 0x20000
    s_mov_b32 s36, s4
    s_mov_b32 s37, s5
    s_mov_b32 s38, 4194304
    s_mov_b32 s39, 0x20000
    s_mov_b32 s40, s62
    s_mov_b32 s41, s63
    s_mov_b32 s42, 4194304
    s_mov_b32 s43, 0x20000
    s_mov_b32 s44, s6
    s_mov_b32 s45, s7
    s_mov_b32 s46, 39911424
    s_mov_b32 s47, 0x20000
    s_barrier
    s_add_u32 m0, s51, 0
    s_nop 0
    buffer_load_dwordx4 v3, s[24:27], s49 offen offset:0 lds
    buffer_load_dwordx4 v4, s[24:27], s49 offen offset:1024 lds
    buffer_load_dwordx4 v5, s[24:27], s49 offen offset:2048 lds
    buffer_load_dwordx4 v6, s[24:27], s49 offen offset:3072 lds
    s_add_u32 s49, s49, 262144
    buffer_load_dwordx4 v[32:35], v1, s[20:23], s48 offen offset:0
    buffer_load_dwordx4 v[36:39], v1, s[20:23], s48 offen offset:1024
    buffer_load_dwordx4 v[40:43], v2, s[20:23], s48 offen offset:0
    buffer_load_dwordx4 v[44:47], v2, s[20:23], s48 offen offset:1024
    buffer_load_dwordx4 v[48:51], v7, s[20:23], s48 offen offset:0
    buffer_load_dwordx4 v[52:55], v7, s[20:23], s48 offen offset:1024
    buffer_load_dwordx4 v[56:59], v13, s[20:23], s48 offen offset:0
    buffer_load_dwordx4 v[60:63], v13, s[20:23], s48 offen offset:1024
    s_add_u32 s48, s48, 32768
    v_bfe_u32 v12, v0, 2, 3
    v_lshlrev_b32 v14, 7, v12
    v_lshrrev_b32 v15, 5, v0
    v_lshl_add_u32 v14, v15, 10, v14
    v_and_b32 v15, 3, v0
    v_lshl_add_u32 v14, v15, 3, v14
    v_add_u32 v14, s51, v14
    v_bfe_u32 v15, v0, 3, 1
    v_lshlrev_b32 v15, 1, v15
    v_bfe_u32 v12, v0, 4, 1
    v_or_b32 v15, v15, v12
    v_lshl_add_u32 v8, v15, 5, v14
    v_xor_b32 v9, 32, v8
    v_xor_b32 v10, 64, v8
    v_xor_b32 v11, 96, v8
    s_mov_b32 s14, 8
    s_lshl_b32 s71, s68, 18
    s_lshl_b32 s72, s66, 16
    s_add_u32 s71, s71, s72
    s_add_u32 s53, s71, s70
    s_setprio 0
    s_waitcnt vmcnt(8)
    ds_read_b64_tr_b16 v[16:17], v8 offset:0
    ds_read_b64_tr_b16 v[18:19], v8 offset:2048
    ds_read_b64_tr_b16 v[20:21], v9 offset:0
    ds_read_b64_tr_b16 v[22:23], v9 offset:2048
    ds_read_b64_tr_b16 v[24:25], v10 offset:0
    ds_read_b64_tr_b16 v[26:27], v10 offset:2048
    ds_read_b64_tr_b16 v[28:29], v11 offset:0
    ds_read_b64_tr_b16 v[30:31], v11 offset:2048
    s_mov_b32 s28, s54
    s_mov_b32 s29, s55
    s_mov_b32 s30, 2097152
    s_mov_b32 s31, 0x20000
    s_lshl_b32 s58, s66, 13
    s_add_u32 s58, s58, 114688
    s_add_u32 s32, s56, 786432
    s_waitcnt vmcnt(7) lgkmcnt(6)
    v_mfma_f32_16x16x32_bf16 a[0:3], v[16:19], v[32:35], 0
    s_add_u32 m0, s51, 4096
    s_nop 0
    buffer_load_dwordx4 v3, s[24:27], s49 offen offset:0 lds
    buffer_load_dwordx4 v4, s[24:27], s49 offen offset:1024 lds
    buffer_load_dwordx4 v5, s[24:27], s49 offen offset:2048 lds
    buffer_load_dwordx4 v6, s[24:27], s49 offen offset:3072 lds
    s_add_u32 s49, s49, 262144
    s_waitcnt lgkmcnt(4)
    v_mfma_f32_16x16x32_bf16 a[4:7], v[20:23], v[32:35], 0
    buffer_load_dwordx4 v[64:67], v1, s[20:23], s48 offen offset:0
    s_waitcnt lgkmcnt(2)
    v_mfma_f32_16x16x32_bf16 a[8:11], v[24:27], v[32:35], 0
    buffer_load_dwordx4 v[68:71], v1, s[20:23], s48 offen offset:1024
    s_waitcnt lgkmcnt(0)
    v_mfma_f32_16x16x32_bf16 a[12:15], v[28:31], v[32:35], 0
    buffer_load_dwordx4 v[72:75], v2, s[20:23], s48 offen offset:0
    s_waitcnt vmcnt(13)
    v_mfma_f32_16x16x32_bf16 a[28:31], v[28:31], v[36:39], 0
    buffer_load_dwordx4 v[76:79], v2, s[20:23], s48 offen offset:1024
    v_mfma_f32_16x16x32_bf16 a[24:27], v[24:27], v[36:39], 0
    buffer_load_dwordx4 v[80:83], v7, s[20:23], s48 offen offset:0
    v_mfma_f32_16x16x32_bf16 a[20:23], v[20:23], v[36:39], 0
    buffer_load_dwordx4 v[84:87], v7, s[20:23], s48 offen offset:1024
    v_mfma_f32_16x16x32_bf16 a[16:19], v[16:19], v[36:39], 0
    buffer_load_dwordx4 v[88:91], v13, s[20:23], s48 offen offset:0
    s_waitcnt vmcnt(16)
    v_mfma_f32_16x16x32_bf16 a[32:35], v[16:19], v[40:43], 0
    buffer_load_dwordx4 v[92:95], v13, s[20:23], s48 offen offset:1024
    s_add_u32 s48, s48, 32768
    v_mfma_f32_16x16x32_bf16 a[36:39], v[20:23], v[40:43], 0
    s_add_u32 m0, s51, 8192
    s_nop 0
    buffer_load_dwordx4 v3, s[24:27], s49 offen offset:0 lds
    buffer_load_dwordx4 v4, s[24:27], s49 offen offset:1024 lds
    buffer_load_dwordx4 v5, s[24:27], s49 offen offset:2048 lds
    buffer_load_dwordx4 v6, s[24:27], s49 offen offset:3072 lds
    s_add_u32 s49, s49, 262144
    v_mfma_f32_16x16x32_bf16 a[40:43], v[24:27], v[40:43], 0
    buffer_load_dwordx4 v[96:99], v1, s[20:23], s48 offen offset:0
    v_mfma_f32_16x16x32_bf16 a[44:47], v[28:31], v[40:43], 0
    buffer_load_dwordx4 v[100:103], v1, s[20:23], s48 offen offset:1024
    s_waitcnt vmcnt(22)
    v_mfma_f32_16x16x32_bf16 a[60:63], v[28:31], v[44:47], 0
    buffer_load_dwordx4 v[104:107], v2, s[20:23], s48 offen offset:0
    v_mfma_f32_16x16x32_bf16 a[56:59], v[24:27], v[44:47], 0
    buffer_load_dwordx4 v[108:111], v2, s[20:23], s48 offen offset:1024
    v_mfma_f32_16x16x32_bf16 a[52:55], v[20:23], v[44:47], 0
    buffer_load_dwordx4 v[112:115], v7, s[20:23], s48 offen offset:0
    v_mfma_f32_16x16x32_bf16 a[48:51], v[16:19], v[44:47], 0
    buffer_load_dwordx4 v[116:119], v7, s[20:23], s48 offen offset:1024
    s_waitcnt vmcnt(25)
    v_mfma_f32_16x16x32_bf16 a[64:67], v[16:19], v[48:51], 0
    buffer_load_dwordx4 v[120:123], v13, s[20:23], s48 offen offset:0
    v_mfma_f32_16x16x32_bf16 a[68:71], v[20:23], v[48:51], 0
    buffer_load_dwordx4 v[124:127], v13, s[20:23], s48 offen offset:1024
    s_add_u32 s48, s48, 32768
    v_mfma_f32_16x16x32_bf16 a[72:75], v[24:27], v[48:51], 0
    v_mfma_f32_16x16x32_bf16 a[76:79], v[28:31], v[48:51], 0
    s_waitcnt vmcnt(26)
    v_mfma_f32_16x16x32_bf16 a[92:95], v[28:31], v[52:55], 0
    v_mfma_f32_16x16x32_bf16 a[88:91], v[24:27], v[52:55], 0
    v_mfma_f32_16x16x32_bf16 a[84:87], v[20:23], v[52:55], 0
    v_mfma_f32_16x16x32_bf16 a[80:83], v[16:19], v[52:55], 0
    s_waitcnt vmcnt(25)
    v_mfma_f32_16x16x32_bf16 a[96:99], v[16:19], v[56:59], 0
    v_mfma_f32_16x16x32_bf16 a[100:103], v[20:23], v[56:59], 0
    v_mfma_f32_16x16x32_bf16 a[104:107], v[24:27], v[56:59], 0
    v_mfma_f32_16x16x32_bf16 a[108:111], v[28:31], v[56:59], 0
    s_waitcnt vmcnt(24)
    v_mfma_f32_16x16x32_bf16 a[112:115], v[16:19], v[60:63], 0
    v_mfma_f32_16x16x32_bf16 a[116:119], v[20:23], v[60:63], 0
    v_mfma_f32_16x16x32_bf16 a[120:123], v[24:27], v[60:63], 0
    v_mfma_f32_16x16x32_bf16 a[124:127], v[28:31], v[60:63], 0
    s_add_u32 m0, s51, 0
    s_nop 0
    buffer_load_dwordx4 v3, s[24:27], s49 offen offset:0 lds
    buffer_load_dwordx4 v4, s[24:27], s49 offen offset:1024 lds
    buffer_load_dwordx4 v5, s[24:27], s49 offen offset:2048 lds
    buffer_load_dwordx4 v6, s[24:27], s49 offen offset:3072 lds
    s_add_u32 s49, s49, 262144
    buffer_load_dwordx4 v[32:35], v1, s[20:23], s48 offen offset:0
    buffer_load_dwordx4 v[36:39], v1, s[20:23], s48 offen offset:1024
    buffer_load_dwordx4 v[40:43], v2, s[20:23], s48 offen offset:0
    buffer_load_dwordx4 v[44:47], v2, s[20:23], s48 offen offset:1024
    buffer_load_dwordx4 v[48:51], v7, s[20:23], s48 offen offset:0
    buffer_load_dwordx4 v[52:55], v7, s[20:23], s48 offen offset:1024
    buffer_load_dwordx4 v[56:59], v13, s[20:23], s48 offen offset:0
    buffer_load_dwordx4 v[60:63], v13, s[20:23], s48 offen offset:1024
    s_add_u32 s48, s48, 32768
    s_waitcnt vmcnt(32)
    ds_read_b64_tr_b16 v[16:17], v8 offset:4096
    ds_read_b64_tr_b16 v[18:19], v8 offset:6144
    ds_read_b64_tr_b16 v[20:21], v9 offset:4096
    ds_read_b64_tr_b16 v[22:23], v9 offset:6144
    ds_read_b64_tr_b16 v[24:25], v10 offset:4096
    ds_read_b64_tr_b16 v[26:27], v10 offset:6144
    ds_read_b64_tr_b16 v[28:29], v11 offset:4096
    ds_read_b64_tr_b16 v[30:31], v11 offset:6144
    s_branch L_k2_kernel_bs1
L_k2_kernel_bloop:
    s_waitcnt vmcnt(31) lgkmcnt(6)
    v_mfma_f32_16x16x32_bf16 a[0:3], v[16:19], v[32:35], a[0:3]
    s_waitcnt lgkmcnt(4)
    v_mfma_f32_16x16x32_bf16 a[4:7], v[20:23], v[32:35], a[4:7]
    s_waitcnt lgkmcnt(2)
    v_mfma_f32_16x16x32_bf16 a[8:11], v[24:27], v[32:35], a[8:11]
    s_waitcnt lgkmcnt(0)
    v_mfma_f32_16x16x32_bf16 a[12:15], v[28:31], v[32:35], a[12:15]
    buffer_load_dwordx4 v[32:35], v1, s[20:23], s48 offen offset:0
    s_waitcnt vmcnt(31)
    v_mfma_f32_16x16x32_bf16 a[28:31], v[28:31], v[36:39], a[28:31]
    s_add_u32 m0, s51, 0
    s_nop 0
    buffer_load_dwordx4 v3, s[24:27], s49 offen offset:0 lds
    buffer_load_dwordx4 v4, s[24:27], s49 offen offset:1024 lds
    buffer_load_dwordx4 v5, s[24:27], s49 offen offset:2048 lds
    buffer_load_dwordx4 v6, s[24:27], s49 offen offset:3072 lds
    s_add_u32 s49, s49, 262144
    v_mfma_f32_16x16x32_bf16 a[24:27], v[24:27], v[36:39], a[24:27]
    v_mfma_f32_16x16x32_bf16 a[20:23], v[20:23], v[36:39], a[20:23]
    v_mfma_f32_16x16x32_bf16 a[16:19], v[16:19], v[36:39], a[16:19]
    buffer_load_dwordx4 v[36:39], v1, s[20:23], s48 offen offset:1024
    s_waitcnt vmcnt(35)
    v_mfma_f32_16x16x32_bf16 a[32:35], v[16:19], v[40:43], a[32:35]
    v_mfma_f32_16x16x32_bf16 a[36:39], v[20:23], v[40:43], a[36:39]
    v_mfma_f32_16x16x32_bf16 a[40:43], v[24:27], v[40:43], a[40:43]
    v_mfma_f32_16x16x32_bf16 a[44:47], v[28:31], v[40:43], a[44:47]
    buffer_load_dwordx4 v[40:43], v2, s[20:23], s48 offen offset:0
    s_waitcnt vmcnt(35)
    v_mfma_f32_16x16x32_bf16 a[60:63], v[28:31], v[44:47], a[60:63]
    v_mfma_f32_16x16x32_bf16 a[56:59], v[24:27], v[44:47], a[56:59]
    v_mfma_f32_16x16x32_bf16 a[52:55], v[20:23], v[44:47], a[52:55]
    v_mfma_f32_16x16x32_bf16 a[48:51], v[16:19], v[44:47], a[48:51]
    buffer_load_dwordx4 v[44:47], v2, s[20:23], s48 offen offset:1024
    s_waitcnt vmcnt(35)
    v_mfma_f32_16x16x32_bf16 a[64:67], v[16:19], v[48:51], a[64:67]
    v_mfma_f32_16x16x32_bf16 a[68:71], v[20:23], v[48:51], a[68:71]
    v_mfma_f32_16x16x32_bf16 a[72:75], v[24:27], v[48:51], a[72:75]
    v_mfma_f32_16x16x32_bf16 a[76:79], v[28:31], v[48:51], a[76:79]
    buffer_load_dwordx4 v[48:51], v7, s[20:23], s48 offen offset:0
    s_waitcnt vmcnt(35)
    v_mfma_f32_16x16x32_bf16 a[92:95], v[28:31], v[52:55], a[92:95]
    v_mfma_f32_16x16x32_bf16 a[88:91], v[24:27], v[52:55], a[88:91]
    v_mfma_f32_16x16x32_bf16 a[84:87], v[20:23], v[52:55], a[84:87]
    v_mfma_f32_16x16x32_bf16 a[80:83], v[16:19], v[52:55], a[80:83]
    buffer_load_dwordx4 v[52:55], v7, s[20:23], s48 offen offset:1024
    s_waitcnt vmcnt(35)
    v_mfma_f32_16x16x32_bf16 a[96:99], v[16:19], v[56:59], a[96:99]
    v_mfma_f32_16x16x32_bf16 a[100:103], v[20:23], v[56:59], a[100:103]
    v_mfma_f32_16x16x32_bf16 a[104:107], v[24:27], v[56:59], a[104:107]
    v_mfma_f32_16x16x32_bf16 a[108:111], v[28:31], v[56:59], a[108:111]
    buffer_load_dwordx4 v[56:59], v13, s[20:23], s48 offen offset:0
    s_waitcnt vmcnt(30)
    v_mfma_f32_16x16x32_bf16 a[112:115], v[16:19], v[60:63], a[112:115]
    ds_read_b64_tr_b16 v[16:17], v8 offset:4096
    ds_read_b64_tr_b16 v[18:19], v8 offset:6144
    v_mfma_f32_16x16x32_bf16 a[116:119], v[20:23], v[60:63], a[116:119]
    ds_read_b64_tr_b16 v[20:21], v9 offset:4096
    ds_read_b64_tr_b16 v[22:23], v9 offset:6144
    v_mfma_f32_16x16x32_bf16 a[120:123], v[24:27], v[60:63], a[120:123]
    ds_read_b64_tr_b16 v[24:25], v10 offset:4096
    ds_read_b64_tr_b16 v[26:27], v10 offset:6144
    v_mfma_f32_16x16x32_bf16 a[124:127], v[28:31], v[60:63], a[124:127]
    buffer_load_dwordx4 v[60:63], v13, s[20:23], s48 offen offset:1024
    s_add_u32 s48, s48, 32768
    ds_read_b64_tr_b16 v[28:29], v11 offset:4096
    ds_read_b64_tr_b16 v[30:31], v11 offset:6144
L_k2_kernel_bs1:
    s_waitcnt vmcnt(31) lgkmcnt(6)
    v_mfma_f32_16x16x32_bf16 a[0:3], v[16:19], v[64:67], a[0:3]
    s_waitcnt lgkmcnt(4)
    v_mfma_f32_16x16x32_bf16 a[4:7], v[20:23], v[64:67], a[4:7]
    s_waitcnt lgkmcnt(2)
    v_mfma_f32_16x16x32_bf16 a[8:11], v[24:27], v[64:67], a[8:11]
    s_waitcnt lgkmcnt(0)
    v_mfma_f32_16x16x32_bf16 a[12:15], v[28:31], v[64:67], a[12:15]
    buffer_load_dwordx4 v[64:67], v1, s[20:23], s48 offen offset:0
    s_waitcnt vmcnt(31)
    v_mfma_f32_16x16x32_bf16 a[28:31], v[28:31], v[68:71], a[28:31]
    s_add_u32 m0, s51, 4096
    s_nop 0
    buffer_load_dwordx4 v3, s[24:27], s49 offen offset:0 lds
    buffer_load_dwordx4 v4, s[24:27], s49 offen offset:1024 lds
    buffer_load_dwordx4 v5, s[24:27], s49 offen offset:2048 lds
    buffer_load_dwordx4 v6, s[24:27], s49 offen offset:3072 lds
    s_add_u32 s49, s49, 262144
    v_mfma_f32_16x16x32_bf16 a[24:27], v[24:27], v[68:71], a[24:27]
    v_mfma_f32_16x16x32_bf16 a[20:23], v[20:23], v[68:71], a[20:23]
    v_mfma_f32_16x16x32_bf16 a[16:19], v[16:19], v[68:71], a[16:19]
    buffer_load_dwordx4 v[68:71], v1, s[20:23], s48 offen offset:1024
    s_waitcnt vmcnt(35)
    v_mfma_f32_16x16x32_bf16 a[32:35], v[16:19], v[72:75], a[32:35]
    v_mfma_f32_16x16x32_bf16 a[36:39], v[20:23], v[72:75], a[36:39]
    v_mfma_f32_16x16x32_bf16 a[40:43], v[24:27], v[72:75], a[40:43]
    v_mfma_f32_16x16x32_bf16 a[44:47], v[28:31], v[72:75], a[44:47]
    buffer_load_dwordx4 v[72:75], v2, s[20:23], s48 offen offset:0
    s_waitcnt vmcnt(35)
    v_mfma_f32_16x16x32_bf16 a[60:63], v[28:31], v[76:79], a[60:63]
    v_mfma_f32_16x16x32_bf16 a[56:59], v[24:27], v[76:79], a[56:59]
    v_mfma_f32_16x16x32_bf16 a[52:55], v[20:23], v[76:79], a[52:55]
    v_mfma_f32_16x16x32_bf16 a[48:51], v[16:19], v[76:79], a[48:51]
    buffer_load_dwordx4 v[76:79], v2, s[20:23], s48 offen offset:1024
    s_waitcnt vmcnt(35)
    v_mfma_f32_16x16x32_bf16 a[64:67], v[16:19], v[80:83], a[64:67]
    v_mfma_f32_16x16x32_bf16 a[68:71], v[20:23], v[80:83], a[68:71]
    v_mfma_f32_16x16x32_bf16 a[72:75], v[24:27], v[80:83], a[72:75]
    v_mfma_f32_16x16x32_bf16 a[76:79], v[28:31], v[80:83], a[76:79]
    buffer_load_dwordx4 v[80:83], v7, s[20:23], s48 offen offset:0
    s_waitcnt vmcnt(35)
    v_mfma_f32_16x16x32_bf16 a[92:95], v[28:31], v[84:87], a[92:95]
    v_mfma_f32_16x16x32_bf16 a[88:91], v[24:27], v[84:87], a[88:91]
    v_mfma_f32_16x16x32_bf16 a[84:87], v[20:23], v[84:87], a[84:87]
    v_mfma_f32_16x16x32_bf16 a[80:83], v[16:19], v[84:87], a[80:83]
    buffer_load_dwordx4 v[84:87], v7, s[20:23], s48 offen offset:1024
    s_waitcnt vmcnt(35)
    v_mfma_f32_16x16x32_bf16 a[96:99], v[16:19], v[88:91], a[96:99]
    v_mfma_f32_16x16x32_bf16 a[100:103], v[20:23], v[88:91], a[100:103]
    v_mfma_f32_16x16x32_bf16 a[104:107], v[24:27], v[88:91], a[104:107]
    v_mfma_f32_16x16x32_bf16 a[108:111], v[28:31], v[88:91], a[108:111]
    buffer_load_dwordx4 v[88:91], v13, s[20:23], s48 offen offset:0
    s_waitcnt vmcnt(30)
    v_mfma_f32_16x16x32_bf16 a[112:115], v[16:19], v[92:95], a[112:115]
    ds_read_b64_tr_b16 v[16:17], v8 offset:8192
    ds_read_b64_tr_b16 v[18:19], v8 offset:10240
    v_mfma_f32_16x16x32_bf16 a[116:119], v[20:23], v[92:95], a[116:119]
    ds_read_b64_tr_b16 v[20:21], v9 offset:8192
    ds_read_b64_tr_b16 v[22:23], v9 offset:10240
    v_mfma_f32_16x16x32_bf16 a[120:123], v[24:27], v[92:95], a[120:123]
    ds_read_b64_tr_b16 v[24:25], v10 offset:8192
    ds_read_b64_tr_b16 v[26:27], v10 offset:10240
    v_mfma_f32_16x16x32_bf16 a[124:127], v[28:31], v[92:95], a[124:127]
    buffer_load_dwordx4 v[92:95], v13, s[20:23], s48 offen offset:1024
    s_add_u32 s48, s48, 32768
    ds_read_b64_tr_b16 v[28:29], v11 offset:8192
    ds_read_b64_tr_b16 v[30:31], v11 offset:10240
    s_waitcnt vmcnt(31) lgkmcnt(6)
    v_mfma_f32_16x16x32_bf16 a[0:3], v[16:19], v[96:99], a[0:3]
    s_waitcnt lgkmcnt(4)
    v_mfma_f32_16x16x32_bf16 a[4:7], v[20:23], v[96:99], a[4:7]
    s_waitcnt lgkmcnt(2)
    v_mfma_f32_16x16x32_bf16 a[8:11], v[24:27], v[96:99], a[8:11]
    s_waitcnt lgkmcnt(0)
    v_mfma_f32_16x16x32_bf16 a[12:15], v[28:31], v[96:99], a[12:15]
    buffer_load_dwordx4 v[96:99], v1, s[20:23], s48 offen offset:0
    s_waitcnt vmcnt(31)
    v_mfma_f32_16x16x32_bf16 a[28:31], v[28:31], v[100:103], a[28:31]
    s_add_u32 m0, s51, 8192
    s_nop 0
    buffer_load_dwordx4 v3, s[24:27], s49 offen offset:0 lds
    buffer_load_dwordx4 v4, s[24:27], s49 offen offset:1024 lds
    buffer_load_dwordx4 v5, s[24:27], s49 offen offset:2048 lds
    buffer_load_dwordx4 v6, s[24:27], s49 offen offset:3072 lds
    s_add_u32 s49, s49, 262144
    v_mfma_f32_16x16x32_bf16 a[24:27], v[24:27], v[100:103], a[24:27]
    v_mfma_f32_16x16x32_bf16 a[20:23], v[20:23], v[100:103], a[20:23]
    v_mfma_f32_16x16x32_bf16 a[16:19], v[16:19], v[100:103], a[16:19]
    buffer_load_dwordx4 v[100:103], v1, s[20:23], s48 offen offset:1024
    s_waitcnt vmcnt(35)
    v_mfma_f32_16x16x32_bf16 a[32:35], v[16:19], v[104:107], a[32:35]
    v_mfma_f32_16x16x32_bf16 a[36:39], v[20:23], v[104:107], a[36:39]
    v_mfma_f32_16x16x32_bf16 a[40:43], v[24:27], v[104:107], a[40:43]
    v_mfma_f32_16x16x32_bf16 a[44:47], v[28:31], v[104:107], a[44:47]
    buffer_load_dwordx4 v[104:107], v2, s[20:23], s48 offen offset:0
    s_waitcnt vmcnt(35)
    v_mfma_f32_16x16x32_bf16 a[60:63], v[28:31], v[108:111], a[60:63]
    s_cmp_lg_u32 s14, 3
    s_cbranch_scc1 L_k2_kernel_noxe
    s_add_u32 m0, s58, 0
    s_nop 0
    buffer_load_dwordx4 v3, s[28:31], s32 offen offset:0 lds
    buffer_load_dwordx4 v4, s[28:31], s32 offen offset:1024 lds
    buffer_load_dwordx4 v5, s[28:31], s32 offen offset:2048 lds
    buffer_load_dwordx4 v6, s[28:31], s32 offen offset:3072 lds
    s_add_u32 s32, s32, 262144
    s_add_u32 m0, s58, 4096
    s_nop 0
    buffer_load_dwordx4 v3, s[28:31], s32 offen offset:0 lds
    buffer_load_dwordx4 v4, s[28:31], s32 offen offset:1024 lds
    buffer_load_dwordx4 v5, s[28:31], s32 offen offset:2048 lds
    buffer_load_dwordx4 v6, s[28:31], s32 offen offset:3072 lds
    s_add_u32 s32, s32, 262144
L_k2_kernel_noxe:
    v_mfma_f32_16x16x32_bf16 a[56:59], v[24:27], v[108:111], a[56:59]
    v_mfma_f32_16x16x32_bf16 a[52:55], v[20:23], v[108:111], a[52:55]
    v_mfma_f32_16x16x32_bf16 a[48:51], v[16:19], v[108:111], a[48:51]
    buffer_load_dwordx4 v[108:111], v2, s[20:23], s48 offen offset:1024
    s_waitcnt vmcnt(35)
    v_mfma_f32_16x16x32_bf16 a[64:67], v[16:19], v[112:115], a[64:67]
    v_mfma_f32_16x16x32_bf16 a[68:71], v[20:23], v[112:115], a[68:71]
    v_mfma_f32_16x16x32_bf16 a[72:75], v[24:27], v[112:115], a[72:75]
    v_mfma_f32_16x16x32_bf16 a[76:79], v[28:31], v[112:115], a[76:79]
    buffer_load_dwordx4 v[112:115], v7, s[20:23], s48 offen offset:0
    s_waitcnt vmcnt(35)
    v_mfma_f32_16x16x32_bf16 a[92:95], v[28:31], v[116:119], a[92:95]
    v_mfma_f32_16x16x32_bf16 a[88:91], v[24:27], v[116:119], a[88:91]
    v_mfma_f32_16x16x32_bf16 a[84:87], v[20:23], v[116:119], a[84:87]
    v_mfma_f32_16x16x32_bf16 a[80:83], v[16:19], v[116:119], a[80:83]
    buffer_load_dwordx4 v[116:119], v7, s[20:23], s48 offen offset:1024
    s_waitcnt vmcnt(35)
    v_mfma_f32_16x16x32_bf16 a[96:99], v[16:19], v[120:123], a[96:99]
    v_mfma_f32_16x16x32_bf16 a[100:103], v[20:23], v[120:123], a[100:103]
    v_mfma_f32_16x16x32_bf16 a[104:107], v[24:27], v[120:123], a[104:107]
    v_mfma_f32_16x16x32_bf16 a[108:111], v[28:31], v[120:123], a[108:111]
    buffer_load_dwordx4 v[120:123], v13, s[20:23], s48 offen offset:0
    s_waitcnt vmcnt(30)
    v_mfma_f32_16x16x32_bf16 a[112:115], v[16:19], v[124:127], a[112:115]
    ds_read_b64_tr_b16 v[16:17], v8 offset:0
    ds_read_b64_tr_b16 v[18:19], v8 offset:2048
    v_mfma_f32_16x16x32_bf16 a[116:119], v[20:23], v[124:127], a[116:119]
    ds_read_b64_tr_b16 v[20:21], v9 offset:0
    ds_read_b64_tr_b16 v[22:23], v9 offset:2048
    v_mfma_f32_16x16x32_bf16 a[120:123], v[24:27], v[124:127], a[120:123]
    ds_read_b64_tr_b16 v[24:25], v10 offset:0
    ds_read_b64_tr_b16 v[26:27], v10 offset:2048
    v_mfma_f32_16x16x32_bf16 a[124:127], v[28:31], v[124:127], a[124:127]
    buffer_load_dwordx4 v[124:127], v13, s[20:23], s48 offen offset:1024
    s_add_u32 s48, s48, 32768
    ds_read_b64_tr_b16 v[28:29], v11 offset:0
    ds_read_b64_tr_b16 v[30:31], v11 offset:2048
    s_sub_u32 s14, s14, 1
    s_cmp_lg_u32 s14, 0
    s_cbranch_scc1 L_k2_kernel_bloop
    s_waitcnt lgkmcnt(6)
    v_mfma_f32_16x16x32_bf16 a[0:3], v[16:19], v[32:35], a[0:3]
    s_waitcnt lgkmcnt(4)
    v_mfma_f32_16x16x32_bf16 a[4:7], v[20:23], v[32:35], a[4:7]
    s_waitcnt lgkmcnt(2)
    v_mfma_f32_16x16x32_bf16 a[8:11], v[24:27], v[32:35], a[8:11]
    s_waitcnt lgkmcnt(0)
    v_mfma_f32_16x16x32_bf16 a[12:15], v[28:31], v[32:35], a[12:15]
    buffer_load_dwordx4 v[32:35], v1, s[20:23], s48 offen offset:0
    s_waitcnt vmcnt(31)
    v_mfma_f32_16x16x32_bf16 a[28:31], v[28:31], v[36:39], a[28:31]
    s_add_u32 m0, s51, 0
    s_nop 0
    buffer_load_dwordx4 v3, s[24:27], s49 offen offset:0 lds
    buffer_load_dwordx4 v4, s[24:27], s49 offen offset:1024 lds
    buffer_load_dwordx4 v5, s[24:27], s49 offen offset:2048 lds
    buffer_load_dwordx4 v6, s[24:27], s49 offen offset:3072 lds
    s_add_u32 s49, s49, 262144
    v_mfma_f32_16x16x32_bf16 a[24:27], v[24:27], v[36:39], a[24:27]
    v_mfma_f32_16x16x32_bf16 a[20:23], v[20:23], v[36:39], a[20:23]
    v_mfma_f32_16x16x32_bf16 a[16:19], v[16:19], v[36:39], a[16:19]
    buffer_load_dwordx4 v[36:39], v1, s[20:23], s48 offen offset:1024
    s_waitcnt vmcnt(35)
    v_mfma_f32_16x16x32_bf16 a[32:35], v[16:19], v[40:43], a[32:35]
    v_mfma_f32_16x16x32_bf16 a[36:39], v[20:23], v[40:43], a[36:39]
    v_mfma_f32_16x16x32_bf16 a[40:43], v[24:27], v[40:43], a[40:43]
    v_mfma_f32_16x16x32_bf16 a[44:47], v[28:31], v[40:43], a[44:47]
    buffer_load_dwordx4 v[40:43], v2, s[20:23], s48 offen offset:0
    s_waitcnt vmcnt(35)
    v_mfma_f32_16x16x32_bf16 a[60:63], v[28:31], v[44:47], a[60:63]
    v_mfma_f32_16x16x32_bf16 a[56:59], v[24:27], v[44:47], a[56:59]
    v_mfma_f32_16x16x32_bf16 a[52:55], v[20:23], v[44:47], a[52:55]
    v_mfma_f32_16x16x32_bf16 a[48:51], v[16:19], v[44:47], a[48:51]
    buffer_load_dwordx4 v[44:47], v2, s[20:23], s48 offen offset:1024
    s_waitcnt vmcnt(35)
    v_mfma_f32_16x16x32_bf16 a[64:67], v[16:19], v[48:51], a[64:67]
    v_mfma_f32_16x16x32_bf16 a[68:71], v[20:23], v[48:51], a[68:71]
    v_mfma_f32_16x16x32_bf16 a[72:75], v[24:27], v[48:51], a[72:75]
    v_mfma_f32_16x16x32_bf16 a[76:79], v[28:31], v[48:51], a[76:79]
    buffer_load_dwordx4 v[48:51], v7, s[20:23], s48 offen offset:0
    s_waitcnt vmcnt(35)
    v_mfma_f32_16x16x32_bf16 a[92:95], v[28:31], v[52:55], a[92:95]
    v_mfma_f32_16x16x32_bf16 a[88:91], v[24:27], v[52:55], a[88:91]
    v_mfma_f32_16x16x32_bf16 a[84:87], v[20:23], v[52:55], a[84:87]
    v_mfma_f32_16x16x32_bf16 a[80:83], v[16:19], v[52:55], a[80:83]
    buffer_load_dwordx4 v[52:55], v7, s[20:23], s48 offen offset:1024
    s_waitcnt vmcnt(35)
    v_mfma_f32_16x16x32_bf16 a[96:99], v[16:19], v[56:59], a[96:99]
    v_mfma_f32_16x16x32_bf16 a[100:103], v[20:23], v[56:59], a[100:103]
    v_mfma_f32_16x16x32_bf16 a[104:107], v[24:27], v[56:59], a[104:107]
    v_mfma_f32_16x16x32_bf16 a[108:111], v[28:31], v[56:59], a[108:111]
    buffer_load_dwordx4 v[56:59], v13, s[20:23], s48 offen offset:0
    s_waitcnt vmcnt(30)
    v_mfma_f32_16x16x32_bf16 a[112:115], v[16:19], v[60:63], a[112:115]
    ds_read_b64_tr_b16 v[16:17], v8 offset:4096
    ds_read_b64_tr_b16 v[18:19], v8 offset:6144
    v_mfma_f32_16x16x32_bf16 a[116:119], v[20:23], v[60:63], a[116:119]
    ds_read_b64_tr_b16 v[20:21], v9 offset:4096
    ds_read_b64_tr_b16 v[22:23], v9 offset:6144
    v_mfma_f32_16x16x32_bf16 a[120:123], v[24:27], v[60:63], a[120:123]
    ds_read_b64_tr_b16 v[24:25], v10 offset:4096
    ds_read_b64_tr_b16 v[26:27], v10 offset:6144
    v_mfma_f32_16x16x32_bf16 a[124:127], v[28:31], v[60:63], a[124:127]
    buffer_load_dwordx4 v[60:63], v13, s[20:23], s48 offen offset:1024
    s_add_u32 s48, s48, 32768
    ds_read_b64_tr_b16 v[28:29], v11 offset:4096
    ds_read_b64_tr_b16 v[30:31], v11 offset:6144
    s_mov_b32 s24, s54
    s_mov_b32 s25, s55
    s_mov_b32 s26, 2097152
    s_mov_b32 s49, s56
    s_lshl_b32 s58, s66, 13
    s_add_u32 s58, s58, 114688
    s_sub_u32 s59, s58, s51
    s_add_u32 s73, s53, 32768
    v_and_b32 v12, 15, v0
    v_lshlrev_b32 v14, 11, v12
    v_bfe_u32 v12, v0, 4, 1
    v_lshl_add_u32 v14, v12, 5, v14
    v_lshrrev_b32 v12, 5, v0
    v_lshl_add_u32 v14, v12, 4, v14
    s_waitcnt lgkmcnt(6)
    v_mfma_f32_16x16x32_bf16 a[0:3], v[16:19], v[64:67], a[0:3]
    s_waitcnt lgkmcnt(4)
    v_mfma_f32_16x16x32_bf16 a[4:7], v[20:23], v[64:67], a[4:7]
    s_waitcnt lgkmcnt(2)
    v_mfma_f32_16x16x32_bf16 a[8:11], v[24:27], v[64:67], a[8:11]
    s_waitcnt lgkmcnt(0)
    v_mfma_f32_16x16x32_bf16 a[12:15], v[28:31], v[64:67], a[12:15]
    s_waitcnt vmcnt(30)
    v_mfma_f32_16x16x32_bf16 a[28:31], v[28:31], v[68:71], a[28:31]
    s_add_u32 m0, s51, 4096
    s_nop 0
    buffer_load_dwordx4 v3, s[24:27], s49 offen offset:0 lds
    buffer_load_dwordx4 v4, s[24:27], s49 offen offset:1024 lds
    buffer_load_dwordx4 v5, s[24:27], s49 offen offset:2048 lds
    buffer_load_dwordx4 v6, s[24:27], s49 offen offset:3072 lds
    s_add_u32 s49, s49, 262144
    v_mfma_f32_16x16x32_bf16 a[24:27], v[24:27], v[68:71], a[24:27]
    v_mfma_f32_16x16x32_bf16 a[20:23], v[20:23], v[68:71], a[20:23]
    v_mfma_f32_16x16x32_bf16 a[16:19], v[16:19], v[68:71], a[16:19]
    s_waitcnt vmcnt(33)
    v_mfma_f32_16x16x32_bf16 a[32:35], v[16:19], v[72:75], a[32:35]
    v_mfma_f32_16x16x32_bf16 a[36:39], v[20:23], v[72:75], a[36:39]
    v_mfma_f32_16x16x32_bf16 a[40:43], v[24:27], v[72:75], a[40:43]
    v_mfma_f32_16x16x32_bf16 a[44:47], v[28:31], v[72:75], a[44:47]
    s_waitcnt vmcnt(32)
    v_mfma_f32_16x16x32_bf16 a[60:63], v[28:31], v[76:79], a[60:63]
    v_mfma_f32_16x16x32_bf16 a[56:59], v[24:27], v[76:79], a[56:59]
    v_mfma_f32_16x16x32_bf16 a[52:55], v[20:23], v[76:79], a[52:55]
    v_mfma_f32_16x16x32_bf16 a[48:51], v[16:19], v[76:79], a[48:51]
    s_waitcnt vmcnt(31)
    v_mfma_f32_16x16x32_bf16 a[64:67], v[16:19], v[80:83], a[64:67]
    v_mfma_f32_16x16x32_bf16 a[68:71], v[20:23], v[80:83], a[68:71]
    v_mfma_f32_16x16x32_bf16 a[72:75], v[24:27], v[80:83], a[72:75]
    v_mfma_f32_16x16x32_bf16 a[76:79], v[28:31], v[80:83], a[76:79]
    s_waitcnt vmcnt(30)
    v_mfma_f32_16x16x32_bf16 a[92:95], v[28:31], v[84:87], a[92:95]
    v_mfma_f32_16x16x32_bf16 a[88:91], v[24:27], v[84:87], a[88:91]
    v_mfma_f32_16x16x32_bf16 a[84:87], v[20:23], v[84:87], a[84:87]
    v_mfma_f32_16x16x32_bf16 a[80:83], v[16:19], v[84:87], a[80:83]
    s_waitcnt vmcnt(29)
    v_mfma_f32_16x16x32_bf16 a[96:99], v[16:19], v[88:91], a[96:99]
    v_mfma_f32_16x16x32_bf16 a[100:103], v[20:23], v[88:91], a[100:103]
    v_mfma_f32_16x16x32_bf16 a[104:107], v[24:27], v[88:91], a[104:107]
    v_mfma_f32_16x16x32_bf16 a[108:111], v[28:31], v[88:91], a[108:111]
    s_waitcnt vmcnt(23)
    v_mfma_f32_16x16x32_bf16 a[112:115], v[16:19], v[92:95], a[112:115]
    ds_read_b64_tr_b16 v[16:17], v8 offset:8192
    ds_read_b64_tr_b16 v[18:19], v8 offset:10240
    v_mfma_f32_16x16x32_bf16 a[116:119], v[20:23], v[92:95], a[116:119]
    ds_read_b64_tr_b16 v[20:21], v9 offset:8192
    ds_read_b64_tr_b16 v[22:23], v9 offset:10240
    v_mfma_f32_16x16x32_bf16 a[120:123], v[24:27], v[92:95], a[120:123]
    ds_read_b64_tr_b16 v[24:25], v10 offset:8192
    ds_read_b64_tr_b16 v[26:27], v10 offset:10240
    v_mfma_f32_16x16x32_bf16 a[124:127], v[28:31], v[92:95], a[124:127]
    ds_read_b64_tr_b16 v[28:29], v11 offset:8192
    ds_read_b64_tr_b16 v[30:31], v11 offset:10240
    s_waitcnt lgkmcnt(6)
    v_mfma_f32_16x16x32_bf16 a[0:3], v[16:19], v[96:99], a[0:3]
    s_waitcnt lgkmcnt(4)
    v_mfma_f32_16x16x32_bf16 a[4:7], v[20:23], v[96:99], a[4:7]
    s_waitcnt lgkmcnt(2)
    v_mfma_f32_16x16x32_bf16 a[8:11], v[24:27], v[96:99], a[8:11]
    s_waitcnt lgkmcnt(0)
    v_mfma_f32_16x16x32_bf16 a[12:15], v[28:31], v[96:99], a[12:15]
    s_waitcnt vmcnt(22)
    v_mfma_f32_16x16x32_bf16 a[28:31], v[28:31], v[100:103], a[28:31]
    s_add_u32 m0, s51, 8192
    s_nop 0
    buffer_load_dwordx4 v3, s[24:27], s49 offen offset:0 lds
    buffer_load_dwordx4 v4, s[24:27], s49 offen offset:1024 lds
    buffer_load_dwordx4 v5, s[24:27], s49 offen offset:2048 lds
    buffer_load_dwordx4 v6, s[24:27], s49 offen offset:3072 lds
    s_add_u32 s49, s49, 262144
    v_mfma_f32_16x16x32_bf16 a[24:27], v[24:27], v[100:103], a[24:27]
    v_mfma_f32_16x16x32_bf16 a[20:23], v[20:23], v[100:103], a[20:23]
    v_mfma_f32_16x16x32_bf16 a[16:19], v[16:19], v[100:103], a[16:19]
    s_waitcnt vmcnt(25)
    v_mfma_f32_16x16x32_bf16 a[32:35], v[16:19], v[104:107], a[32:35]
    v_mfma_f32_16x16x32_bf16 a[36:39], v[20:23], v[104:107], a[36:39]
    v_mfma_f32_16x16x32_bf16 a[40:43], v[24:27], v[104:107], a[40:43]
    v_mfma_f32_16x16x32_bf16 a[44:47], v[28:31], v[104:107], a[44:47]
    s_waitcnt vmcnt(24)
    v_mfma_f32_16x16x32_bf16 a[60:63], v[28:31], v[108:111], a[60:63]
    v_mfma_f32_16x16x32_bf16 a[56:59], v[24:27], v[108:111], a[56:59]
    v_mfma_f32_16x16x32_bf16 a[52:55], v[20:23], v[108:111], a[52:55]
    v_mfma_f32_16x16x32_bf16 a[48:51], v[16:19], v[108:111], a[48:51]
    s_waitcnt vmcnt(23)
    v_mfma_f32_16x16x32_bf16 a[64:67], v[16:19], v[112:115], a[64:67]
    v_mfma_f32_16x16x32_bf16 a[68:71], v[20:23], v[112:115], a[68:71]
    v_mfma_f32_16x16x32_bf16 a[72:75], v[24:27], v[112:115], a[72:75]
    v_mfma_f32_16x16x32_bf16 a[76:79], v[28:31], v[112:115], a[76:79]
    s_waitcnt vmcnt(22)
    v_mfma_f32_16x16x32_bf16 a[92:95], v[28:31], v[116:119], a[92:95]
    v_mfma_f32_16x16x32_bf16 a[88:91], v[24:27], v[116:119], a[88:91]
    v_mfma_f32_16x16x32_bf16 a[84:87], v[20:23], v[116:119], a[84:87]
    v_mfma_f32_16x16x32_bf16 a[80:83], v[16:19], v[116:119], a[80:83]
    s_waitcnt vmcnt(21)
    v_mfma_f32_16x16x32_bf16 a[96:99], v[16:19], v[120:123], a[96:99]
    v_mfma_f32_16x16x32_bf16 a[100:103], v[20:23], v[120:123], a[100:103]
    v_mfma_f32_16x16x32_bf16 a[104:107], v[24:27], v[120:123], a[104:107]
    v_mfma_f32_16x16x32_bf16 a[108:111], v[28:31], v[120:123], a[108:111]
    s_waitcnt vmcnt(15)
    v_mfma_f32_16x16x32_bf16 a[112:115], v[16:19], v[124:127], a[112:115]
    ds_read_b64_tr_b16 v[16:17], v8 offset:0
    ds_read_b64_tr_b16 v[18:19], v8 offset:2048
    v_mfma_f32_16x16x32_bf16 a[116:119], v[20:23], v[124:127], a[116:119]
    ds_read_b64_tr_b16 v[20:21], v9 offset:0
    ds_read_b64_tr_b16 v[22:23], v9 offset:2048
    v_mfma_f32_16x16x32_bf16 a[120:123], v[24:27], v[124:127], a[120:123]
    ds_read_b64_tr_b16 v[24:25], v10 offset:0
    ds_read_b64_tr_b16 v[26:27], v10 offset:2048
    v_mfma_f32_16x16x32_bf16 a[124:127], v[28:31], v[124:127], a[124:127]
    ds_read_b64_tr_b16 v[28:29], v11 offset:0
    ds_read_b64_tr_b16 v[30:31], v11 offset:2048
    s_waitcnt lgkmcnt(6)
    v_mfma_f32_16x16x32_bf16 a[0:3], v[16:19], v[32:35], a[0:3]
    s_waitcnt lgkmcnt(4)
    v_mfma_f32_16x16x32_bf16 a[4:7], v[20:23], v[32:35], a[4:7]
    s_waitcnt lgkmcnt(2)
    v_mfma_f32_16x16x32_bf16 a[8:11], v[24:27], v[32:35], a[8:11]
    s_waitcnt lgkmcnt(0)
    v_mfma_f32_16x16x32_bf16 a[12:15], v[28:31], v[32:35], a[12:15]
    s_waitcnt vmcnt(14)
    v_mfma_f32_16x16x32_bf16 a[28:31], v[28:31], v[36:39], a[28:31]
    s_add_u32 m0, s51, 0
    s_nop 0
    buffer_load_dwordx4 v3, s[24:27], s49 offen offset:0 lds
    buffer_load_dwordx4 v4, s[24:27], s49 offen offset:1024 lds
    buffer_load_dwordx4 v5, s[24:27], s49 offen offset:2048 lds
    buffer_load_dwordx4 v6, s[24:27], s49 offen offset:3072 lds
    s_add_u32 s49, s49, 262144
    v_mfma_f32_16x16x32_bf16 a[24:27], v[24:27], v[36:39], a[24:27]
    v_mfma_f32_16x16x32_bf16 a[20:23], v[20:23], v[36:39], a[20:23]
    v_mfma_f32_16x16x32_bf16 a[16:19], v[16:19], v[36:39], a[16:19]
    s_waitcnt vmcnt(17)
    v_mfma_f32_16x16x32_bf16 a[32:35], v[16:19], v[40:43], a[32:35]
    v_mfma_f32_16x16x32_bf16 a[36:39], v[20:23], v[40:43], a[36:39]
    v_mfma_f32_16x16x32_bf16 a[40:43], v[24:27], v[40:43], a[40:43]
    v_mfma_f32_16x16x32_bf16 a[44:47], v[28:31], v[40:43], a[44:47]
    s_waitcnt vmcnt(16)
    v_mfma_f32_16x16x32_bf16 a[60:63], v[28:31], v[44:47], a[60:63]
    v_mfma_f32_16x16x32_bf16 a[56:59], v[24:27], v[44:47], a[56:59]
    v_mfma_f32_16x16x32_bf16 a[52:55], v[20:23], v[44:47], a[52:55]
    v_mfma_f32_16x16x32_bf16 a[48:51], v[16:19], v[44:47], a[48:51]
    s_waitcnt vmcnt(15)
    v_mfma_f32_16x16x32_bf16 a[64:67], v[16:19], v[48:51], a[64:67]
    v_mfma_f32_16x16x32_bf16 a[68:71], v[20:23], v[48:51], a[68:71]
    v_mfma_f32_16x16x32_bf16 a[72:75], v[24:27], v[48:51], a[72:75]
    v_mfma_f32_16x16x32_bf16 a[76:79], v[28:31], v[48:51], a[76:79]
    s_waitcnt vmcnt(14)
    v_mfma_f32_16x16x32_bf16 a[92:95], v[28:31], v[52:55], a[92:95]
    v_mfma_f32_16x16x32_bf16 a[88:91], v[24:27], v[52:55], a[88:91]
    v_mfma_f32_16x16x32_bf16 a[84:87], v[20:23], v[52:55], a[84:87]
    v_mfma_f32_16x16x32_bf16 a[80:83], v[16:19], v[52:55], a[80:83]
    s_waitcnt vmcnt(13)
    v_mfma_f32_16x16x32_bf16 a[96:99], v[16:19], v[56:59], a[96:99]
    v_mfma_f32_16x16x32_bf16 a[100:103], v[20:23], v[56:59], a[100:103]
    v_mfma_f32_16x16x32_bf16 a[104:107], v[24:27], v[56:59], a[104:107]
    v_mfma_f32_16x16x32_bf16 a[108:111], v[28:31], v[56:59], a[108:111]
    s_waitcnt vmcnt(8)
    v_mfma_f32_16x16x32_bf16 a[112:115], v[16:19], v[60:63], a[112:115]
    ds_read_b64_tr_b16 v[16:17], v8 offset:4096
    ds_read_b64_tr_b16 v[18:19], v8 offset:6144
    v_mfma_f32_16x16x32_bf16 a[116:119], v[20:23], v[60:63], a[116:119]
    ds_read_b64_tr_b16 v[20:21], v9 offset:4096
    ds_read_b64_tr_b16 v[22:23], v9 offset:6144
    v_mfma_f32_16x16x32_bf16 a[120:123], v[24:27], v[60:63], a[120:123]
    ds_read_b64_tr_b16 v[24:25], v10 offset:4096
    ds_read_b64_tr_b16 v[26:27], v10 offset:6144
    v_mfma_f32_16x16x32_bf16 a[124:127], v[28:31], v[60:63], a[124:127]
    ds_read_b64_tr_b16 v[28:29], v11 offset:4096
    ds_read_b64_tr_b16 v[30:31], v11 offset:6144
    s_add_u32 s49, s49, 524288
    s_cmp_lg_u32 s3, 4
    s_cbranch_scc1 L_k2_kernel_polled
    v_mov_b32 v15, 0
    s_mov_b32 s77, 0x100000
L_k2_kernel_poll:
    v_mov_b32 v12, 0
    s_mov_b64 exec, 1
    buffer_atomic_add v12, v15, s[44:47], s57 offen sc0 sc1
    s_mov_b64 exec, -1
    s_waitcnt vmcnt(0)
    v_readfirstlane_b32 s76, v12
    s_nop 0
    s_cmp_ge_u32 s76, 64
    s_cbranch_scc1 L_k2_kernel_polled
    s_sub_u32 s77, s77, 1
    s_cmp_lg_u32 s77, 0
    s_cbranch_scc1 L_k2_kernel_poll
L_k2_kernel_polled:
    s_barrier
    buffer_load_dwordx4 v[64:67], v1, s[20:23], s48 offen offset:0 sc1
    buffer_load_dwordx4 v[68:71], v1, s[20:23], s48 offen offset:1024 sc1
    buffer_load_dwordx4 v[72:75], v2, s[20:23], s48 offen offset:0 sc1
    buffer_load_dwordx4 v[76:79], v2, s[20:23], s48 offen offset:1024 sc1
    buffer_load_dwordx4 v[80:83], v7, s[20:23], s48 offen offset:0 sc1
    buffer_load_dwordx4 v[84:87], v7, s[20:23], s48 offen offset:1024 sc1
    buffer_load_dwordx4 v[88:91], v13, s[20:23], s48 offen offset:0 sc1
    buffer_load_dwordx4 v[92:95], v13, s[20:23], s48 offen offset:1024 sc1
    s_add_u32 s48, s48, 32768
    buffer_load_dwordx4 v[96:99], v1, s[20:23], s48 offen offset:0 sc1
    buffer_load_dwordx4 v[100:103], v1, s[20:23], s48 offen offset:1024 sc1
    buffer_load_dwordx4 v[104:107], v2, s[20:23], s48 offen offset:0 sc1
    buffer_load_dwordx4 v[108:111], v2, s[20:23], s48 offen offset:1024 sc1
    buffer_load_dwordx4 v[112:115], v7, s[20:23], s48 offen offset:0 sc1
    buffer_load_dwordx4 v[116:119], v7, s[20:23], s48 offen offset:1024 sc1
    buffer_load_dwordx4 v[120:123], v13, s[20:23], s48 offen offset:0 sc1
    buffer_load_dwordx4 v[124:127], v13, s[20:23], s48 offen offset:1024 sc1
    s_add_u32 s48, s48, 32768
    buffer_load_dwordx4 v[32:35], v1, s[20:23], s48 offen offset:0 sc1
    buffer_load_dwordx4 v[36:39], v1, s[20:23], s48 offen offset:1024 sc1
    buffer_load_dwordx4 v[40:43], v2, s[20:23], s48 offen offset:0 sc1
    buffer_load_dwordx4 v[44:47], v2, s[20:23], s48 offen offset:1024 sc1
    buffer_load_dwordx4 v[48:51], v7, s[20:23], s48 offen offset:0 sc1
    buffer_load_dwordx4 v[52:55], v7, s[20:23], s48 offen offset:1024 sc1
    buffer_load_dwordx4 v[56:59], v13, s[20:23], s48 offen offset:0 sc1
    buffer_load_dwordx4 v[60:63], v13, s[20:23], s48 offen offset:1024 sc1
    s_add_u32 s48, s48, 32768
    s_waitcnt vmcnt(23) lgkmcnt(6)
    v_mfma_f32_16x16x32_bf16 a[0:3], v[16:19], v[64:67], a[0:3]
    s_waitcnt lgkmcnt(4)
    v_mfma_f32_16x16x32_bf16 a[4:7], v[20:23], v[64:67], a[4:7]
    s_waitcnt lgkmcnt(2)
    v_mfma_f32_16x16x32_bf16 a[8:11], v[24:27], v[64:67], a[8:11]
    s_waitcnt lgkmcnt(0)
    v_mfma_f32_16x16x32_bf16 a[12:15], v[28:31], v[64:67], a[12:15]
    buffer_load_dwordx4 v[64:67], v1, s[20:23], s48 offen offset:0 sc1
    s_waitcnt vmcnt(23)
    v_mfma_f32_16x16x32_bf16 a[28:31], v[28:31], v[68:71], a[28:31]
    s_add_u32 m0, s51, 4096
    s_nop 0
    buffer_load_dwordx4 v3, s[24:27], s49 offen offset:0 lds
    buffer_load_dwordx4 v4, s[24:27], s49 offen offset:1024 lds
    buffer_load_dwordx4 v5, s[24:27], s49 offen offset:2048 lds
    buffer_load_dwordx4 v6, s[24:27], s49 offen offset:3072 lds
    s_add_u32 s49, s49, 262144
    v_mfma_f32_16x16x32_bf16 a[24:27], v[24:27], v[68:71], a[24:27]
    v_mfma_f32_16x16x32_bf16 a[20:23], v[20:23], v[68:71], a[20:23]
    v_mfma_f32_16x16x32_bf16 a[16:19], v[16:19], v[68:71], a[16:19]
    buffer_load_dwordx4 v[68:71], v1, s[20:23], s48 offen offset:1024 sc1
    s_waitcnt vmcnt(27)
    v_mfma_f32_16x16x32_bf16 a[32:35], v[16:19], v[72:75], a[32:35]
    v_mfma_f32_16x16x32_bf16 a[36:39], v[20:23], v[72:75], a[36:39]
    v_mfma_f32_16x16x32_bf16 a[40:43], v[24:27], v[72:75], a[40:43]
    v_mfma_f32_16x16x32_bf16 a[44:47], v[28:31], v[72:75], a[44:47]
    buffer_load_dwordx4 v[72:75], v2, s[20:23], s48 offen offset:0 sc1
    s_waitcnt vmcnt(27)
    v_mfma_f32_16x16x32_bf16 a[60:63], v[28:31], v[76:79], a[60:63]
    v_mfma_f32_16x16x32_bf16 a[56:59], v[24:27], v[76:79], a[56:59]
    v_mfma_f32_16x16x32_bf16 a[52:55], v[20:23], v[76:79], a[52:55]
    v_mfma_f32_16x16x32_bf16 a[48:51], v[16:19], v[76:79], a[48:51]
    buffer_load_dwordx4 v[76:79], v2, s[20:23], s48 offen offset:1024 sc1
    s_waitcnt vmcnt(27)
    v_mfma_f32_16x16x32_bf16 a[64:67], v[16:19], v[80:83], a[64:67]
    v_mfma_f32_16x16x32_bf16 a[68:71], v[20:23], v[80:83], a[68:71]
    v_mfma_f32_16x16x32_bf16 a[72:75], v[24:27], v[80:83], a[72:75]
    v_mfma_f32_16x16x32_bf16 a[76:79], v[28:31], v[80:83], a[76:79]
    buffer_load_dwordx4 v[80:83], v7, s[20:23], s48 offen offset:0 sc1
    s_waitcnt vmcnt(27)
    v_mfma_f32_16x16x32_bf16 a[92:95], v[28:31], v[84:87], a[92:95]
    v_mfma_f32_16x16x32_bf16 a[88:91], v[24:27], v[84:87], a[88:91]
    v_mfma_f32_16x16x32_bf16 a[84:87], v[20:23], v[84:87], a[84:87]
    v_mfma_f32_16x16x32_bf16 a[80:83], v[16:19], v[84:87], a[80:83]
    buffer_load_dwordx4 v[84:87], v7, s[20:23], s48 offen offset:1024 sc1
    s_waitcnt vmcnt(27)
    v_mfma_f32_16x16x32_bf16 a[96:99], v[16:19], v[88:91], a[96:99]
    v_mfma_f32_16x16x32_bf16 a[100:103], v[20:23], v[88:91], a[100:103]
    v_mfma_f32_16x16x32_bf16 a[104:107], v[24:27], v[88:91], a[104:107]
    v_mfma_f32_16x16x32_bf16 a[108:111], v[28:31], v[88:91], a[108:111]
    buffer_load_dwordx4 v[88:91], v13, s[20:23], s48 offen offset:0 sc1
    s_waitcnt vmcnt(27)
    v_mfma_f32_16x16x32_bf16 a[112:115], v[16:19], v[92:95], a[112:115]
    ds_read_b64_tr_b16 v[16:17], v8 offset:8192
    ds_read_b64_tr_b16 v[18:19], v8 offset:10240
    v_mfma_f32_16x16x32_bf16 a[116:119], v[20:23], v[92:95], a[116:119]
    ds_read_b64_tr_b16 v[20:21], v9 offset:8192
    ds_read_b64_tr_b16 v[22:23], v9 offset:10240
    v_mfma_f32_16x16x32_bf16 a[120:123], v[24:27], v[92:95], a[120:123]
    ds_read_b64_tr_b16 v[24:25], v10 offset:8192
    ds_read_b64_tr_b16 v[26:27], v10 offset:10240
    v_mfma_f32_16x16x32_bf16 a[124:127], v[28:31], v[92:95], a[124:127]
    buffer_load_dwordx4 v[92:95], v13, s[20:23], s48 offen offset:1024 sc1
    s_add_u32 s48, s48, 32768
    ds_read_b64_tr_b16 v[28:29], v11 offset:8192
    ds_read_b64_tr_b16 v[30:31], v11 offset:10240
    s_waitcnt vmcnt(27) lgkmcnt(6)
    v_mfma_f32_16x16x32_bf16 a[0:3], v[16:19], v[96:99], a[0:3]
    s_waitcnt lgkmcnt(4)
    v_mfma_f32_16x16x32_bf16 a[4:7], v[20:23], v[96:99], a[4:7]
    s_waitcnt lgkmcnt(2)
    v_mfma_f32_16x16x32_bf16 a[8:11], v[24:27], v[96:99], a[8:11]
    s_waitcnt lgkmcnt(0)
    v_mfma_f32_16x16x32_bf16 a[12:15], v[28:31], v[96:99], a[12:15]
    buffer_load_dwordx4 v[96:99], v1, s[20:23], s48 offen offset:0 sc1
    s_waitcnt vmcnt(27)
    v_mfma_f32_16x16x32_bf16 a[28:31], v[28:31], v[100:103], a[28:31]
    s_add_u32 m0, s51, 8192
    s_nop 0
    buffer_load_dwordx4 v3, s[24:27], s49 offen offset:0 lds
    buffer_load_dwordx4 v4, s[24:27], s49 offen offset:1024 lds
    buffer_load_dwordx4 v5, s[24:27], s49 offen offset:2048 lds
    buffer_load_dwordx4 v6, s[24:27], s49 offen offset:3072 lds
    s_add_u32 s49, s49, 262144
    v_mfma_f32_16x16x32_bf16 a[24:27], v[24:27], v[100:103], a[24:27]
    v_mfma_f32_16x16x32_bf16 a[20:23], v[20:23], v[100:103], a[20:23]
    v_mfma_f32_16x16x32_bf16 a[16:19], v[16:19], v[100:103], a[16:19]
    buffer_load_dwordx4 v[100:103], v1, s[20:23], s48 offen offset:1024 sc1
    s_waitcnt vmcnt(31)
    v_mfma_f32_16x16x32_bf16 a[32:35], v[16:19], v[104:107], a[32:35]
    v_mfma_f32_16x16x32_bf16 a[36:39], v[20:23], v[104:107], a[36:39]
    v_mfma_f32_16x16x32_bf16 a[40:43], v[24:27], v[104:107], a[40:43]
    v_mfma_f32_16x16x32_bf16 a[44:47], v[28:31], v[104:107], a[44:47]
    buffer_load_dwordx4 v[104:107], v2, s[20:23], s48 offen offset:0 sc1
    s_waitcnt vmcnt(31)
    v_mfma_f32_16x16x32_bf16 a[60:63], v[28:31], v[108:111], a[60:63]
    v_mfma_f32_16x16x32_bf16 a[56:59], v[24:27], v[108:111], a[56:59]
    v_mfma_f32_16x16x32_bf16 a[52:55], v[20:23], v[108:111], a[52:55]
    v_mfma_f32_16x16x32_bf16 a[48:51], v[16:19], v[108:111], a[48:51]
    buffer_load_dwordx4 v[108:111], v2, s[20:23], s48 offen offset:1024 sc1
    s_waitcnt vmcnt(31)
    v_mfma_f32_16x16x32_bf16 a[64:67], v[16:19], v[112:115], a[64:67]
    v_mfma_f32_16x16x32_bf16 a[68:71], v[20:23], v[112:115], a[68:71]
    v_mfma_f32_16x16x32_bf16 a[72:75], v[24:27], v[112:115], a[72:75]
    v_mfma_f32_16x16x32_bf16 a[76:79], v[28:31], v[112:115], a[76:79]
    buffer_load_dwordx4 v[112:115], v7, s[20:23], s48 offen offset:0 sc1
    s_waitcnt vmcnt(31)
    v_mfma_f32_16x16x32_bf16 a[92:95], v[28:31], v[116:119], a[92:95]
    v_mfma_f32_16x16x32_bf16 a[88:91], v[24:27], v[116:119], a[88:91]
    v_mfma_f32_16x16x32_bf16 a[84:87], v[20:23], v[116:119], a[84:87]
    v_mfma_f32_16x16x32_bf16 a[80:83], v[16:19], v[116:119], a[80:83]
    buffer_load_dwordx4 v[116:119], v7, s[20:23], s48 offen offset:1024 sc1
    s_waitcnt vmcnt(31)
    v_mfma_f32_16x16x32_bf16 a[96:99], v[16:19], v[120:123], a[96:99]
    v_mfma_f32_16x16x32_bf16 a[100:103], v[20:23], v[120:123], a[100:103]
    v_mfma_f32_16x16x32_bf16 a[104:107], v[24:27], v[120:123], a[104:107]
    v_mfma_f32_16x16x32_bf16 a[108:111], v[28:31], v[120:123], a[108:111]
    buffer_load_dwordx4 v[120:123], v13, s[20:23], s48 offen offset:0 sc1
    s_waitcnt vmcnt(31)
    v_mfma_f32_16x16x32_bf16 a[112:115], v[16:19], v[124:127], a[112:115]
    ds_read_b64_tr_b16 v[16:17], v8 offset:0
    ds_read_b64_tr_b16 v[18:19], v8 offset:2048
    v_mfma_f32_16x16x32_bf16 a[116:119], v[20:23], v[124:127], a[116:119]
    ds_read_b64_tr_b16 v[20:21], v9 offset:0
    ds_read_b64_tr_b16 v[22:23], v9 offset:2048
    v_mfma_f32_16x16x32_bf16 a[120:123], v[24:27], v[124:127], a[120:123]
    ds_read_b64_tr_b16 v[24:25], v10 offset:0
    ds_read_b64_tr_b16 v[26:27], v10 offset:2048
    v_mfma_f32_16x16x32_bf16 a[124:127], v[28:31], v[124:127], a[124:127]
    buffer_load_dwordx4 v[124:127], v13, s[20:23], s48 offen offset:1024 sc1
    s_add_u32 s48, s48, 32768
    ds_read_b64_tr_b16 v[28:29], v11 offset:0
    ds_read_b64_tr_b16 v[30:31], v11 offset:2048
    s_waitcnt vmcnt(31) lgkmcnt(6)
    v_mfma_f32_16x16x32_bf16 a[0:3], v[16:19], v[32:35], a[0:3]
    s_waitcnt lgkmcnt(4)
    v_mfma_f32_16x16x32_bf16 a[4:7], v[20:23], v[32:35], a[4:7]
    s_waitcnt lgkmcnt(2)
    v_mfma_f32_16x16x32_bf16 a[8:11], v[24:27], v[32:35], a[8:11]
    s_waitcnt lgkmcnt(0)
    v_mfma_f32_16x16x32_bf16 a[12:15], v[28:31], v[32:35], a[12:15]
    buffer_load_dwordx4 v[32:35], v1, s[20:23], s48 offen offset:0 sc1
    s_waitcnt vmcnt(31)
    v_mfma_f32_16x16x32_bf16 a[28:31], v[28:31], v[36:39], a[28:31]
    s_add_u32 m0, s51, 0
    s_nop 0
    buffer_load_dwordx4 v3, s[24:27], s49 offen offset:0 lds
    buffer_load_dwordx4 v4, s[24:27], s49 offen offset:1024 lds
    buffer_load_dwordx4 v5, s[24:27], s49 offen offset:2048 lds
    buffer_load_dwordx4 v6, s[24:27], s49 offen offset:3072 lds
    s_add_u32 s49, s49, 262144
    v_mfma_f32_16x16x32_bf16 a[24:27], v[24:27], v[36:39], a[24:27]
    v_mfma_f32_16x16x32_bf16 a[20:23], v[20:23], v[36:39], a[20:23]
    v_mfma_f32_16x16x32_bf16 a[16:19], v[16:19], v[36:39], a[16:19]
    buffer_load_dwordx4 v[36:39], v1, s[20:23], s48 offen offset:1024 sc1
    s_waitcnt vmcnt(35)
    v_mfma_f32_16x16x32_bf16 a[32:35], v[16:19], v[40:43], a[32:35]
    v_mfma_f32_16x16x32_bf16 a[36:39], v[20:23], v[40:43], a[36:39]
    v_mfma_f32_16x16x32_bf16 a[40:43], v[24:27], v[40:43], a[40:43]
    v_mfma_f32_16x16x32_bf16 a[44:47], v[28:31], v[40:43], a[44:47]
    buffer_load_dwordx4 v[40:43], v2, s[20:23], s48 offen offset:0 sc1
    s_waitcnt vmcnt(35)
    v_mfma_f32_16x16x32_bf16 a[60:63], v[28:31], v[44:47], a[60:63]
    v_mfma_f32_16x16x32_bf16 a[56:59], v[24:27], v[44:47], a[56:59]
    v_mfma_f32_16x16x32_bf16 a[52:55], v[20:23], v[44:47], a[52:55]
    v_mfma_f32_16x16x32_bf16 a[48:51], v[16:19], v[44:47], a[48:51]
    buffer_load_dwordx4 v[44:47], v2, s[20:23], s48 offen offset:1024 sc1
    s_waitcnt vmcnt(35)
    v_mfma_f32_16x16x32_bf16 a[64:67], v[16:19], v[48:51], a[64:67]
    v_mfma_f32_16x16x32_bf16 a[68:71], v[20:23], v[48:51], a[68:71]
    v_mfma_f32_16x16x32_bf16 a[72:75], v[24:27], v[48:51], a[72:75]
    v_mfma_f32_16x16x32_bf16 a[76:79], v[28:31], v[48:51], a[76:79]
    buffer_load_dwordx4 v[48:51], v7, s[20:23], s48 offen offset:0 sc1
    s_waitcnt vmcnt(35)
    v_mfma_f32_16x16x32_bf16 a[92:95], v[28:31], v[52:55], a[92:95]
    v_mfma_f32_16x16x32_bf16 a[88:91], v[24:27], v[52:55], a[88:91]
    v_mfma_f32_16x16x32_bf16 a[84:87], v[20:23], v[52:55], a[84:87]
    v_mfma_f32_16x16x32_bf16 a[80:83], v[16:19], v[52:55], a[80:83]
    buffer_load_dwordx4 v[52:55], v7, s[20:23], s48 offen offset:1024 sc1
    s_waitcnt vmcnt(35)
    v_mfma_f32_16x16x32_bf16 a[96:99], v[16:19], v[56:59], a[96:99]
    v_mfma_f32_16x16x32_bf16 a[100:103], v[20:23], v[56:59], a[100:103]
    v_mfma_f32_16x16x32_bf16 a[104:107], v[24:27], v[56:59], a[104:107]
    v_add_u32 v8, s59, v8
    v_add_u32 v9, s59, v9
    v_add_u32 v10, s59, v10
    v_add_u32 v11, s59, v11
    v_mfma_f32_16x16x32_bf16 a[108:111], v[28:31], v[56:59], a[108:111]
    buffer_load_dwordx4 v[56:59], v13, s[20:23], s48 offen offset:0 sc1
    s_waitcnt vmcnt(35)
    v_mfma_f32_16x16x32_bf16 a[112:115], v[16:19], v[60:63], a[112:115]
    ds_read_b64_tr_b16 v[16:17], v8 offset:0
    ds_read_b64_tr_b16 v[18:19], v8 offset:2048
    v_mfma_f32_16x16x32_bf16 a[116:119], v[20:23], v[60:63], a[116:119]
    ds_read_b64_tr_b16 v[20:21], v9 offset:0
    ds_read_b64_tr_b16 v[22:23], v9 offset:2048
    v_mfma_f32_16x16x32_bf16 a[120:123], v[24:27], v[60:63], a[120:123]
    ds_read_b64_tr_b16 v[24:25], v10 offset:0
    ds_read_b64_tr_b16 v[26:27], v10 offset:2048
    v_mfma_f32_16x16x32_bf16 a[124:127], v[28:31], v[60:63], a[124:127]
    buffer_load_dwordx4 v[60:63], v13, s[20:23], s48 offen offset:1024 sc1
    s_add_u32 s48, s48, 32768
    ds_read_b64_tr_b16 v[28:29], v11 offset:0
    ds_read_b64_tr_b16 v[30:31], v11 offset:2048
    s_waitcnt vmcnt(35) lgkmcnt(6)
    v_mfma_f32_16x16x32_bf16 a[0:3], v[16:19], v[64:67], a[0:3]
    s_waitcnt lgkmcnt(4)
    v_mfma_f32_16x16x32_bf16 a[4:7], v[20:23], v[64:67], a[4:7]
    s_waitcnt lgkmcnt(2)
    v_mfma_f32_16x16x32_bf16 a[8:11], v[24:27], v[64:67], a[8:11]
    s_waitcnt lgkmcnt(0)
    v_mfma_f32_16x16x32_bf16 a[12:15], v[28:31], v[64:67], a[12:15]
    buffer_load_dwordx4 v[64:67], v1, s[20:23], s48 offen offset:0 sc1
    s_waitcnt vmcnt(31)
    v_mfma_f32_16x16x32_bf16 a[28:31], v[28:31], v[68:71], a[28:31]
    v_mfma_f32_16x16x32_bf16 a[24:27], v[24:27], v[68:71], a[24:27]
    v_mfma_f32_16x16x32_bf16 a[20:23], v[20:23], v[68:71], a[20:23]
    v_mfma_f32_16x16x32_bf16 a[16:19], v[16:19], v[68:71], a[16:19]
    buffer_load_dwordx4 v[68:71], v1, s[20:23], s48 offen offset:1024 sc1
    s_waitcnt vmcnt(31)
    v_mfma_f32_16x16x32_bf16 a[32:35], v[16:19], v[72:75], a[32:35]
    v_mfma_f32_16x16x32_bf16 a[36:39], v[20:23], v[72:75], a[36:39]
    v_mfma_f32_16x16x32_bf16 a[40:43], v[24:27], v[72:75], a[40:43]
    v_mfma_f32_16x16x32_bf16 a[44:47], v[28:31], v[72:75], a[44:47]
    buffer_load_dwordx4 v[72:75], v2, s[20:23], s48 offen offset:0 sc1
    s_waitcnt vmcnt(31)
    v_mfma_f32_16x16x32_bf16 a[60:63], v[28:31], v[76:79], a[60:63]
    v_mfma_f32_16x16x32_bf16 a[56:59], v[24:27], v[76:79], a[56:59]
    v_mfma_f32_16x16x32_bf16 a[52:55], v[20:23], v[76:79], a[52:55]
    v_mfma_f32_16x16x32_bf16 a[48:51], v[16:19], v[76:79], a[48:51]
    buffer_load_dwordx4 v[76:79], v2, s[20:23], s48 offen offset:1024 sc1
    s_waitcnt vmcnt(31)
    v_mfma_f32_16x16x32_bf16 a[64:67], v[16:19], v[80:83], a[64:67]
    v_mfma_f32_16x16x32_bf16 a[68:71], v[20:23], v[80:83], a[68:71]
    v_mfma_f32_16x16x32_bf16 a[72:75], v[24:27], v[80:83], a[72:75]
    v_mfma_f32_16x16x32_bf16 a[76:79], v[28:31], v[80:83], a[76:79]
    buffer_load_dwordx4 v[80:83], v7, s[20:23], s48 offen offset:0 sc1
    s_waitcnt vmcnt(31)
    v_mfma_f32_16x16x32_bf16 a[92:95], v[28:31], v[84:87], a[92:95]
    v_mfma_f32_16x16x32_bf16 a[88:91], v[24:27], v[84:87], a[88:91]
    v_mfma_f32_16x16x32_bf16 a[84:87], v[20:23], v[84:87], a[84:87]
    v_mfma_f32_16x16x32_bf16 a[80:83], v[16:19], v[84:87], a[80:83]
    buffer_load_dwordx4 v[84:87], v7, s[20:23], s48 offen offset:1024 sc1
    s_waitcnt vmcnt(31)
    v_mfma_f32_16x16x32_bf16 a[96:99], v[16:19], v[88:91], a[96:99]
    v_mfma_f32_16x16x32_bf16 a[100:103], v[20:23], v[88:91], a[100:103]
    v_mfma_f32_16x16x32_bf16 a[104:107], v[24:27], v[88:91], a[104:107]
    v_mfma_f32_16x16x32_bf16 a[108:111], v[28:31], v[88:91], a[108:111]
    buffer_load_dwordx4 v[88:91], v13, s[20:23], s48 offen offset:0 sc1
    s_waitcnt vmcnt(31)
    v_mfma_f32_16x16x32_bf16 a[112:115], v[16:19], v[92:95], a[112:115]
    ds_read_b64_tr_b16 v[16:17], v8 offset:4096
    ds_read_b64_tr_b16 v[18:19], v8 offset:6144
    v_mfma_f32_16x16x32_bf16 a[116:119], v[20:23], v[92:95], a[116:119]
    ds_read_b64_tr_b16 v[20:21], v9 offset:4096
    ds_read_b64_tr_b16 v[22:23], v9 offset:6144
    v_mfma_f32_16x16x32_bf16 a[120:123], v[24:27], v[92:95], a[120:123]
    ds_read_b64_tr_b16 v[24:25], v10 offset:4096
    ds_read_b64_tr_b16 v[26:27], v10 offset:6144
    v_mfma_f32_16x16x32_bf16 a[124:127], v[28:31], v[92:95], a[124:127]
    buffer_load_dwordx4 v[92:95], v13, s[20:23], s48 offen offset:1024 sc1
    s_add_u32 s48, s48, 32768
    ds_read_b64_tr_b16 v[28:29], v11 offset:4096
    ds_read_b64_tr_b16 v[30:31], v11 offset:6144
    s_waitcnt vmcnt(31) lgkmcnt(6)
    v_mfma_f32_16x16x32_bf16 a[0:3], v[16:19], v[96:99], a[0:3]
    s_waitcnt lgkmcnt(4)
    v_mfma_f32_16x16x32_bf16 a[4:7], v[20:23], v[96:99], a[4:7]
    s_waitcnt lgkmcnt(2)
    v_mfma_f32_16x16x32_bf16 a[8:11], v[24:27], v[96:99], a[8:11]
    s_waitcnt lgkmcnt(0)
    v_mfma_f32_16x16x32_bf16 a[12:15], v[28:31], v[96:99], a[12:15]
    buffer_load_dwordx4 v[96:99], v1, s[20:23], s48 offen offset:0 sc1
    s_waitcnt vmcnt(27)
    v_mfma_f32_16x16x32_bf16 a[28:31], v[28:31], v[100:103], a[28:31]
    v_mfma_f32_16x16x32_bf16 a[24:27], v[24:27], v[100:103], a[24:27]
    v_mfma_f32_16x16x32_bf16 a[20:23], v[20:23], v[100:103], a[20:23]
    v_mfma_f32_16x16x32_bf16 a[16:19], v[16:19], v[100:103], a[16:19]
    buffer_load_dwordx4 v[100:103], v1, s[20:23], s48 offen offset:1024 sc1
    s_waitcnt vmcnt(27)
    v_mfma_f32_16x16x32_bf16 a[32:35], v[16:19], v[104:107], a[32:35]
    v_mfma_f32_16x16x32_bf16 a[36:39], v[20:23], v[104:107], a[36:39]
    v_mfma_f32_16x16x32_bf16 a[40:43], v[24:27], v[104:107], a[40:43]
    v_mfma_f32_16x16x32_bf16 a[44:47], v[28:31], v[104:107], a[44:47]
    buffer_load_dwordx4 v[104:107], v2, s[20:23], s48 offen offset:0 sc1
    s_waitcnt vmcnt(27)
    v_mfma_f32_16x16x32_bf16 a[60:63], v[28:31], v[108:111], a[60:63]
    v_mfma_f32_16x16x32_bf16 a[56:59], v[24:27], v[108:111], a[56:59]
    v_mfma_f32_16x16x32_bf16 a[52:55], v[20:23], v[108:111], a[52:55]
    v_mfma_f32_16x16x32_bf16 a[48:51], v[16:19], v[108:111], a[48:51]
    buffer_load_dwordx4 v[108:111], v2, s[20:23], s48 offen offset:1024 sc1
    s_waitcnt vmcnt(27)
    v_mfma_f32_16x16x32_bf16 a[64:67], v[16:19], v[112:115], a[64:67]
    v_mfma_f32_16x16x32_bf16 a[68:71], v[20:23], v[112:115], a[68:71]
    v_mfma_f32_16x16x32_bf16 a[72:75], v[24:27], v[112:115], a[72:75]
    v_mfma_f32_16x16x32_bf16 a[76:79], v[28:31], v[112:115], a[76:79]
    buffer_load_dwordx4 v[112:115], v7, s[20:23], s48 offen offset:0 sc1
    s_waitcnt vmcnt(27)
    v_mfma_f32_16x16x32_bf16 a[92:95], v[28:31], v[116:119], a[92:95]
    v_mfma_f32_16x16x32_bf16 a[88:91], v[24:27], v[116:119], a[88:91]
    v_mfma_f32_16x16x32_bf16 a[84:87], v[20:23], v[116:119], a[84:87]
    v_mfma_f32_16x16x32_bf16 a[80:83], v[16:19], v[116:119], a[80:83]
    buffer_load_dwordx4 v[116:119], v7, s[20:23], s48 offen offset:1024 sc1
    s_waitcnt vmcnt(27)
    v_mfma_f32_16x16x32_bf16 a[96:99], v[16:19], v[120:123], a[96:99]
    v_mfma_f32_16x16x32_bf16 a[100:103], v[20:23], v[120:123], a[100:103]
    v_mfma_f32_16x16x32_bf16 a[104:107], v[24:27], v[120:123], a[104:107]
    v_subrev_u32 v8, s59, v8
    v_subrev_u32 v9, s59, v9
    v_subrev_u32 v10, s59, v10
    v_subrev_u32 v11, s59, v11
    v_mfma_f32_16x16x32_bf16 a[108:111], v[28:31], v[120:123], a[108:111]
    buffer_load_dwordx4 v[120:123], v13, s[20:23], s48 offen offset:0 sc1
    s_waitcnt vmcnt(27)
    v_mfma_f32_16x16x32_bf16 a[112:115], v[16:19], v[124:127], a[112:115]
    ds_read_b64_tr_b16 v[16:17], v8 offset:4096
    ds_read_b64_tr_b16 v[18:19], v8 offset:6144
    v_mfma_f32_16x16x32_bf16 a[116:119], v[20:23], v[124:127], a[116:119]
    ds_read_b64_tr_b16 v[20:21], v9 offset:4096
    ds_read_b64_tr_b16 v[22:23], v9 offset:6144
    v_mfma_f32_16x16x32_bf16 a[120:123], v[24:27], v[124:127], a[120:123]
    ds_read_b64_tr_b16 v[24:25], v10 offset:4096
    ds_read_b64_tr_b16 v[26:27], v10 offset:6144
    v_mfma_f32_16x16x32_bf16 a[124:127], v[28:31], v[124:127], a[124:127]
    buffer_load_dwordx4 v[124:127], v13, s[20:23], s48 offen offset:1024 sc1
    s_add_u32 s48, s48, 32768
    ds_read_b64_tr_b16 v[28:29], v11 offset:4096
    ds_read_b64_tr_b16 v[30:31], v11 offset:6144
    s_waitcnt vmcnt(27) lgkmcnt(6)
    v_mfma_f32_16x16x32_bf16 a[0:3], v[16:19], v[32:35], a[0:3]
    s_waitcnt lgkmcnt(4)
    v_mfma_f32_16x16x32_bf16 a[4:7], v[20:23], v[32:35], a[4:7]
    s_waitcnt lgkmcnt(2)
    v_mfma_f32_16x16x32_bf16 a[8:11], v[24:27], v[32:35], a[8:11]
    s_waitcnt lgkmcnt(0)
    v_mfma_f32_16x16x32_bf16 a[12:15], v[28:31], v[32:35], a[12:15]
    s_waitcnt vmcnt(22)
    v_mfma_f32_16x16x32_bf16 a[28:31], v[28:31], v[36:39], a[28:31]
    v_mfma_f32_16x16x32_bf16 a[24:27], v[24:27], v[36:39], a[24:27]
    v_mfma_f32_16x16x32_bf16 a[20:23], v[20:23], v[36:39], a[20:23]
    v_mfma_f32_16x16x32_bf16 a[16:19], v[16:19], v[36:39], a[16:19]
    s_waitcnt vmcnt(21)
    v_mfma_f32_16x16x32_bf16 a[32:35], v[16:19], v[40:43], a[32:35]
    v_mfma_f32_16x16x32_bf16 a[36:39], v[20:23], v[40:43], a[36:39]
    v_mfma_f32_16x16x32_bf16 a[40:43], v[24:27], v[40:43], a[40:43]
    v_mfma_f32_16x16x32_bf16 a[44:47], v[28:31], v[40:43], a[44:47]
    s_waitcnt vmcnt(20)
    v_mfma_f32_16x16x32_bf16 a[60:63], v[28:31], v[44:47], a[60:63]
    v_mfma_f32_16x16x32_bf16 a[56:59], v[24:27], v[44:47], a[56:59]
    v_mfma_f32_16x16x32_bf16 a[52:55], v[20:23], v[44:47], a[52:55]
    v_mfma_f32_16x16x32_bf16 a[48:51], v[16:19], v[44:47], a[48:51]
    s_waitcnt vmcnt(19)
    v_mfma_f32_16x16x32_bf16 a[64:67], v[16:19], v[48:51], a[64:67]
    v_mfma_f32_16x16x32_bf16 a[68:71], v[20:23], v[48:51], a[68:71]
    v_mfma_f32_16x16x32_bf16 a[72:75], v[24:27], v[48:51], a[72:75]
    v_mfma_f32_16x16x32_bf16 a[76:79], v[28:31], v[48:51], a[76:79]
    s_waitcnt vmcnt(18)
    v_mfma_f32_16x16x32_bf16 a[92:95], v[28:31], v[52:55], a[92:95]
    v_mfma_f32_16x16x32_bf16 a[88:91], v[24:27], v[52:55], a[88:91]
    v_mfma_f32_16x16x32_bf16 a[84:87], v[20:23], v[52:55], a[84:87]
    v_mfma_f32_16x16x32_bf16 a[80:83], v[16:19], v[52:55], a[80:83]
    s_waitcnt vmcnt(17)
    v_mfma_f32_16x16x32_bf16 a[96:99], v[16:19], v[56:59], a[96:99]
    v_mfma_f32_16x16x32_bf16 a[100:103], v[20:23], v[56:59], a[100:103]
    v_mfma_f32_16x16x32_bf16 a[104:107], v[24:27], v[56:59], a[104:107]
    v_mfma_f32_16x16x32_bf16 a[108:111], v[28:31], v[56:59], a[108:111]
    s_waitcnt vmcnt(16)
    v_mfma_f32_16x16x32_bf16 a[112:115], v[16:19], v[60:63], a[112:115]
    ds_read_b64_tr_b16 v[16:17], v8 offset:8192
    ds_read_b64_tr_b16 v[18:19], v8 offset:10240
    v_mfma_f32_16x16x32_bf16 a[116:119], v[20:23], v[60:63], a[116:119]
    ds_read_b64_tr_b16 v[20:21], v9 offset:8192
    ds_read_b64_tr_b16 v[22:23], v9 offset:10240
    v_mfma_f32_16x16x32_bf16 a[120:123], v[24:27], v[60:63], a[120:123]
    ds_read_b64_tr_b16 v[24:25], v10 offset:8192
    ds_read_b64_tr_b16 v[26:27], v10 offset:10240
    v_mfma_f32_16x16x32_bf16 a[124:127], v[28:31], v[60:63], a[124:127]
    ds_read_b64_tr_b16 v[28:29], v11 offset:8192
    ds_read_b64_tr_b16 v[30:31], v11 offset:10240
    s_waitcnt vmcnt(15) lgkmcnt(6)
    v_mfma_f32_16x16x32_bf16 a[0:3], v[16:19], v[64:67], a[0:3]
    s_waitcnt lgkmcnt(4)
    v_mfma_f32_16x16x32_bf16 a[4:7], v[20:23], v[64:67], a[4:7]
    buffer_load_dwordx4 v[32:35], v14, s[36:39], s53 offen offset:0
    buffer_load_dwordx4 v[36:39], v14, s[36:39], s53 offen offset:64
    buffer_load_dwordx4 v[40:43], v14, s[36:39], s73 offen offset:0
    buffer_load_dwordx4 v[44:47], v14, s[36:39], s73 offen offset:64
    s_waitcnt lgkmcnt(2)
    v_mfma_f32_16x16x32_bf16 a[8:11], v[24:27], v[64:67], a[8:11]
    s_waitcnt lgkmcnt(0)
    v_mfma_f32_16x16x32_bf16 a[12:15], v[28:31], v[64:67], a[12:15]
    s_waitcnt vmcnt(18)
    v_mfma_f32_16x16x32_bf16 a[28:31], v[28:31], v[68:71], a[28:31]
    v_mfma_f32_16x16x32_bf16 a[24:27], v[24:27], v[68:71], a[24:27]
    v_lshlrev_b32 v12, 4, v0
    s_mul_i32 s74, s66, 24576
    v_add_u32 v4, s74, v12
    s_add_u32 s75, s66, 1
    s_and_b32 s75, s75, 3
    s_mul_i32 s75, s75, 24576
    v_add_u32 v1, s75, v12
    s_add_u32 s75, s66, 2
    s_and_b32 s75, s75, 3
    s_mul_i32 s75, s75, 24576
    v_add_u32 v2, s75, v12
    s_add_u32 s75, s66, 3
    s_and_b32 s75, s75, 3
    s_mul_i32 s75, s75, 24576
    v_add_u32 v3, s75, v12
    v_mfma_f32_16x16x32_bf16 a[20:23], v[20:23], v[68:71], a[20:23]
    v_mfma_f32_16x16x32_bf16 a[16:19], v[16:19], v[68:71], a[16:19]
    s_waitcnt vmcnt(17)
    v_mfma_f32_16x16x32_bf16 a[32:35], v[16:19], v[72:75], a[32:35]
    v_mfma_f32_16x16x32_bf16 a[36:39], v[20:23], v[72:75], a[36:39]
    v_mfma_f32_16x16x32_bf16 a[40:43], v[24:27], v[72:75], a[40:43]
    v_mfma_f32_16x16x32_bf16 a[44:47], v[28:31], v[72:75], a[44:47]
    s_waitcnt vmcnt(16)
    v_mfma_f32_16x16x32_bf16 a[60:63], v[28:31], v[76:79], a[60:63]
    v_mfma_f32_16x16x32_bf16 a[56:59], v[24:27], v[76:79], a[56:59]
    v_mfma_f32_16x16x32_bf16 a[52:55], v[20:23], v[76:79], a[52:55]
    v_mfma_f32_16x16x32_bf16 a[48:51], v[16:19], v[76:79], a[48:51]
    s_waitcnt vmcnt(15)
    v_mfma_f32_16x16x32_bf16 a[64:67], v[16:19], v[80:83], a[64:67]
    v_mfma_f32_16x16x32_bf16 a[68:71], v[20:23], v[80:83], a[68:71]
    v_mfma_f32_16x16x32_bf16 a[72:75], v[24:27], v[80:83], a[72:75]
    v_mfma_f32_16x16x32_bf16 a[76:79], v[28:31], v[80:83], a[76:79]
    s_waitcnt vmcnt(14)
    v_mfma_f32_16x16x32_bf16 a[92:95], v[28:31], v[84:87], a[92:95]
    v_mfma_f32_16x16x32_bf16 a[88:91], v[24:27], v[84:87], a[88:91]
    v_mfma_f32_16x16x32_bf16 a[84:87], v[20:23], v[84:87], a[84:87]
    v_mfma_f32_16x16x32_bf16 a[80:83], v[16:19], v[84:87], a[80:83]
    s_waitcnt vmcnt(13)
    v_mfma_f32_16x16x32_bf16 a[96:99], v[16:19], v[88:91], a[96:99]
    v_mfma_f32_16x16x32_bf16 a[100:103], v[20:23], v[88:91], a[100:103]
    v_mfma_f32_16x16x32_bf16 a[104:107], v[24:27], v[88:91], a[104:107]
    v_mfma_f32_16x16x32_bf16 a[108:111], v[28:31], v[88:91], a[108:111]
    s_waitcnt vmcnt(12)
    v_mfma_f32_16x16x32_bf16 a[112:115], v[16:19], v[92:95], a[112:115]
    ds_read_b64_tr_b16 v[16:17], v8 offset:0
    ds_read_b64_tr_b16 v[18:19], v8 offset:2048
    v_mfma_f32_16x16x32_bf16 a[116:119], v[20:23], v[92:95], a[116:119]
    ds_read_b64_tr_b16 v[20:21], v9 offset:0
    ds_read_b64_tr_b16 v[22:23], v9 offset:2048
    v_mfma_f32_16x16x32_bf16 a[120:123], v[24:27], v[92:95], a[120:123]
    ds_read_b64_tr_b16 v[24:25], v10 offset:0
    ds_read_b64_tr_b16 v[26:27], v10 offset:2048
    v_mfma_f32_16x16x32_bf16 a[124:127], v[28:31], v[92:95], a[124:127]
    ds_read_b64_tr_b16 v[28:29], v11 offset:0
    ds_read_b64_tr_b16 v[30:31], v11 offset:2048
    s_waitcnt lgkmcnt(0)
    s_barrier
    s_waitcnt vmcnt(9)
    v_mfma_f32_16x16x32_bf16 a[32:35], v[16:19], v[104:107], a[32:35]
    v_mfma_f32_16x16x32_bf16 a[36:39], v[20:23], v[104:107], a[36:39]
    v_mfma_f32_16x16x32_bf16 a[40:43], v[24:27], v[104:107], a[40:43]
    v_mfma_f32_16x16x32_bf16 a[44:47], v[28:31], v[104:107], a[44:47]
    s_waitcnt vmcnt(8)
    v_mfma_f32_16x16x32_bf16 a[60:63], v[28:31], v[108:111], a[60:63]
    v_mfma_f32_16x16x32_bf16 a[56:59], v[24:27], v[108:111], a[56:59]
    v_mfma_f32_16x16x32_bf16 a[52:55], v[20:23], v[108:111], a[52:55]
    v_mfma_f32_16x16x32_bf16 a[48:51], v[16:19], v[108:111], a[48:51]
    s_waitcnt vmcnt(7)
    v_mfma_f32_16x16x32_bf16 a[64:67], v[16:19], v[112:115], a[64:67]
    ds_write_b128 v1, a[32:35] offset:0
    v_mfma_f32_16x16x32_bf16 a[68:71], v[20:23], v[112:115], a[68:71]
    ds_write_b128 v1, a[36:39] offset:1024
    v_mfma_f32_16x16x32_bf16 a[72:75], v[24:27], v[112:115], a[72:75]
    ds_write_b128 v1, a[40:43] offset:2048
    v_mfma_f32_16x16x32_bf16 a[76:79], v[28:31], v[112:115], a[76:79]
    ds_write_b128 v1, a[44:47] offset:3072
    s_waitcnt vmcnt(6)
    v_mfma_f32_16x16x32_bf16 a[92:95], v[28:31], v[116:119], a[92:95]
    ds_write_b128 v1, a[48:51] offset:4096
    v_mfma_f32_16x16x32_bf16 a[88:91], v[24:27], v[116:119], a[88:91]
    ds_write_b128 v1, a[52:55] offset:5120
    v_mfma_f32_16x16x32_bf16 a[84:87], v[20:23], v[116:119], a[84:87]
    ds_write_b128 v1, a[56:59] offset:6144
    v_mfma_f32_16x16x32_bf16 a[80:83], v[16:19], v[116:119], a[80:83]
    ds_write_b128 v1, a[60:63] offset:7168
    s_waitcnt vmcnt(5)
    v_mfma_f32_16x16x32_bf16 a[96:99], v[16:19], v[120:123], a[96:99]
    ds_write_b128 v2, a[64:67] offset:8192
    v_mfma_f32_16x16x32_bf16 a[100:103], v[20:23], v[120:123], a[100:103]
    ds_write_b128 v2, a[68:71] offset:9216
    v_mfma_f32_16x16x32_bf16 a[104:107], v[24:27], v[120:123], a[104:107]
    ds_write_b128 v2, a[72:75] offset:10240
    v_mfma_f32_16x16x32_bf16 a[108:111], v[28:31], v[120:123], a[108:111]
    ds_write_b128 v2, a[76:79] offset:11264
    s_waitcnt vmcnt(4)
    v_mfma_f32_16x16x32_bf16 a[112:115], v[16:19], v[124:127], a[112:115]
    ds_write_b128 v2, a[80:83] offset:12288
    v_mfma_f32_16x16x32_bf16 a[116:119], v[20:23], v[124:127], a[116:119]
    ds_write_b128 v2, a[84:87] offset:13312
    v_mfma_f32_16x16x32_bf16 a[120:123], v[24:27], v[124:127], a[120:123]
    ds_write_b128 v2, a[88:91] offset:14336
    v_mfma_f32_16x16x32_bf16 a[124:127], v[28:31], v[124:127], a[124:127]
    ds_write_b128 v2, a[92:95] offset:15360
    v_mfma_f32_16x16x32_bf16 a[0:3], v[16:19], v[96:99], a[0:3]
    ds_write_b128 v3, a[96:99] offset:16384
    v_mfma_f32_16x16x32_bf16 a[4:7], v[20:23], v[96:99], a[4:7]
    ds_write_b128 v3, a[100:103] offset:17408
    v_mfma_f32_16x16x32_bf16 a[8:11], v[24:27], v[96:99], a[8:11]
    ds_write_b128 v3, a[104:107] offset:18432
    v_mfma_f32_16x16x32_bf16 a[12:15], v[28:31], v[96:99], a[12:15]
    ds_write_b128 v3, a[108:111] offset:19456
    v_mfma_f32_16x16x32_bf16 a[28:31], v[28:31], v[100:103], a[28:31]
    ds_write_b128 v3, a[112:115] offset:20480
    v_mfma_f32_16x16x32_bf16 a[24:27], v[24:27], v[100:103], a[24:27]
    ds_write_b128 v3, a[116:119] offset:21504
    v_mfma_f32_16x16x32_bf16 a[20:23], v[20:23], v[100:103], a[20:23]
    ds_write_b128 v3, a[120:123] offset:22528
    v_mfma_f32_16x16x32_bf16 a[16:19], v[16:19], v[100:103], a[16:19]
    ds_write_b128 v3, a[124:127] offset:23552
    v_accvgpr_read_b32 v48, a0
    v_accvgpr_read_b32 v49, a1
    v_accvgpr_read_b32 v50, a2
    v_accvgpr_read_b32 v51, a3
    v_accvgpr_read_b32 v52, a4
    v_accvgpr_read_b32 v53, a5
    v_accvgpr_read_b32 v54, a6
    v_accvgpr_read_b32 v55, a7
    v_accvgpr_read_b32 v56, a8
    v_accvgpr_read_b32 v57, a9
    v_accvgpr_read_b32 v58, a10
    v_accvgpr_read_b32 v59, a11
    v_accvgpr_read_b32 v60, a12
    v_accvgpr_read_b32 v61, a13
    v_accvgpr_read_b32 v62, a14
    v_accvgpr_read_b32 v63, a15
    v_accvgpr_read_b32 v64, a16
    v_accvgpr_read_b32 v65, a17
    v_accvgpr_read_b32 v66, a18
    v_accvgpr_read_b32 v67, a19
    v_accvgpr_read_b32 v68, a20
    v_accvgpr_read_b32 v69, a21
    v_accvgpr_read_b32 v70, a22
    v_accvgpr_read_b32 v71, a23
    v_accvgpr_read_b32 v72, a24
    v_accvgpr_read_b32 v73, a25
    v_accvgpr_read_b32 v74, a26
    v_accvgpr_read_b32 v75, a27
    v_accvgpr_read_b32 v76, a28
    v_accvgpr_read_b32 v77, a29
    v_accvgpr_read_b32 v78, a30
    v_accvgpr_read_b32 v79, a31
    s_waitcnt lgkmcnt(0)
    s_barrier
    ds_read_b128 v[80:83], v4 offset:0
    ds_read_b128 v[84:87], v4 offset:1024
    ds_read_b128 v[88:91], v4 offset:8192
    ds_read_b128 v[92:95], v4 offset:9216
    ds_read_b128 v[96:99], v4 offset:16384
    ds_read_b128 v[100:103], v4 offset:17408
    ds_read_b128 v[104:107], v4 offset:2048
    ds_read_b128 v[108:111], v4 offset:3072
    ds_read_b128 v[112:115], v4 offset:10240
    ds_read_b128 v[116:119], v4 offset:11264
    ds_read_b128 v[120:123], v4 offset:18432
    ds_read_b128 v[124:127], v4 offset:19456
    s_waitcnt lgkmcnt(11)
    v_pk_add_f32 v[48:49], v[48:49], v[80:81]
    s_waitcnt lgkmcnt(7)
    v_pk_add_f32 v[88:89], v[88:89], v[96:97]
    v_pk_add_f32 v[50:51], v[50:51], v[82:83]
    v_pk_add_f32 v[90:91], v[90:91], v[98:99]
    v_pk_add_f32 v[52:53], v[52:53], v[84:85]
    s_waitcnt lgkmcnt(6)
    v_pk_add_f32 v[92:93], v[92:93], v[100:101]
    v_pk_add_f32 v[54:55], v[54:55], v[86:87]
    v_pk_add_f32 v[94:95], v[94:95], v[102:103]
    v_pk_add_f32 v[48:49], v[48:49], v[88:89]
    v_pk_add_f32 v[50:51], v[50:51], v[90:91]
    v_pk_add_f32 v[52:53], v[52:53], v[92:93]
    v_pk_add_f32 v[54:55], v[54:55], v[94:95]
    s_waitcnt vmcnt(3)
    v_lshlrev_b32 v16, 16, v32
    v_and_b32 v17, 0xffff0000, v32
    v_lshlrev_b32 v18, 16, v33
    v_and_b32 v19, 0xffff0000, v33
    v_lshlrev_b32 v20, 16, v34
    v_and_b32 v21, 0xffff0000, v34
    v_lshlrev_b32 v22, 16, v35
    v_and_b32 v23, 0xffff0000, v35
    v_permlane16_swap_b32 v48, v52
    v_permlane16_swap_b32 v49, v53
    v_permlane16_swap_b32 v50, v54
    v_permlane16_swap_b32 v51, v55
    v_pk_add_f32 v[48:49], v[48:49], v[16:17]
    v_pk_add_f32 v[50:51], v[50:51], v[18:19]
    v_pk_add_f32 v[52:53], v[52:53], v[20:21]
    v_pk_add_f32 v[54:55], v[54:55], v[22:23]
    v_cvt_pk_bf16_f32 v24, v48, v49
    v_cvt_pk_bf16_f32 v25, v50, v51
    v_cvt_pk_bf16_f32 v26, v52, v53
    v_cvt_pk_bf16_f32 v27, v54, v55
    buffer_store_dwordx4 v[24:27], v14, s[40:43], s53 offen offset:0 sc1 nt
    ds_read_b128 v[80:83], v4 offset:4096
    ds_read_b128 v[84:87], v4 offset:5120
    ds_read_b128 v[88:91], v4 offset:12288
    ds_read_b128 v[92:95], v4 offset:13312
    ds_read_b128 v[96:99], v4 offset:20480
    ds_read_b128 v[100:103], v4 offset:21504
    s_waitcnt lgkmcnt(11)
    v_pk_add_f32 v[56:57], v[56:57], v[104:105]
    s_waitcnt lgkmcnt(7)
    v_pk_add_f32 v[112:113], v[112:113], v[120:121]
    v_pk_add_f32 v[58:59], v[58:59], v[106:107]
    v_pk_add_f32 v[114:115], v[114:115], v[122:123]
    v_pk_add_f32 v[60:61], v[60:61], v[108:109]
    s_waitcnt lgkmcnt(6)
    v_pk_add_f32 v[116:117], v[116:117], v[124:125]
    v_pk_add_f32 v[62:63], v[62:63], v[110:111]
    v_pk_add_f32 v[118:119], v[118:119], v[126:127]
    v_pk_add_f32 v[56:57], v[56:57], v[112:113]
    v_pk_add_f32 v[58:59], v[58:59], v[114:115]
    v_pk_add_f32 v[60:61], v[60:61], v[116:117]
    v_pk_add_f32 v[62:63], v[62:63], v[118:119]
    s_waitcnt vmcnt(3)
    v_lshlrev_b32 v16, 16, v36
    v_and_b32 v17, 0xffff0000, v36
    v_lshlrev_b32 v18, 16, v37
    v_and_b32 v19, 0xffff0000, v37
    v_lshlrev_b32 v20, 16, v38
    v_and_b32 v21, 0xffff0000, v38
    v_lshlrev_b32 v22, 16, v39
    v_and_b32 v23, 0xffff0000, v39
    v_permlane16_swap_b32 v56, v60
    v_permlane16_swap_b32 v57, v61
    v_permlane16_swap_b32 v58, v62
    v_permlane16_swap_b32 v59, v63
    v_pk_add_f32 v[56:57], v[56:57], v[16:17]
    v_pk_add_f32 v[58:59], v[58:59], v[18:19]
    v_pk_add_f32 v[60:61], v[60:61], v[20:21]
    v_pk_add_f32 v[62:63], v[62:63], v[22:23]
    v_cvt_pk_bf16_f32 v28, v56, v57
    v_cvt_pk_bf16_f32 v29, v58, v59
    v_cvt_pk_bf16_f32 v30, v60, v61
    v_cvt_pk_bf16_f32 v31, v62, v63
    buffer_store_dwordx4 v[28:31], v14, s[40:43], s53 offen offset:64 sc1 nt
    ds_read_b128 v[104:107], v4 offset:6144
    ds_read_b128 v[108:111], v4 offset:7168
    ds_read_b128 v[112:115], v4 offset:14336
    ds_read_b128 v[116:119], v4 offset:15360
    ds_read_b128 v[120:123], v4 offset:22528
    ds_read_b128 v[124:127], v4 offset:23552
    s_waitcnt lgkmcnt(11)
    v_pk_add_f32 v[64:65], v[64:65], v[80:81]
    s_waitcnt lgkmcnt(7)
    v_pk_add_f32 v[88:89], v[88:89], v[96:97]
    v_pk_add_f32 v[66:67], v[66:67], v[82:83]
    v_pk_add_f32 v[90:91], v[90:91], v[98:99]
    v_pk_add_f32 v[68:69], v[68:69], v[84:85]
    s_waitcnt lgkmcnt(6)
    v_pk_add_f32 v[92:93], v[92:93], v[100:101]
    v_pk_add_f32 v[70:71], v[70:71], v[86:87]
    v_pk_add_f32 v[94:95], v[94:95], v[102:103]
    v_pk_add_f32 v[64:65], v[64:65], v[88:89]
    v_pk_add_f32 v[66:67], v[66:67], v[90:91]
    v_pk_add_f32 v[68:69], v[68:69], v[92:93]
    v_pk_add_f32 v[70:71], v[70:71], v[94:95]
    s_waitcnt vmcnt(3)
    v_lshlrev_b32 v16, 16, v40
    v_and_b32 v17, 0xffff0000, v40
    v_lshlrev_b32 v18, 16, v41
    v_and_b32 v19, 0xffff0000, v41
    v_lshlrev_b32 v20, 16, v42
    v_and_b32 v21, 0xffff0000, v42
    v_lshlrev_b32 v22, 16, v43
    v_and_b32 v23, 0xffff0000, v43
    v_permlane16_swap_b32 v64, v68
    v_permlane16_swap_b32 v65, v69
    v_permlane16_swap_b32 v66, v70
    v_permlane16_swap_b32 v67, v71
    v_pk_add_f32 v[64:65], v[64:65], v[16:17]
    v_pk_add_f32 v[66:67], v[66:67], v[18:19]
    v_pk_add_f32 v[68:69], v[68:69], v[20:21]
    v_pk_add_f32 v[70:71], v[70:71], v[22:23]
    v_cvt_pk_bf16_f32 v24, v64, v65
    v_cvt_pk_bf16_f32 v25, v66, v67
    v_cvt_pk_bf16_f32 v26, v68, v69
    v_cvt_pk_bf16_f32 v27, v70, v71
    buffer_store_dwordx4 v[24:27], v14, s[40:43], s73 offen offset:0 sc1 nt
    s_waitcnt lgkmcnt(5)
    v_pk_add_f32 v[72:73], v[72:73], v[104:105]
    s_waitcnt lgkmcnt(1)
    v_pk_add_f32 v[112:113], v[112:113], v[120:121]
    v_pk_add_f32 v[74:75], v[74:75], v[106:107]
    v_pk_add_f32 v[114:115], v[114:115], v[122:123]
    v_pk_add_f32 v[76:77], v[76:77], v[108:109]
    s_waitcnt lgkmcnt(0)
    v_pk_add_f32 v[116:117], v[116:117], v[124:125]
    v_pk_add_f32 v[78:79], v[78:79], v[110:111]
    v_pk_add_f32 v[118:119], v[118:119], v[126:127]
    v_pk_add_f32 v[72:73], v[72:73], v[112:113]
    v_pk_add_f32 v[74:75], v[74:75], v[114:115]
    v_pk_add_f32 v[76:77], v[76:77], v[116:117]
    v_pk_add_f32 v[78:79], v[78:79], v[118:119]
    s_waitcnt vmcnt(3)
    v_lshlrev_b32 v16, 16, v44
    v_and_b32 v17, 0xffff0000, v44
    v_lshlrev_b32 v18, 16, v45
    v_and_b32 v19, 0xffff0000, v45
    v_lshlrev_b32 v20, 16, v46
    v_and_b32 v21, 0xffff0000, v46
    v_lshlrev_b32 v22, 16, v47
    v_and_b32 v23, 0xffff0000, v47
    v_permlane16_swap_b32 v72, v76
    v_permlane16_swap_b32 v73, v77
    v_permlane16_swap_b32 v74, v78
    v_permlane16_swap_b32 v75, v79
    v_pk_add_f32 v[72:73], v[72:73], v[16:17]
    v_pk_add_f32 v[74:75], v[74:75], v[18:19]
    v_pk_add_f32 v[76:77], v[76:77], v[20:21]
    v_pk_add_f32 v[78:79], v[78:79], v[22:23]
    v_cvt_pk_bf16_f32 v28, v72, v73
    v_cvt_pk_bf16_f32 v29, v74, v75
    v_cvt_pk_bf16_f32 v30, v76, v77
    v_cvt_pk_bf16_f32 v31, v78, v79
    buffer_store_dwordx4 v[28:31], v14, s[40:43], s73 offen offset:64 sc1 nt
L_k2_kernel_end:
    s_endpgm
L_text_end:
    s_endpgm
.section .rodata,"a"
.p2align 6
.amdhsa_kernel gemm1_kernel
  .amdhsa_next_free_vgpr 484
  .amdhsa_next_free_sgpr 100
  .amdhsa_accum_offset 256
  .amdhsa_group_segment_fixed_size 0
  .amdhsa_kernarg_size 80
  .amdhsa_user_sgpr_count 2
  .amdhsa_user_sgpr_kernarg_segment_ptr 1
  .amdhsa_system_sgpr_workgroup_id_x 1
.end_amdhsa_kernel
.p2align 6
.amdhsa_kernel k2_kernel
  .amdhsa_next_free_vgpr 256
  .amdhsa_next_free_sgpr 96
  .amdhsa_accum_offset 128
  .amdhsa_group_segment_fixed_size 0
  .amdhsa_kernarg_size 80
  .amdhsa_user_sgpr_count 2
  .amdhsa_user_sgpr_kernarg_segment_ptr 1
  .amdhsa_system_sgpr_workgroup_id_x 1
.end_amdhsa_kernel
```
